```python
import torch

def _softmax(x, axis=-1):
    return torch.softmax(x, dim=axis)

def _gelu(x):
    return torch.nn.functional.gelu(x, approximate='tanh')

def _silu(x):
    return torch.nn.functional.silu(x)

def _sigmoid(x):
    return torch.sigmoid(x)

def _layernorm(x, axis=-1, eps=1e-05):
    m = x.mean(dim=axis, keepdim=True)
    v = x.var(dim=axis, keepdim=True, unbiased=False)
    return (x - m) / torch.sqrt(v + eps)

def _scatter_add(tgt, idx, src, axis=0):
    return tgt.clone().index_add_(axis, idx, src)

def _segment_sum(src, seg, n):
    out = torch.zeros((n,) + src.shape[1:], dtype=src.dtype)
    return out.index_add_(0, seg, src)

def _pad(x, pw):
    flat = tuple((v for pair in reversed(pw) for v in pair))
    return torch.nn.functional.pad(x, flat)
kernel_name = 'gated_mix__memory_aug_recurrent_mem_tr__dense_activation_squared_relu__prompt'

def setup_inputs():

    _w = lambda a: (lambda t: t.to(torch.bfloat16) if t.is_floating_point() else t)(torch.as_tensor(a))

    def _A_setup():
        B, S, Dm = (1, 2048, 512)
        H, Dh = (32, 128)
        M, seg = (8, 32)
        seg = min(seg, S)
        S = S // seg * seg
        return {'x': _w((lambda *s: torch.randn(*s, dtype=torch.bfloat16) * 0.05)(B, S, Dm)), 'mem0': _w((lambda *s: torch.randn(*s, dtype=torch.bfloat16) * 0.8)(B, M, Dm)), 'Wq': _w((lambda *s: torch.randn(*s, dtype=torch.bfloat16) * 1.6)(Dm, H, Dh) * Dm ** (-0.5)), 'Wk': _w((lambda *s: torch.randn(*s, dtype=torch.bfloat16) * 1.6)(Dm, H, Dh) * Dm ** (-0.5)), 'Wv': _w((lambda *s: torch.randn(*s, dtype=torch.bfloat16) * 0.8)(Dm, H, Dh) * Dm ** (-0.5)), 'Wo': _w((lambda *s: torch.randn(*s, dtype=torch.bfloat16) * 0.8)(H, Dh, Dm) * (H * Dh) ** (-0.5)), 'seg_len': seg}
    _A_in = _A_setup()

    def _B_setup():
        B, S, D, F = (1, 2048, 512, 1792)
        return {'x': _w((lambda *s: torch.randn(*s, dtype=torch.bfloat16) * 0.05)(B, S, D)), 'w1': _w((lambda *s: torch.randn(*s, dtype=torch.bfloat16) * 0.05)(D, F)), 'b1': _w((lambda *s: torch.randn(*s, dtype=torch.bfloat16) * 0.1)(F)), 'w2': _w((lambda *s: torch.randn(*s, dtype=torch.bfloat16) * 0.05)(F, D)), 'b2': _w((lambda *s: torch.randn(*s, dtype=torch.bfloat16) * 0.05)(D))}
    _B_in = _B_setup()
    return {'A_x': _A_in['x'], 'A_mem0': _A_in['mem0'], 'A_Wq': _A_in['Wq'], 'A_Wk': _A_in['Wk'], 'A_Wv': _A_in['Wv'], 'A_Wo': _A_in['Wo'], 'A_seg_len': _A_in['seg_len'], 'B_x': _B_in['x'], 'B_w1': _B_in['w1'], 'B_b1': _B_in['b1'], 'B_w2': _B_in['w2'], 'B_b2': _B_in['b2'], 'gate_w': _w((lambda *s: torch.randn(*s, dtype=torch.bfloat16) * 0.05)(512) * 16.0)}

def reference(A_x, A_mem0, A_Wq, A_Wk, A_Wv, A_Wo, A_seg_len, B_x, B_w1, B_b1, B_w2, B_b2, gate_w):

    def _A_ref(x, mem0, Wq, Wk, Wv, Wo, seg_len):
        B, S, Dm = x.shape
        H, Dh = (Wq.shape[1], Wq.shape[2])
        M = mem0.shape[1]
        scale = Dh ** (-0.5)
        n_seg = S // seg_len
        L = M + seg_len
        idx = torch.arange(L)
        mask = (idx[:, None] < M) | (idx[:, None] >= idx[None, :])
        mem = mem0
        outs = []
        for s in range(n_seg):
            xs = x[:, s * seg_len:(s + 1) * seg_len, :].clone()
            h = torch.concatenate([mem, xs], axis=1)
            q = torch.einsum('btd,dhe->bhte', h, Wq)
            k = torch.einsum('btd,dhe->bhte', h, Wk)
            v = torch.einsum('btd,dhe->bhte', h, Wv)
            scores = torch.einsum('bhqe,bhke->bhqk', q, k) * scale
            scores = torch.where(mask[None, None], scores, -1000000000.0)
            p = _softmax(scores, axis=-1)
            o = torch.einsum('bhqk,bhke->bhqe', p, v)
            o = torch.einsum('bhte,hed->btd', o, Wo)
            mem = o[:, :M, :].clone()
            outs.append(o[:, M:, :])
        return torch.concatenate(outs, axis=1)

    def _B_ref(x, w1, b1, w2, b2):
        h = torch.einsum('bsd,df->bsf', x, w1) + b1
        zero = torch.zeros_like(h)
        r = torch.where(h > zero, h, zero)
        h = r * r
        out = torch.einsum('bsf,fd->bsd', h, w2) + b2
        return out
    x = A_x
    g = _sigmoid((x * gate_w).sum(-1, keepdims=True))
    a = _A_ref(x, A_mem0, A_Wq, A_Wk, A_Wv, A_Wo, A_seg_len)
    b = _B_ref(x, B_w1, B_b1, B_w2, B_b2)
    return g * a + (1 - g) * b
```

```asm
; @launch grid=(256,1,1) block=(256,1,1) lds=163840
.amdgcn_target "amdgcn-amd-amdhsa--gfx950"
.text
.globl gated_mix__memory_aug_recurrent_mem_tr__dense_activation_squared_relu__prompt_kernel
.p2align 8
.type gated_mix__memory_aug_recurrent_mem_tr__dense_activation_squared_relu__prompt_kernel,@function
gated_mix__memory_aug_recurrent_mem_tr__dense_activation_squared_relu__prompt_kernel:
  s_cmp_ge_u32 s2, 256
  s_cbranch_scc1 L_exit
  s_load_dwordx16 s[64:79], s[0:1], 0
  s_load_dwordx16 s[80:95], s[0:1], 64
  s_and_b32 s3, s2, 7
  s_lshr_b32 s32, s2, 3
  s_waitcnt lgkmcnt(0)
  s_mov_b32 s4, s94
  s_and_b32 s5, s95, 0xffff
  s_mov_b32 s6, 0x10000000
  s_mov_b32 s7, 0x00020000
  s_mov_b32 s8, s92
  s_and_b32 s9, s93, 0xffff
  s_mov_b32 s10, 0x100
  s_mov_b32 s11, 0x00020000
  s_cmp_lg_u32 s3, 0
  s_cbranch_scc1 L_worker
  s_mov_b32 s12, s68
  s_and_b32 s13, s69, 0xffff
  s_mov_b32 s14, 0x400000
  s_mov_b32 s15, 0x00020000
  s_mov_b32 s16, s70
  s_and_b32 s17, s71, 0xffff
  s_mov_b32 s18, 0x400000
  s_mov_b32 s19, 0x00020000
  s_mov_b32 s20, s72
  s_and_b32 s21, s73, 0xffff
  s_mov_b32 s22, 0x400000
  s_mov_b32 s23, 0x00020000
  s_mov_b32 s24, s74
  s_and_b32 s25, s75, 0xffff
  s_mov_b32 s26, 0x400000
  s_mov_b32 s27, 0x00020000
  s_mov_b32 s28, s66
  s_and_b32 s29, s67, 0xffff
  s_mov_b32 s30, 0x2000
  s_mov_b32 s31, 0x00020000
  v_lshrrev_b32 v1, 6, v0
  v_and_b32 v0, 63, v0
  s_nop 0
  v_readfirstlane_b32 s33, v1
  v_lshlrev_b32 v3, 4, v0
  v_lshlrev_b32 v4, 3, v0
  s_cmp_eq_u32 s33, 1
  s_cbranch_scc1 c_pro1
  s_cmp_eq_u32 s33, 2
  s_cbranch_scc1 c_pro2
  s_cmp_eq_u32 s33, 3
  s_cbranch_scc1 c_pro3
c_pro0:
  v_lshrrev_b32 v16, 4, v0
  v_bfe_u32 v17, v0, 1, 3
  v_and_b32 v18, 1, v0
  v_and_b32 v19, 1, v16
  v_lshlrev_b32 v19, 1, v19
  v_xor_b32 v19, v19, v17
  v_lshlrev_b32 v19, 5, v19
  v_lshl_add_u32 v19, v18, 4, v19
  v_lshl_add_u32 v20, v16, 10, v19
  s_lshl_b32 s41, s32, 17
  s_add_u32 s41, s41, 0
  v_xor_b32 v21, 128, v20
  v_add_u32 v20, s41, v20
  v_add_u32 v21, s41, v21
  s_mov_b32 m0, 0
  s_mov_b32 s41, 0
  buffer_load_dwordx4 v20, s[24:27], s41 offen nt lds
  s_mov_b32 m0, 1024
  s_mov_b32 s41, 4096
  buffer_load_dwordx4 v20, s[24:27], s41 offen nt lds
  s_mov_b32 m0, 2048
  s_mov_b32 s41, 32768
  buffer_load_dwordx4 v21, s[24:27], s41 offen nt lds
  s_mov_b32 m0, 3072
  s_mov_b32 s41, 36864
  buffer_load_dwordx4 v21, s[24:27], s41 offen nt lds
  s_mov_b32 m0, 65536
  s_mov_b32 s41, 8192
  buffer_load_dwordx4 v20, s[24:27], s41 offen nt lds
  s_mov_b32 m0, 66560
  s_mov_b32 s41, 12288
  buffer_load_dwordx4 v20, s[24:27], s41 offen nt lds
  s_mov_b32 m0, 67584
  s_mov_b32 s41, 40960
  buffer_load_dwordx4 v21, s[24:27], s41 offen nt lds
  s_mov_b32 m0, 68608
  s_mov_b32 s41, 45056
  buffer_load_dwordx4 v21, s[24:27], s41 offen nt lds
  s_mov_b32 m0, 114688
  s_mov_b32 s41, 16384
  buffer_load_dwordx4 v20, s[24:27], s41 offen nt lds
  s_mov_b32 m0, 115712
  s_mov_b32 s41, 20480
  buffer_load_dwordx4 v20, s[24:27], s41 offen nt lds
  s_mov_b32 m0, 116736
  s_mov_b32 s41, 49152
  buffer_load_dwordx4 v21, s[24:27], s41 offen nt lds
  s_mov_b32 m0, 117760
  s_mov_b32 s41, 53248
  buffer_load_dwordx4 v21, s[24:27], s41 offen nt lds
  v_mov_b64 v[28:29], -1
  v_mov_b64 v[30:31], -1
  s_lshl_b32 s41, s32, 13
  s_add_u32 s41, s41, 83886080
  buffer_store_dwordx4 v[28:31], v3, s[4:7], s41 offen sc1
  buffer_store_dwordx4 v[28:31], v3, s[4:7], s41 offen offset:1024 sc1
  s_add_u32 s41, s41, 0x40000
  buffer_store_dwordx4 v[28:31], v3, s[4:7], s41 offen sc1
  buffer_store_dwordx4 v[28:31], v3, s[4:7], s41 offen offset:1024 sc1
  s_lshl_b32 s41, s32, 8
  s_add_u32 s41, s41, 84967424
  v_lshlrev_b32 v19, 2, v0
  buffer_store_dword v28, v19, s[4:7], s41 offen sc1
  s_bfe_u32 s41, s32, 0x20001
  s_lshl_b32 s38, s41, 6
  s_lshl_b32 s41, s41, 11
  s_lshr_b32 s42, s32, 3
  s_lshl_b32 s50, s42, 9
  s_add_u32 s38, s38, s50
  s_lshl_b32 s42, s42, 8
  s_add_u32 s41, s41, s42
  s_and_b32 s42, s32, 1
  s_lshl_b32 s50, s42, 8
  s_add_u32 s38, s38, s50
  s_lshl_b32 s42, s42, 4
  s_add_u32 s41, s41, s42
  v_lshrrev_b32 v19, 5, v0
  v_lshlrev_b32 v48, 10, v19
  v_and_b32 v19, 3, v0
  v_lshl_add_u32 v48, v19, 2, v48
  v_and_b32 v19, 1, v16
  v_lshl_add_u32 v48, v19, 1, v48
  buffer_load_ushort v49, v48, s[28:31], s41 offen offset:0
  buffer_load_ushort v50, v48, s[28:31], s41 offen offset:32
  s_lshl_b32 s37, s32, 13
  s_add_u32 s37, s37, 84148224
  s_add_u32 s39, s38, 85000192
  s_add_u32 s38, s38, 84934656
  s_lshl_b32 s46, s32, 13
  s_add_u32 s46, s46, 16777216
  s_add_u32 s70, s46, 16515072
  s_mov_b32 s34, 0
  s_lshl_b32 s71, s32, 7
  s_add_u32 s71, s71, 85200896
  v_lshrrev_b32 v19, 5, v0
  v_xor_b32 v19, 0, v19
  v_xor_b32 v19, v19, v17
  v_lshlrev_b32 v19, 5, v19
  v_lshl_add_u32 v19, v18, 4, v19
  v_lshl_add_u32 v22, v16, 13, v19
  s_lshl_b32 s41, s32, 8
  v_xor_b32 v23, 64, v22
  v_add_u32 v22, s41, v22
  v_add_u32 v23, s41, v23
  v_bfe_u32 v26, v0, 4, 1
  v_lshrrev_b32 v27, 5, v0
  v_bfe_u32 v12, v0, 2, 1
  v_bfe_u32 v13, v0, 3, 1
  v_and_b32 v14, 3, v0
  v_lshlrev_b32 v15, 3, v26
  v_lshl_add_u32 v15, v27, 2, v15
  v_add_u32 v15, v15, v13
  v_lshlrev_b32 v24, 8, v15
  v_lshl_add_u32 v24, v12, 5, v24
  v_lshl_add_u32 v24, v13, 6, v24
  v_lshl_add_u32 v24, v26, 7, v24
  v_lshl_add_u32 v24, v14, 3, v24
  v_lshlrev_b32 v15, 3, v27
  v_lshl_add_u32 v15, v26, 1, v15
  v_lshl_add_u32 v15, v12, 4, v15
  v_lshl_add_u32 v15, v13, 2, v15
  v_lshlrev_b32 v25, 8, v15
  v_lshl_add_u32 v25, v26, 5, v25
  v_lshl_add_u32 v25, v13, 6, v25
  v_lshl_add_u32 v25, v12, 7, v25
  v_lshl_add_u32 v25, v14, 3, v25
  v_lshrrev_b32 v16, 4, v0
  v_and_b32 v17, 15, v0
  v_bfe_u32 v18, v0, 1, 1
  v_mov_b32 v1, 0x88884444
  v_mov_b32 v19, 0xddddeeee
  v_cmp_eq_u32 vcc, 1, v18
  s_nop 1
  v_cndmask_b32 v1, v1, v19, vcc
  v_lshrrev_b32 v18, 2, v17
  v_bfe_u32 v19, v0, 1, 1
  v_lshlrev_b32 v2, 5, v19
  v_lshrrev_b32 v19, 1, v16
  v_lshl_add_u32 v2, v19, 4, v2
  v_and_b32 v19, 1, v0
  v_lshl_add_u32 v2, v19, 3, v2
  v_and_b32 v19, 1, v16
  v_lshl_add_u32 v2, v19, 2, v2
  v_lshlrev_b32 v5, 4, v17
  v_lshl_add_u32 v5, v16, 2, v5
  v_lshlrev_b32 v6, 1, v5
  v_and_b32 v19, 1, v0
  v_lshl_add_u32 v19, v18, 1, v19
  v_lshlrev_b32 v8, 4, v19
  v_lshl_add_u32 v8, v16, 7, v8
  v_and_b32 v19, 7, v0
  v_lshlrev_b32 v10, 3, v19
  v_lshrrev_b32 v19, 3, v0
  v_lshl_add_u32 v10, v19, 13, v10
  s_mov_b32 s43, 0x3e0293ee
  s_mov_b32 s44, 0x35800000
  s_mov_b32 s69, 0x14000000
  s_waitcnt vmcnt(15) lgkmcnt(0)
  s_barrier
  s_mov_b32 m0, 147456
  s_mov_b32 s41, 24576
  buffer_load_dwordx4 v20, s[24:27], s41 offen nt lds
  s_mov_b32 m0, 148480
  s_mov_b32 s41, 28672
  buffer_load_dwordx4 v20, s[24:27], s41 offen nt lds
  s_mov_b32 m0, 149504
  s_mov_b32 s41, 57344
  buffer_load_dwordx4 v21, s[24:27], s41 offen nt lds
  s_mov_b32 m0, 150528
  s_mov_b32 s41, 61440
  buffer_load_dwordx4 v21, s[24:27], s41 offen nt lds
  v_xor_b32 v12, 0, v24
  v_add_u32 v12, 0, v12
  ds_read_b64_tr_b16 v[128:129], v12 offset:0
  ds_read_b64_tr_b16 v[130:131], v12 offset:512
  v_xor_b32 v12, 64, v24
  v_add_u32 v12, 0, v12
  ds_read_b64_tr_b16 v[160:161], v12 offset:0
  ds_read_b64_tr_b16 v[162:163], v12 offset:512
  v_xor_b32 v12, 128, v24
  v_add_u32 v12, 0, v12
  ds_read_b64_tr_b16 v[192:193], v12 offset:0
  ds_read_b64_tr_b16 v[194:195], v12 offset:512
  v_xor_b32 v12, 192, v24
  v_add_u32 v12, 0, v12
  ds_read_b64_tr_b16 v[224:225], v12 offset:0
  ds_read_b64_tr_b16 v[226:227], v12 offset:512
  s_waitcnt vmcnt(15) lgkmcnt(0)
  s_barrier
  s_mov_b32 m0, 0
  s_mov_b32 s41, 65536
  buffer_load_dwordx4 v20, s[24:27], s41 offen nt lds
  s_mov_b32 m0, 1024
  s_mov_b32 s41, 69632
  buffer_load_dwordx4 v20, s[24:27], s41 offen nt lds
  s_mov_b32 m0, 2048
  s_mov_b32 s41, 98304
  buffer_load_dwordx4 v21, s[24:27], s41 offen nt lds
  s_mov_b32 m0, 3072
  s_mov_b32 s41, 102400
  buffer_load_dwordx4 v21, s[24:27], s41 offen nt lds
  v_xor_b32 v12, 0, v24
  v_add_u32 v12, 65536, v12
  ds_read_b64_tr_b16 v[132:133], v12 offset:0
  ds_read_b64_tr_b16 v[134:135], v12 offset:512
  v_xor_b32 v12, 64, v24
  v_add_u32 v12, 65536, v12
  ds_read_b64_tr_b16 v[164:165], v12 offset:0
  ds_read_b64_tr_b16 v[166:167], v12 offset:512
  v_xor_b32 v12, 128, v24
  v_add_u32 v12, 65536, v12
  ds_read_b64_tr_b16 v[196:197], v12 offset:0
  ds_read_b64_tr_b16 v[198:199], v12 offset:512
  v_xor_b32 v12, 192, v24
  v_add_u32 v12, 65536, v12
  ds_read_b64_tr_b16 v[228:229], v12 offset:0
  ds_read_b64_tr_b16 v[230:231], v12 offset:512
  s_waitcnt vmcnt(15) lgkmcnt(0)
  s_barrier
  s_mov_b32 m0, 65536
  s_mov_b32 s41, 73728
  buffer_load_dwordx4 v20, s[24:27], s41 offen nt lds
  s_mov_b32 m0, 66560
  s_mov_b32 s41, 77824
  buffer_load_dwordx4 v20, s[24:27], s41 offen nt lds
  s_mov_b32 m0, 67584
  s_mov_b32 s41, 106496
  buffer_load_dwordx4 v21, s[24:27], s41 offen nt lds
  s_mov_b32 m0, 68608
  s_mov_b32 s41, 110592
  buffer_load_dwordx4 v21, s[24:27], s41 offen nt lds
  v_xor_b32 v12, 0, v24
  v_add_u32 v12, 114688, v12
  ds_read_b64_tr_b16 v[136:137], v12 offset:0
  ds_read_b64_tr_b16 v[138:139], v12 offset:512
  v_xor_b32 v12, 64, v24
  v_add_u32 v12, 114688, v12
  ds_read_b64_tr_b16 v[168:169], v12 offset:0
  ds_read_b64_tr_b16 v[170:171], v12 offset:512
  v_xor_b32 v12, 128, v24
  v_add_u32 v12, 114688, v12
  ds_read_b64_tr_b16 v[200:201], v12 offset:0
  ds_read_b64_tr_b16 v[202:203], v12 offset:512
  v_xor_b32 v12, 192, v24
  v_add_u32 v12, 114688, v12
  ds_read_b64_tr_b16 v[232:233], v12 offset:0
  ds_read_b64_tr_b16 v[234:235], v12 offset:512
  s_waitcnt vmcnt(8) lgkmcnt(0)
  s_barrier
  s_mov_b32 m0, 114688
  s_mov_b32 s41, 81920
  buffer_load_dwordx4 v20, s[24:27], s41 offen nt lds
  s_mov_b32 m0, 115712
  s_mov_b32 s41, 86016
  buffer_load_dwordx4 v20, s[24:27], s41 offen nt lds
  s_mov_b32 m0, 116736
  s_mov_b32 s41, 114688
  buffer_load_dwordx4 v21, s[24:27], s41 offen nt lds
  s_mov_b32 m0, 117760
  s_mov_b32 s41, 118784
  buffer_load_dwordx4 v21, s[24:27], s41 offen nt lds
  v_lshl_or_b32 v49, v50, 16, v49
  buffer_store_dword v49, v2, s[4:7], s38 offen sc1
  v_xor_b32 v12, 0, v24
  v_add_u32 v12, 147456, v12
  ds_read_b64_tr_b16 v[140:141], v12 offset:0
  ds_read_b64_tr_b16 v[142:143], v12 offset:512
  v_xor_b32 v12, 64, v24
  v_add_u32 v12, 147456, v12
  ds_read_b64_tr_b16 v[172:173], v12 offset:0
  ds_read_b64_tr_b16 v[174:175], v12 offset:512
  v_xor_b32 v12, 128, v24
  v_add_u32 v12, 147456, v12
  ds_read_b64_tr_b16 v[204:205], v12 offset:0
  ds_read_b64_tr_b16 v[206:207], v12 offset:512
  v_xor_b32 v12, 192, v24
  v_add_u32 v12, 147456, v12
  ds_read_b64_tr_b16 v[236:237], v12 offset:0
  ds_read_b64_tr_b16 v[238:239], v12 offset:512
  s_waitcnt vmcnt(9) lgkmcnt(0)
  s_barrier
  s_mov_b32 m0, 147456
  s_mov_b32 s41, 90112
  buffer_load_dwordx4 v20, s[24:27], s41 offen nt lds
  s_mov_b32 m0, 148480
  s_mov_b32 s41, 94208
  buffer_load_dwordx4 v20, s[24:27], s41 offen nt lds
  s_mov_b32 m0, 149504
  s_mov_b32 s41, 122880
  buffer_load_dwordx4 v21, s[24:27], s41 offen nt lds
  s_mov_b32 m0, 150528
  s_mov_b32 s41, 126976
  buffer_load_dwordx4 v21, s[24:27], s41 offen nt lds
  v_xor_b32 v12, 0, v24
  v_add_u32 v12, 0, v12
  ds_read_b64_tr_b16 v[144:145], v12 offset:0
  ds_read_b64_tr_b16 v[146:147], v12 offset:512
  v_xor_b32 v12, 64, v24
  v_add_u32 v12, 0, v12
  ds_read_b64_tr_b16 v[176:177], v12 offset:0
  ds_read_b64_tr_b16 v[178:179], v12 offset:512
  v_xor_b32 v12, 128, v24
  v_add_u32 v12, 0, v12
  ds_read_b64_tr_b16 v[208:209], v12 offset:0
  ds_read_b64_tr_b16 v[210:211], v12 offset:512
  v_xor_b32 v12, 192, v24
  v_add_u32 v12, 0, v12
  ds_read_b64_tr_b16 v[240:241], v12 offset:0
  ds_read_b64_tr_b16 v[242:243], v12 offset:512
  s_waitcnt vmcnt(9) lgkmcnt(0)
  s_barrier
  s_mov_b32 m0, 0
  s_mov_b32 s41, 0
  buffer_load_dwordx4 v22, s[12:15], s41 offen nt lds
  s_mov_b32 m0, 1024
  s_mov_b32 s41, 32768
  buffer_load_dwordx4 v23, s[12:15], s41 offen nt lds
  s_mov_b32 m0, 2048
  s_mov_b32 s41, 65536
  buffer_load_dwordx4 v22, s[12:15], s41 offen nt lds
  s_mov_b32 m0, 3072
  s_mov_b32 s41, 98304
  buffer_load_dwordx4 v23, s[12:15], s41 offen nt lds
  v_xor_b32 v12, 0, v24
  v_add_u32 v12, 65536, v12
  ds_read_b64_tr_b16 v[148:149], v12 offset:0
  ds_read_b64_tr_b16 v[150:151], v12 offset:512
  v_xor_b32 v12, 64, v24
  v_add_u32 v12, 65536, v12
  ds_read_b64_tr_b16 v[180:181], v12 offset:0
  ds_read_b64_tr_b16 v[182:183], v12 offset:512
  v_xor_b32 v12, 128, v24
  v_add_u32 v12, 65536, v12
  ds_read_b64_tr_b16 v[212:213], v12 offset:0
  ds_read_b64_tr_b16 v[214:215], v12 offset:512
  v_xor_b32 v12, 192, v24
  v_add_u32 v12, 65536, v12
  ds_read_b64_tr_b16 v[244:245], v12 offset:0
  ds_read_b64_tr_b16 v[246:247], v12 offset:512
  s_waitcnt vmcnt(9) lgkmcnt(0)
  s_barrier
  s_mov_b32 m0, 65536
  s_mov_b32 s41, 2097152
  buffer_load_dwordx4 v22, s[12:15], s41 offen nt lds
  s_mov_b32 m0, 66560
  s_mov_b32 s41, 2129920
  buffer_load_dwordx4 v23, s[12:15], s41 offen nt lds
  s_mov_b32 m0, 67584
  s_mov_b32 s41, 2162688
  buffer_load_dwordx4 v22, s[12:15], s41 offen nt lds
  s_mov_b32 m0, 68608
  s_mov_b32 s41, 2195456
  buffer_load_dwordx4 v23, s[12:15], s41 offen nt lds
  v_xor_b32 v12, 0, v24
  v_add_u32 v12, 114688, v12
  ds_read_b64_tr_b16 v[152:153], v12 offset:0
  ds_read_b64_tr_b16 v[154:155], v12 offset:512
  v_xor_b32 v12, 64, v24
  v_add_u32 v12, 114688, v12
  ds_read_b64_tr_b16 v[184:185], v12 offset:0
  ds_read_b64_tr_b16 v[186:187], v12 offset:512
  v_xor_b32 v12, 128, v24
  v_add_u32 v12, 114688, v12
  ds_read_b64_tr_b16 v[216:217], v12 offset:0
  ds_read_b64_tr_b16 v[218:219], v12 offset:512
  v_xor_b32 v12, 192, v24
  v_add_u32 v12, 114688, v12
  ds_read_b64_tr_b16 v[248:249], v12 offset:0
  ds_read_b64_tr_b16 v[250:251], v12 offset:512
  s_waitcnt vmcnt(8) lgkmcnt(0)
  s_barrier
  s_mov_b32 m0, 114688
  s_mov_b32 s41, 262144
  buffer_load_dwordx4 v22, s[12:15], s41 offen nt lds
  s_mov_b32 m0, 115712
  s_mov_b32 s41, 294912
  buffer_load_dwordx4 v23, s[12:15], s41 offen nt lds
  s_mov_b32 m0, 116736
  s_mov_b32 s41, 327680
  buffer_load_dwordx4 v22, s[12:15], s41 offen nt lds
  s_mov_b32 m0, 117760
  s_mov_b32 s41, 360448
  buffer_load_dwordx4 v23, s[12:15], s41 offen nt lds
  s_getreg_b32 s50, hwreg(HW_REG_XCC_ID, 0, 3)
  s_mul_i32 s50, s50, 6
  s_lshl_b64 s[56:57], 1, s50
  v_mov_b32 v28, s56
  v_mov_b32 v29, s57
  s_mov_b64 exec, 1
  buffer_atomic_add_x2 v[28:29], off, s[8:11], 0
  s_mov_b64 exec, -1
  v_xor_b32 v12, 0, v24
  v_add_u32 v12, 147456, v12
  ds_read_b64_tr_b16 v[156:157], v12 offset:0
  ds_read_b64_tr_b16 v[158:159], v12 offset:512
  v_xor_b32 v12, 64, v24
  v_add_u32 v12, 147456, v12
  ds_read_b64_tr_b16 v[188:189], v12 offset:0
  ds_read_b64_tr_b16 v[190:191], v12 offset:512
  v_xor_b32 v12, 128, v24
  v_add_u32 v12, 147456, v12
  ds_read_b64_tr_b16 v[220:221], v12 offset:0
  ds_read_b64_tr_b16 v[222:223], v12 offset:512
  v_xor_b32 v12, 192, v24
  v_add_u32 v12, 147456, v12
  ds_read_b64_tr_b16 v[252:253], v12 offset:0
  ds_read_b64_tr_b16 v[254:255], v12 offset:512
  s_waitcnt vmcnt(9) lgkmcnt(0)
  s_barrier
  s_mov_b32 m0, 147456
  s_mov_b32 s41, 2359296
  buffer_load_dwordx4 v22, s[12:15], s41 offen nt lds
  s_mov_b32 m0, 148480
  s_mov_b32 s41, 2392064
  buffer_load_dwordx4 v23, s[12:15], s41 offen nt lds
  s_mov_b32 m0, 149504
  s_mov_b32 s41, 2424832
  buffer_load_dwordx4 v22, s[12:15], s41 offen nt lds
  s_mov_b32 m0, 150528
  s_mov_b32 s41, 2457600
  buffer_load_dwordx4 v23, s[12:15], s41 offen nt lds
  v_xor_b32 v12, 0, v25
  v_add_u32 v12, 0, v12
  ds_read_b64_tr_b16 a[0:1], v12 offset:0
  ds_read_b64_tr_b16 a[2:3], v12 offset:256
  ds_read_b64_tr_b16 a[4:5], v12 offset:8192
  ds_read_b64_tr_b16 a[6:7], v12 offset:8448
  v_xor_b32 v12, 32, v25
  v_add_u32 v12, 0, v12
  ds_read_b64_tr_b16 a[64:65], v12 offset:0
  ds_read_b64_tr_b16 a[66:67], v12 offset:256
  ds_read_b64_tr_b16 a[68:69], v12 offset:8192
  ds_read_b64_tr_b16 a[70:71], v12 offset:8448
  s_waitcnt vmcnt(9) lgkmcnt(0)
  s_barrier
  s_mov_b32 m0, 0
  s_mov_b32 s41, 524288
  buffer_load_dwordx4 v22, s[12:15], s41 offen nt lds
  s_mov_b32 m0, 1024
  s_mov_b32 s41, 557056
  buffer_load_dwordx4 v23, s[12:15], s41 offen nt lds
  s_mov_b32 m0, 2048
  s_mov_b32 s41, 589824
  buffer_load_dwordx4 v22, s[12:15], s41 offen nt lds
  s_mov_b32 m0, 3072
  s_mov_b32 s41, 622592
  buffer_load_dwordx4 v23, s[12:15], s41 offen nt lds
  v_xor_b32 v12, 0, v25
  v_add_u32 v12, 65536, v12
  ds_read_b64_tr_b16 a[8:9], v12 offset:0
  ds_read_b64_tr_b16 a[10:11], v12 offset:256
  ds_read_b64_tr_b16 a[12:13], v12 offset:8192
  ds_read_b64_tr_b16 a[14:15], v12 offset:8448
  v_xor_b32 v12, 32, v25
  v_add_u32 v12, 65536, v12
  ds_read_b64_tr_b16 a[72:73], v12 offset:0
  ds_read_b64_tr_b16 a[74:75], v12 offset:256
  ds_read_b64_tr_b16 a[76:77], v12 offset:8192
  ds_read_b64_tr_b16 a[78:79], v12 offset:8448
  s_waitcnt vmcnt(9) lgkmcnt(0)
  s_barrier
  s_mov_b32 m0, 65536
  s_mov_b32 s41, 2621440
  buffer_load_dwordx4 v22, s[12:15], s41 offen nt lds
  s_mov_b32 m0, 66560
  s_mov_b32 s41, 2654208
  buffer_load_dwordx4 v23, s[12:15], s41 offen nt lds
  s_mov_b32 m0, 67584
  s_mov_b32 s41, 2686976
  buffer_load_dwordx4 v22, s[12:15], s41 offen nt lds
  s_mov_b32 m0, 68608
  s_mov_b32 s41, 2719744
  buffer_load_dwordx4 v23, s[12:15], s41 offen nt lds
  v_xor_b32 v12, 0, v25
  v_add_u32 v12, 114688, v12
  ds_read_b64_tr_b16 a[16:17], v12 offset:0
  ds_read_b64_tr_b16 a[18:19], v12 offset:256
  ds_read_b64_tr_b16 a[20:21], v12 offset:8192
  ds_read_b64_tr_b16 a[22:23], v12 offset:8448
  v_xor_b32 v12, 32, v25
  v_add_u32 v12, 114688, v12
  ds_read_b64_tr_b16 a[80:81], v12 offset:0
  ds_read_b64_tr_b16 a[82:83], v12 offset:256
  ds_read_b64_tr_b16 a[84:85], v12 offset:8192
  ds_read_b64_tr_b16 a[86:87], v12 offset:8448
  s_waitcnt vmcnt(8) lgkmcnt(0)
  s_barrier
  s_mov_b32 m0, 114688
  s_mov_b32 s41, 786432
  buffer_load_dwordx4 v22, s[12:15], s41 offen nt lds
  s_mov_b32 m0, 115712
  s_mov_b32 s41, 819200
  buffer_load_dwordx4 v23, s[12:15], s41 offen nt lds
  s_mov_b32 m0, 116736
  s_mov_b32 s41, 851968
  buffer_load_dwordx4 v22, s[12:15], s41 offen nt lds
  s_mov_b32 m0, 117760
  s_mov_b32 s41, 884736
  buffer_load_dwordx4 v23, s[12:15], s41 offen nt lds
  v_xor_b32 v12, 0, v25
  v_add_u32 v12, 147456, v12
  ds_read_b64_tr_b16 a[24:25], v12 offset:0
  ds_read_b64_tr_b16 a[26:27], v12 offset:256
  ds_read_b64_tr_b16 a[28:29], v12 offset:8192
  ds_read_b64_tr_b16 a[30:31], v12 offset:8448
  v_xor_b32 v12, 32, v25
  v_add_u32 v12, 147456, v12
  ds_read_b64_tr_b16 a[88:89], v12 offset:0
  ds_read_b64_tr_b16 a[90:91], v12 offset:256
  ds_read_b64_tr_b16 a[92:93], v12 offset:8192
  ds_read_b64_tr_b16 a[94:95], v12 offset:8448
  s_waitcnt vmcnt(8) lgkmcnt(0)
  s_barrier
  s_mov_b32 m0, 147456
  s_mov_b32 s41, 2883584
  buffer_load_dwordx4 v22, s[12:15], s41 offen nt lds
  s_mov_b32 m0, 148480
  s_mov_b32 s41, 2916352
  buffer_load_dwordx4 v23, s[12:15], s41 offen nt lds
  s_mov_b32 m0, 149504
  s_mov_b32 s41, 2949120
  buffer_load_dwordx4 v22, s[12:15], s41 offen nt lds
  s_mov_b32 m0, 150528
  s_mov_b32 s41, 2981888
  buffer_load_dwordx4 v23, s[12:15], s41 offen nt lds
  v_xor_b32 v12, 0, v25
  v_add_u32 v12, 0, v12
  ds_read_b64_tr_b16 a[32:33], v12 offset:0
  ds_read_b64_tr_b16 a[34:35], v12 offset:256
  ds_read_b64_tr_b16 a[36:37], v12 offset:8192
  ds_read_b64_tr_b16 a[38:39], v12 offset:8448
  v_xor_b32 v12, 32, v25
  v_add_u32 v12, 0, v12
  ds_read_b64_tr_b16 a[96:97], v12 offset:0
  ds_read_b64_tr_b16 a[98:99], v12 offset:256
  ds_read_b64_tr_b16 a[100:101], v12 offset:8192
  ds_read_b64_tr_b16 a[102:103], v12 offset:8448
  s_waitcnt vmcnt(8) lgkmcnt(0)
  s_barrier
  s_mov_b32 m0, 0
  s_mov_b32 s41, 0
  buffer_load_dwordx4 v22, s[16:19], s41 offen nt lds
  s_mov_b32 m0, 1024
  s_mov_b32 s41, 32768
  buffer_load_dwordx4 v23, s[16:19], s41 offen nt lds
  s_mov_b32 m0, 2048
  s_mov_b32 s41, 65536
  buffer_load_dwordx4 v22, s[16:19], s41 offen nt lds
  s_mov_b32 m0, 3072
  s_mov_b32 s41, 98304
  buffer_load_dwordx4 v23, s[16:19], s41 offen nt lds
  v_xor_b32 v12, 0, v25
  v_add_u32 v12, 65536, v12
  ds_read_b64_tr_b16 a[40:41], v12 offset:0
  ds_read_b64_tr_b16 a[42:43], v12 offset:256
  ds_read_b64_tr_b16 a[44:45], v12 offset:8192
  ds_read_b64_tr_b16 a[46:47], v12 offset:8448
  v_xor_b32 v12, 32, v25
  v_add_u32 v12, 65536, v12
  ds_read_b64_tr_b16 a[104:105], v12 offset:0
  ds_read_b64_tr_b16 a[106:107], v12 offset:256
  ds_read_b64_tr_b16 a[108:109], v12 offset:8192
  ds_read_b64_tr_b16 a[110:111], v12 offset:8448
  s_waitcnt vmcnt(8) lgkmcnt(0)
  s_barrier
  s_mov_b32 m0, 65536
  s_mov_b32 s41, 2097152
  buffer_load_dwordx4 v22, s[16:19], s41 offen nt lds
  s_mov_b32 m0, 66560
  s_mov_b32 s41, 2129920
  buffer_load_dwordx4 v23, s[16:19], s41 offen nt lds
  s_mov_b32 m0, 67584
  s_mov_b32 s41, 2162688
  buffer_load_dwordx4 v22, s[16:19], s41 offen nt lds
  s_mov_b32 m0, 68608
  s_mov_b32 s41, 2195456
  buffer_load_dwordx4 v23, s[16:19], s41 offen nt lds
  v_xor_b32 v12, 0, v25
  v_add_u32 v12, 114688, v12
  ds_read_b64_tr_b16 a[48:49], v12 offset:0
  ds_read_b64_tr_b16 a[50:51], v12 offset:256
  ds_read_b64_tr_b16 a[52:53], v12 offset:8192
  ds_read_b64_tr_b16 a[54:55], v12 offset:8448
  v_xor_b32 v12, 32, v25
  v_add_u32 v12, 114688, v12
  ds_read_b64_tr_b16 a[112:113], v12 offset:0
  ds_read_b64_tr_b16 a[114:115], v12 offset:256
  ds_read_b64_tr_b16 a[116:117], v12 offset:8192
  ds_read_b64_tr_b16 a[118:119], v12 offset:8448
  s_waitcnt vmcnt(8) lgkmcnt(0)
  s_barrier
  s_mov_b32 m0, 114688
  s_mov_b32 s41, 262144
  buffer_load_dwordx4 v22, s[16:19], s41 offen nt lds
  s_mov_b32 m0, 115712
  s_mov_b32 s41, 294912
  buffer_load_dwordx4 v23, s[16:19], s41 offen nt lds
  s_mov_b32 m0, 116736
  s_mov_b32 s41, 327680
  buffer_load_dwordx4 v22, s[16:19], s41 offen nt lds
  s_mov_b32 m0, 117760
  s_mov_b32 s41, 360448
  buffer_load_dwordx4 v23, s[16:19], s41 offen nt lds
  v_xor_b32 v12, 0, v25
  v_add_u32 v12, 147456, v12
  ds_read_b64_tr_b16 a[56:57], v12 offset:0
  ds_read_b64_tr_b16 a[58:59], v12 offset:256
  ds_read_b64_tr_b16 a[60:61], v12 offset:8192
  ds_read_b64_tr_b16 a[62:63], v12 offset:8448
  v_xor_b32 v12, 32, v25
  v_add_u32 v12, 147456, v12
  ds_read_b64_tr_b16 a[120:121], v12 offset:0
  ds_read_b64_tr_b16 a[122:123], v12 offset:256
  ds_read_b64_tr_b16 a[124:125], v12 offset:8192
  ds_read_b64_tr_b16 a[126:127], v12 offset:8448
  s_waitcnt vmcnt(8) lgkmcnt(0)
  s_barrier
  s_mov_b32 m0, 147456
  s_mov_b32 s41, 2359296
  buffer_load_dwordx4 v22, s[16:19], s41 offen nt lds
  s_mov_b32 m0, 148480
  s_mov_b32 s41, 2392064
  buffer_load_dwordx4 v23, s[16:19], s41 offen nt lds
  s_mov_b32 m0, 149504
  s_mov_b32 s41, 2424832
  buffer_load_dwordx4 v22, s[16:19], s41 offen nt lds
  s_mov_b32 m0, 150528
  s_mov_b32 s41, 2457600
  buffer_load_dwordx4 v23, s[16:19], s41 offen nt lds
  v_xor_b32 v12, 0, v25
  v_add_u32 v12, 0, v12
  ds_read_b64_tr_b16 a[128:129], v12 offset:0
  ds_read_b64_tr_b16 a[130:131], v12 offset:256
  ds_read_b64_tr_b16 a[132:133], v12 offset:8192
  ds_read_b64_tr_b16 a[134:135], v12 offset:8448
  v_xor_b32 v12, 32, v25
  v_add_u32 v12, 0, v12
  ds_read_b64_tr_b16 a[192:193], v12 offset:0
  ds_read_b64_tr_b16 a[194:195], v12 offset:256
  ds_read_b64_tr_b16 a[196:197], v12 offset:8192
  ds_read_b64_tr_b16 a[198:199], v12 offset:8448
  s_waitcnt vmcnt(8) lgkmcnt(0)
  s_barrier
  s_mov_b32 m0, 0
  s_mov_b32 s41, 524288
  buffer_load_dwordx4 v22, s[16:19], s41 offen nt lds
  s_mov_b32 m0, 1024
  s_mov_b32 s41, 557056
  buffer_load_dwordx4 v23, s[16:19], s41 offen nt lds
  s_mov_b32 m0, 2048
  s_mov_b32 s41, 589824
  buffer_load_dwordx4 v22, s[16:19], s41 offen nt lds
  s_mov_b32 m0, 3072
  s_mov_b32 s41, 622592
  buffer_load_dwordx4 v23, s[16:19], s41 offen nt lds
  v_xor_b32 v12, 0, v25
  v_add_u32 v12, 65536, v12
  ds_read_b64_tr_b16 a[136:137], v12 offset:0
  ds_read_b64_tr_b16 a[138:139], v12 offset:256
  ds_read_b64_tr_b16 a[140:141], v12 offset:8192
  ds_read_b64_tr_b16 a[142:143], v12 offset:8448
  v_xor_b32 v12, 32, v25
  v_add_u32 v12, 65536, v12
  ds_read_b64_tr_b16 a[200:201], v12 offset:0
  ds_read_b64_tr_b16 a[202:203], v12 offset:256
  ds_read_b64_tr_b16 a[204:205], v12 offset:8192
  ds_read_b64_tr_b16 a[206:207], v12 offset:8448
  s_waitcnt vmcnt(8) lgkmcnt(0)
  s_barrier
  s_mov_b32 m0, 65536
  s_mov_b32 s41, 2621440
  buffer_load_dwordx4 v22, s[16:19], s41 offen nt lds
  s_mov_b32 m0, 66560
  s_mov_b32 s41, 2654208
  buffer_load_dwordx4 v23, s[16:19], s41 offen nt lds
  s_mov_b32 m0, 67584
  s_mov_b32 s41, 2686976
  buffer_load_dwordx4 v22, s[16:19], s41 offen nt lds
  s_mov_b32 m0, 68608
  s_mov_b32 s41, 2719744
  buffer_load_dwordx4 v23, s[16:19], s41 offen nt lds
  buffer_load_dwordx2 v[52:53], off, s[8:11], 0 sc1
  buffer_load_dword v54, off, s[8:11], 0 offset:16 sc1
  s_mov_b32 s40, 0
  v_xor_b32 v12, 0, v25
  v_add_u32 v12, 114688, v12
  ds_read_b64_tr_b16 a[144:145], v12 offset:0
  ds_read_b64_tr_b16 a[146:147], v12 offset:256
  ds_read_b64_tr_b16 a[148:149], v12 offset:8192
  ds_read_b64_tr_b16 a[150:151], v12 offset:8448
  v_xor_b32 v12, 32, v25
  v_add_u32 v12, 114688, v12
  ds_read_b64_tr_b16 a[208:209], v12 offset:0
  ds_read_b64_tr_b16 a[210:211], v12 offset:256
  ds_read_b64_tr_b16 a[212:213], v12 offset:8192
  ds_read_b64_tr_b16 a[214:215], v12 offset:8448
  s_waitcnt vmcnt(10) lgkmcnt(0)
  s_barrier
  s_mov_b32 m0, 114688
  s_mov_b32 s41, 786432
  buffer_load_dwordx4 v22, s[16:19], s41 offen nt lds
  s_mov_b32 m0, 115712
  s_mov_b32 s41, 819200
  buffer_load_dwordx4 v23, s[16:19], s41 offen nt lds
  s_mov_b32 m0, 116736
  s_mov_b32 s41, 851968
  buffer_load_dwordx4 v22, s[16:19], s41 offen nt lds
  s_mov_b32 m0, 117760
  s_mov_b32 s41, 884736
  buffer_load_dwordx4 v23, s[16:19], s41 offen nt lds
  v_xor_b32 v12, 0, v25
  v_add_u32 v12, 147456, v12
  ds_read_b64_tr_b16 a[152:153], v12 offset:0
  ds_read_b64_tr_b16 a[154:155], v12 offset:256
  ds_read_b64_tr_b16 a[156:157], v12 offset:8192
  ds_read_b64_tr_b16 a[158:159], v12 offset:8448
  v_xor_b32 v12, 32, v25
  v_add_u32 v12, 147456, v12
  ds_read_b64_tr_b16 a[216:217], v12 offset:0
  ds_read_b64_tr_b16 a[218:219], v12 offset:256
  ds_read_b64_tr_b16 a[220:221], v12 offset:8192
  ds_read_b64_tr_b16 a[222:223], v12 offset:8448
  s_waitcnt vmcnt(10) lgkmcnt(0)
  s_barrier
  s_mov_b32 m0, 147456
  s_mov_b32 s41, 2883584
  buffer_load_dwordx4 v22, s[16:19], s41 offen nt lds
  s_mov_b32 m0, 148480
  s_mov_b32 s41, 2916352
  buffer_load_dwordx4 v23, s[16:19], s41 offen nt lds
  s_mov_b32 m0, 149504
  s_mov_b32 s41, 2949120
  buffer_load_dwordx4 v22, s[16:19], s41 offen nt lds
  s_mov_b32 m0, 150528
  s_mov_b32 s41, 2981888
  buffer_load_dwordx4 v23, s[16:19], s41 offen nt lds
  v_xor_b32 v12, 0, v25
  v_add_u32 v12, 0, v12
  ds_read_b64_tr_b16 a[160:161], v12 offset:0
  ds_read_b64_tr_b16 a[162:163], v12 offset:256
  ds_read_b64_tr_b16 a[164:165], v12 offset:8192
  ds_read_b64_tr_b16 a[166:167], v12 offset:8448
  v_xor_b32 v12, 32, v25
  v_add_u32 v12, 0, v12
  ds_read_b64_tr_b16 a[224:225], v12 offset:0
  ds_read_b64_tr_b16 a[226:227], v12 offset:256
  ds_read_b64_tr_b16 a[228:229], v12 offset:8192
  ds_read_b64_tr_b16 a[230:231], v12 offset:8448
  s_waitcnt vmcnt(10) lgkmcnt(0)
  s_barrier
  s_mov_b32 m0, 0
  s_mov_b32 s41, 0
  buffer_load_dwordx4 v22, s[20:23], s41 offen nt lds
  s_mov_b32 m0, 1024
  s_mov_b32 s41, 32768
  buffer_load_dwordx4 v23, s[20:23], s41 offen nt lds
  s_mov_b32 m0, 2048
  s_mov_b32 s41, 65536
  buffer_load_dwordx4 v22, s[20:23], s41 offen nt lds
  s_mov_b32 m0, 3072
  s_mov_b32 s41, 98304
  buffer_load_dwordx4 v23, s[20:23], s41 offen nt lds
  v_xor_b32 v12, 0, v25
  v_add_u32 v12, 65536, v12
  ds_read_b64_tr_b16 a[168:169], v12 offset:0
  ds_read_b64_tr_b16 a[170:171], v12 offset:256
  ds_read_b64_tr_b16 a[172:173], v12 offset:8192
  ds_read_b64_tr_b16 a[174:175], v12 offset:8448
  v_xor_b32 v12, 32, v25
  v_add_u32 v12, 65536, v12
  ds_read_b64_tr_b16 a[232:233], v12 offset:0
  ds_read_b64_tr_b16 a[234:235], v12 offset:256
  ds_read_b64_tr_b16 a[236:237], v12 offset:8192
  ds_read_b64_tr_b16 a[238:239], v12 offset:8448
  s_waitcnt vmcnt(8) lgkmcnt(0)
  s_barrier
  s_mov_b32 m0, 65536
  s_mov_b32 s41, 2097152
  buffer_load_dwordx4 v22, s[20:23], s41 offen nt lds
  s_mov_b32 m0, 66560
  s_mov_b32 s41, 2129920
  buffer_load_dwordx4 v23, s[20:23], s41 offen nt lds
  s_mov_b32 m0, 67584
  s_mov_b32 s41, 2162688
  buffer_load_dwordx4 v22, s[20:23], s41 offen nt lds
  s_mov_b32 m0, 68608
  s_mov_b32 s41, 2195456
  buffer_load_dwordx4 v23, s[20:23], s41 offen nt lds
c_cen0:
  s_getreg_b32 s50, hwreg(HW_REG_XCC_ID, 0, 3)
  s_mul_i32 s50, s50, 6
  s_lshl_b64 s[56:57], 32, s50
  v_readfirstlane_b32 s58, v52
  v_readfirstlane_b32 s59, v53
  v_readfirstlane_b32 s50, v54
  s_cmp_eq_u64 s[56:57], s[58:59]
  s_cselect_b32 s96, 1, 0
  s_mov_b32 s41, 0
  s_and_b32 s42, s58, 63
  s_add_u32 s41, s41, s42
  s_lshr_b64 s[58:59], s[58:59], 6
  s_and_b32 s42, s58, 63
  s_add_u32 s41, s41, s42
  s_lshr_b64 s[58:59], s[58:59], 6
  s_and_b32 s42, s58, 63
  s_add_u32 s41, s41, s42
  s_lshr_b64 s[58:59], s[58:59], 6
  s_and_b32 s42, s58, 63
  s_add_u32 s41, s41, s42
  s_lshr_b64 s[58:59], s[58:59], 6
  s_and_b32 s42, s58, 63
  s_add_u32 s41, s41, s42
  s_lshr_b64 s[58:59], s[58:59], 6
  s_and_b32 s42, s58, 63
  s_add_u32 s41, s41, s42
  s_lshr_b64 s[58:59], s[58:59], 6
  s_and_b32 s42, s58, 63
  s_add_u32 s41, s41, s42
  s_lshr_b64 s[58:59], s[58:59], 6
  s_and_b32 s42, s58, 63
  s_add_u32 s41, s41, s42
  s_lshr_b64 s[58:59], s[58:59], 6
  s_mul_i32 s41, s41, s50
  s_cmp_lg_u32 s41, 32
  s_cbranch_scc1 c_cenw0
c_cend0:
  v_xor_b32 v12, 0, v25
  v_add_u32 v12, 114688, v12
  ds_read_b64_tr_b16 a[176:177], v12 offset:0
  ds_read_b64_tr_b16 a[178:179], v12 offset:256
  ds_read_b64_tr_b16 a[180:181], v12 offset:8192
  ds_read_b64_tr_b16 a[182:183], v12 offset:8448
  v_xor_b32 v12, 32, v25
  v_add_u32 v12, 114688, v12
  ds_read_b64_tr_b16 a[240:241], v12 offset:0
  ds_read_b64_tr_b16 a[242:243], v12 offset:256
  ds_read_b64_tr_b16 a[244:245], v12 offset:8192
  ds_read_b64_tr_b16 a[246:247], v12 offset:8448
  s_waitcnt vmcnt(8) lgkmcnt(0)
  s_barrier
  s_mov_b32 m0, 114688
  s_mov_b32 s41, 262144
  buffer_load_dwordx4 v22, s[20:23], s41 offen nt lds
  s_mov_b32 m0, 115712
  s_mov_b32 s41, 294912
  buffer_load_dwordx4 v23, s[20:23], s41 offen nt lds
  s_mov_b32 m0, 116736
  s_mov_b32 s41, 327680
  buffer_load_dwordx4 v22, s[20:23], s41 offen nt lds
  s_mov_b32 m0, 117760
  s_mov_b32 s41, 360448
  buffer_load_dwordx4 v23, s[20:23], s41 offen nt lds
  v_xor_b32 v12, 0, v25
  v_add_u32 v12, 147456, v12
  ds_read_b64_tr_b16 a[184:185], v12 offset:0
  ds_read_b64_tr_b16 a[186:187], v12 offset:256
  ds_read_b64_tr_b16 a[188:189], v12 offset:8192
  ds_read_b64_tr_b16 a[190:191], v12 offset:8448
  v_xor_b32 v12, 32, v25
  v_add_u32 v12, 147456, v12
  ds_read_b64_tr_b16 a[248:249], v12 offset:0
  ds_read_b64_tr_b16 a[250:251], v12 offset:256
  ds_read_b64_tr_b16 a[252:253], v12 offset:8192
  ds_read_b64_tr_b16 a[254:255], v12 offset:8448
  s_waitcnt vmcnt(8) lgkmcnt(0)
  s_barrier
  s_mov_b32 m0, 147456
  s_mov_b32 s41, 2359296
  buffer_load_dwordx4 v22, s[20:23], s41 offen nt lds
  s_mov_b32 m0, 148480
  s_mov_b32 s41, 2392064
  buffer_load_dwordx4 v23, s[20:23], s41 offen nt lds
  s_mov_b32 m0, 149504
  s_mov_b32 s41, 2424832
  buffer_load_dwordx4 v22, s[20:23], s41 offen nt lds
  s_mov_b32 m0, 150528
  s_mov_b32 s41, 2457600
  buffer_load_dwordx4 v23, s[20:23], s41 offen nt lds
  s_waitcnt vmcnt(8) lgkmcnt(0)
  s_barrier
  s_mov_b32 m0, 0
  s_mov_b32 s41, 524288
  buffer_load_dwordx4 v22, s[20:23], s41 offen nt lds
  s_mov_b32 m0, 1024
  s_mov_b32 s41, 557056
  buffer_load_dwordx4 v23, s[20:23], s41 offen nt lds
  s_mov_b32 m0, 2048
  s_mov_b32 s41, 589824
  buffer_load_dwordx4 v22, s[20:23], s41 offen nt lds
  s_mov_b32 m0, 3072
  s_mov_b32 s41, 622592
  buffer_load_dwordx4 v23, s[20:23], s41 offen nt lds
  s_waitcnt vmcnt(8) lgkmcnt(0)
  s_barrier
  s_mov_b32 m0, 65536
  s_mov_b32 s41, 2621440
  buffer_load_dwordx4 v22, s[20:23], s41 offen nt lds
  s_mov_b32 m0, 66560
  s_mov_b32 s41, 2654208
  buffer_load_dwordx4 v23, s[20:23], s41 offen nt lds
  s_mov_b32 m0, 67584
  s_mov_b32 s41, 2686976
  buffer_load_dwordx4 v22, s[20:23], s41 offen nt lds
  s_mov_b32 m0, 68608
  s_mov_b32 s41, 2719744
  buffer_load_dwordx4 v23, s[20:23], s41 offen nt lds
  s_waitcnt vmcnt(8) lgkmcnt(0)
  s_barrier
  s_mov_b32 m0, 114688
  s_mov_b32 s41, 786432
  buffer_load_dwordx4 v22, s[20:23], s41 offen nt lds
  s_mov_b32 m0, 115712
  s_mov_b32 s41, 819200
  buffer_load_dwordx4 v23, s[20:23], s41 offen nt lds
  s_mov_b32 m0, 116736
  s_mov_b32 s41, 851968
  buffer_load_dwordx4 v22, s[20:23], s41 offen nt lds
  s_mov_b32 m0, 117760
  s_mov_b32 s41, 884736
  buffer_load_dwordx4 v23, s[20:23], s41 offen nt lds
  s_add_u32 s41, s46, 4096
  s_add_u32 s42, s46, 16777216
  s_add_u32 s50, s46, 16781312
  s_mov_b32 m0, 16384
  s_nop 0
  buffer_load_dwordx4 v3, s[4:7], s46 offen offset:0 sc1 lds
  buffer_load_dwordx4 v3, s[4:7], s46 offen offset:1024 sc1 lds
  buffer_load_dwordx4 v3, s[4:7], s46 offen offset:2048 sc1 lds
  buffer_load_dwordx4 v3, s[4:7], s46 offen offset:3072 sc1 lds
  s_mov_b32 m0, 20480
  s_nop 0
  buffer_load_dwordx4 v3, s[4:7], s41 offen offset:0 sc1 lds
  buffer_load_dwordx4 v3, s[4:7], s41 offen offset:1024 sc1 lds
  buffer_load_dwordx4 v3, s[4:7], s41 offen offset:2048 sc1 lds
  buffer_load_dwordx4 v3, s[4:7], s41 offen offset:3072 sc1 lds
  s_mov_b32 m0, 24576
  s_nop 0
  buffer_load_dwordx4 v3, s[4:7], s42 offen offset:0 sc1 lds
  buffer_load_dwordx4 v3, s[4:7], s42 offen offset:1024 sc1 lds
  buffer_load_dwordx4 v3, s[4:7], s42 offen offset:2048 sc1 lds
  buffer_load_dwordx4 v3, s[4:7], s42 offen offset:3072 sc1 lds
  s_mov_b32 m0, 28672
  s_nop 0
  buffer_load_dwordx4 v3, s[4:7], s50 offen offset:0 sc1 lds
  buffer_load_dwordx4 v3, s[4:7], s50 offen offset:1024 sc1 lds
  buffer_load_dwordx4 v3, s[4:7], s50 offen offset:2048 sc1 lds
  buffer_load_dwordx4 v3, s[4:7], s50 offen offset:3072 sc1 lds
  s_waitcnt vmcnt(24) lgkmcnt(0)
  s_barrier
  s_mov_b32 m0, 147456
  s_mov_b32 s41, 2883584
  buffer_load_dwordx4 v22, s[20:23], s41 offen nt lds
  s_mov_b32 m0, 148480
  s_mov_b32 s41, 2916352
  buffer_load_dwordx4 v23, s[20:23], s41 offen nt lds
  s_mov_b32 m0, 149504
  s_mov_b32 s41, 2949120
  buffer_load_dwordx4 v22, s[20:23], s41 offen nt lds
  s_mov_b32 m0, 150528
  s_mov_b32 s41, 2981888
  buffer_load_dwordx4 v23, s[20:23], s41 offen nt lds
  s_waitcnt vmcnt(24) lgkmcnt(0)
  s_barrier
  v_lshrrev_b32 v55, 4, v0
  v_and_b32 v55, 1, v55
  v_lshlrev_b32 v55, 18, v55
  v_and_b32 v56, 15, v0
  v_lshl_add_u32 v55, v56, 7, v55
  s_lshl_b32 s41, s32, 13
  s_add_u32 s41, s41, 83886080
  v_and_b32 v56, 1, v0
  v_lshlrev_b32 v56, 7, v56
  s_lshl_b32 s42, s32, 8
  s_add_u32 s42, s42, 84934656
  buffer_load_dword v57, v55, s[4:7], s41 offen sc1
  buffer_load_dword v57, v56, s[4:7], s42 offen sc1
  s_waitcnt vmcnt(22) lgkmcnt(0)
  s_barrier
  s_waitcnt vmcnt(2) lgkmcnt(0)
  s_barrier
  s_waitcnt lgkmcnt(0)
  s_barrier
  v_lshrrev_b32 v16, 4, v0
  v_and_b32 v17, 15, v0
  v_lshrrev_b32 v18, 2, v0
  v_lshlrev_b32 v7, 4, v18
  v_and_b32 v18, 1, v0
  v_lshl_add_u32 v7, v18, 3, v7
  v_lshrrev_b32 v18, 3, v17
  v_and_b32 v19, 7, v0
  v_lshlrev_b32 v9, 9, v18
  v_lshl_add_u32 v9, v16, 7, v9
  v_lshl_add_u32 v9, v19, 4, v9
  v_add_u32 v11, -1, v18
  s_lshl_b32 s47, s32, 13
  s_add_u32 s47, s47, 83883008
  s_lshl_b32 s36, s32, 6
  s_add_u32 s36, s36, 84148224
  s_mov_b32 s35, 84934656
  s_mov_b32 s67, 0
  s_mov_b32 s68, 0
  s_add_u32 s46, s46, 0
  s_add_u32 s70, s70, 0
  s_mov_b32 m0, 16384
  s_waitcnt vmcnt(0) lgkmcnt(0)
  v_mov_b32 v12, 0x3f803f80
  v_mov_b32 v13, 0x3f803f80
  v_mov_b32 v14, 0x3f803f80
  v_mov_b32 v15, 0x3f803f80
  s_cmp_eq_u32 s96, 1
  s_cbranch_scc1 cf0_step
  s_branch cs0_step
c_cenw0:
  s_add_u32 s40, s40, 1
  s_cmp_gt_u32 s40, 131072
  s_cbranch_scc1 c_cend0
  buffer_load_dwordx2 v[52:53], off, s[8:11], 0 sc1
  buffer_load_dword v54, off, s[8:11], 0 offset:16 sc1
  s_waitcnt vmcnt(0)
  s_branch c_cen0
c_pro1:
  v_lshrrev_b32 v16, 4, v0
  v_bfe_u32 v17, v0, 1, 3
  v_and_b32 v18, 1, v0
  v_and_b32 v19, 1, v16
  v_lshlrev_b32 v19, 1, v19
  v_xor_b32 v19, v19, v17
  v_lshlrev_b32 v19, 5, v19
  v_lshl_add_u32 v19, v18, 4, v19
  v_lshl_add_u32 v20, v16, 10, v19
  s_lshl_b32 s41, s32, 17
  s_add_u32 s41, s41, 256
  v_xor_b32 v21, 128, v20
  v_add_u32 v20, s41, v20
  v_add_u32 v21, s41, v21
  s_mov_b32 m0, 4096
  s_mov_b32 s41, 0
  buffer_load_dwordx4 v20, s[24:27], s41 offen nt lds
  s_mov_b32 m0, 5120
  s_mov_b32 s41, 4096
  buffer_load_dwordx4 v20, s[24:27], s41 offen nt lds
  s_mov_b32 m0, 6144
  s_mov_b32 s41, 32768
  buffer_load_dwordx4 v21, s[24:27], s41 offen nt lds
  s_mov_b32 m0, 7168
  s_mov_b32 s41, 36864
  buffer_load_dwordx4 v21, s[24:27], s41 offen nt lds
  s_mov_b32 m0, 69632
  s_mov_b32 s41, 8192
  buffer_load_dwordx4 v20, s[24:27], s41 offen nt lds
  s_mov_b32 m0, 70656
  s_mov_b32 s41, 12288
  buffer_load_dwordx4 v20, s[24:27], s41 offen nt lds
  s_mov_b32 m0, 71680
  s_mov_b32 s41, 40960
  buffer_load_dwordx4 v21, s[24:27], s41 offen nt lds
  s_mov_b32 m0, 72704
  s_mov_b32 s41, 45056
  buffer_load_dwordx4 v21, s[24:27], s41 offen nt lds
  s_mov_b32 m0, 118784
  s_mov_b32 s41, 16384
  buffer_load_dwordx4 v20, s[24:27], s41 offen nt lds
  s_mov_b32 m0, 119808
  s_mov_b32 s41, 20480
  buffer_load_dwordx4 v20, s[24:27], s41 offen nt lds
  s_mov_b32 m0, 120832
  s_mov_b32 s41, 49152
  buffer_load_dwordx4 v21, s[24:27], s41 offen nt lds
  s_mov_b32 m0, 121856
  s_mov_b32 s41, 53248
  buffer_load_dwordx4 v21, s[24:27], s41 offen nt lds
  v_mov_b64 v[28:29], -1
  v_mov_b64 v[30:31], -1
  s_lshl_b32 s41, s32, 13
  s_add_u32 s41, s41, 83888128
  buffer_store_dwordx4 v[28:31], v3, s[4:7], s41 offen sc1
  buffer_store_dwordx4 v[28:31], v3, s[4:7], s41 offen offset:1024 sc1
  s_add_u32 s41, s41, 0x40000
  buffer_store_dwordx4 v[28:31], v3, s[4:7], s41 offen sc1
  buffer_store_dwordx4 v[28:31], v3, s[4:7], s41 offen offset:1024 sc1
  s_lshl_b32 s41, s32, 8
  s_add_u32 s41, s41, 84967424
  v_lshlrev_b32 v19, 2, v0
  buffer_store_dword v28, v19, s[4:7], s41 offen sc1
  s_bfe_u32 s41, s32, 0x20001
  s_lshl_b32 s38, s41, 6
  s_lshl_b32 s41, s41, 11
  s_lshr_b32 s42, s32, 3
  s_lshl_b32 s50, s42, 9
  s_add_u32 s38, s38, s50
  s_lshl_b32 s42, s42, 8
  s_add_u32 s41, s41, s42
  s_and_b32 s42, s32, 1
  s_lshl_b32 s50, s42, 8
  s_add_u32 s38, s38, s50
  s_lshl_b32 s42, s42, 4
  s_add_u32 s41, s41, s42
  v_lshrrev_b32 v19, 5, v0
  v_lshlrev_b32 v48, 10, v19
  v_and_b32 v19, 3, v0
  v_lshl_add_u32 v48, v19, 2, v48
  v_and_b32 v19, 1, v16
  v_lshl_add_u32 v48, v19, 1, v48
  buffer_load_ushort v49, v48, s[28:31], s41 offen offset:64
  buffer_load_ushort v50, v48, s[28:31], s41 offen offset:96
  s_lshl_b32 s37, s32, 13
  s_add_u32 s37, s37, 84150272
  s_add_u32 s39, s38, 85002240
  s_add_u32 s38, s38, 84936704
  s_lshl_b32 s46, s32, 13
  s_add_u32 s46, s46, 16777216
  s_add_u32 s70, s46, 16515072
  s_mov_b32 s34, 0
  s_lshl_b32 s71, s32, 7
  s_add_u32 s71, s71, 85200896
  v_lshrrev_b32 v19, 5, v0
  v_xor_b32 v19, 4, v19
  v_xor_b32 v19, v19, v17
  v_lshlrev_b32 v19, 5, v19
  v_lshl_add_u32 v19, v18, 4, v19
  v_lshl_add_u32 v22, v16, 13, v19
  s_lshl_b32 s41, s32, 8
  v_xor_b32 v23, 64, v22
  v_add_u32 v22, s41, v22
  v_add_u32 v23, s41, v23
  v_bfe_u32 v26, v0, 4, 1
  v_lshrrev_b32 v27, 5, v0
  v_bfe_u32 v12, v0, 2, 1
  v_bfe_u32 v13, v0, 3, 1
  v_and_b32 v14, 3, v0
  v_lshlrev_b32 v15, 3, v26
  v_lshl_add_u32 v15, v27, 2, v15
  v_add_u32 v15, v15, v13
  v_lshlrev_b32 v24, 8, v15
  v_lshl_add_u32 v24, v12, 5, v24
  v_lshl_add_u32 v24, v13, 6, v24
  v_lshl_add_u32 v24, v26, 7, v24
  v_lshl_add_u32 v24, v14, 3, v24
  v_lshlrev_b32 v15, 3, v27
  v_lshl_add_u32 v15, v26, 1, v15
  v_lshl_add_u32 v15, v12, 4, v15
  v_lshl_add_u32 v15, v13, 2, v15
  v_lshlrev_b32 v25, 8, v15
  v_lshl_add_u32 v25, v26, 5, v25
  v_lshl_add_u32 v25, v13, 6, v25
  v_lshl_add_u32 v25, v12, 7, v25
  v_lshl_add_u32 v25, v14, 3, v25
  v_lshrrev_b32 v16, 4, v0
  v_and_b32 v17, 15, v0
  v_bfe_u32 v18, v0, 1, 1
  v_mov_b32 v1, 0x88884444
  v_mov_b32 v19, 0xddddeeee
  v_cmp_eq_u32 vcc, 1, v18
  s_nop 1
  v_cndmask_b32 v1, v1, v19, vcc
  v_lshrrev_b32 v18, 2, v17
  v_bfe_u32 v19, v0, 1, 1
  v_lshlrev_b32 v2, 5, v19
  v_lshrrev_b32 v19, 1, v16
  v_lshl_add_u32 v2, v19, 4, v2
  v_and_b32 v19, 1, v0
  v_lshl_add_u32 v2, v19, 3, v2
  v_and_b32 v19, 1, v16
  v_lshl_add_u32 v2, v19, 2, v2
  v_lshlrev_b32 v5, 4, v17
  v_lshl_add_u32 v5, v16, 2, v5
  v_lshlrev_b32 v6, 1, v5
  v_and_b32 v19, 1, v0
  v_lshl_add_u32 v19, v18, 1, v19
  v_lshlrev_b32 v8, 4, v19
  v_lshl_add_u32 v8, v16, 7, v8
  v_and_b32 v19, 7, v0
  v_lshlrev_b32 v10, 3, v19
  v_lshrrev_b32 v19, 3, v0
  v_lshl_add_u32 v10, v19, 13, v10
  s_mov_b32 s43, 0x3e0293ee
  s_mov_b32 s44, 0x35800000
  s_mov_b32 s69, 0x14000000
  v_add_u32 v7, 32768, v3
  s_waitcnt vmcnt(15) lgkmcnt(0)
  s_barrier
  s_mov_b32 m0, 151552
  s_mov_b32 s41, 24576
  buffer_load_dwordx4 v20, s[24:27], s41 offen nt lds
  s_mov_b32 m0, 152576
  s_mov_b32 s41, 28672
  buffer_load_dwordx4 v20, s[24:27], s41 offen nt lds
  s_mov_b32 m0, 153600
  s_mov_b32 s41, 57344
  buffer_load_dwordx4 v21, s[24:27], s41 offen nt lds
  s_mov_b32 m0, 154624
  s_mov_b32 s41, 61440
  buffer_load_dwordx4 v21, s[24:27], s41 offen nt lds
  v_xor_b32 v12, 0, v24
  v_add_u32 v12, 4096, v12
  ds_read_b64_tr_b16 v[128:129], v12 offset:0
  ds_read_b64_tr_b16 v[130:131], v12 offset:512
  v_xor_b32 v12, 64, v24
  v_add_u32 v12, 4096, v12
  ds_read_b64_tr_b16 v[160:161], v12 offset:0
  ds_read_b64_tr_b16 v[162:163], v12 offset:512
  v_xor_b32 v12, 128, v24
  v_add_u32 v12, 4096, v12
  ds_read_b64_tr_b16 v[192:193], v12 offset:0
  ds_read_b64_tr_b16 v[194:195], v12 offset:512
  v_xor_b32 v12, 192, v24
  v_add_u32 v12, 4096, v12
  ds_read_b64_tr_b16 v[224:225], v12 offset:0
  ds_read_b64_tr_b16 v[226:227], v12 offset:512
  s_waitcnt vmcnt(15) lgkmcnt(0)
  s_barrier
  s_mov_b32 m0, 4096
  s_mov_b32 s41, 65536
  buffer_load_dwordx4 v20, s[24:27], s41 offen nt lds
  s_mov_b32 m0, 5120
  s_mov_b32 s41, 69632
  buffer_load_dwordx4 v20, s[24:27], s41 offen nt lds
  s_mov_b32 m0, 6144
  s_mov_b32 s41, 98304
  buffer_load_dwordx4 v21, s[24:27], s41 offen nt lds
  s_mov_b32 m0, 7168
  s_mov_b32 s41, 102400
  buffer_load_dwordx4 v21, s[24:27], s41 offen nt lds
  v_xor_b32 v12, 0, v24
  v_add_u32 v12, 69632, v12
  ds_read_b64_tr_b16 v[132:133], v12 offset:0
  ds_read_b64_tr_b16 v[134:135], v12 offset:512
  v_xor_b32 v12, 64, v24
  v_add_u32 v12, 69632, v12
  ds_read_b64_tr_b16 v[164:165], v12 offset:0
  ds_read_b64_tr_b16 v[166:167], v12 offset:512
  v_xor_b32 v12, 128, v24
  v_add_u32 v12, 69632, v12
  ds_read_b64_tr_b16 v[196:197], v12 offset:0
  ds_read_b64_tr_b16 v[198:199], v12 offset:512
  v_xor_b32 v12, 192, v24
  v_add_u32 v12, 69632, v12
  ds_read_b64_tr_b16 v[228:229], v12 offset:0
  ds_read_b64_tr_b16 v[230:231], v12 offset:512
  s_waitcnt vmcnt(15) lgkmcnt(0)
  s_barrier
  s_mov_b32 m0, 69632
  s_mov_b32 s41, 73728
  buffer_load_dwordx4 v20, s[24:27], s41 offen nt lds
  s_mov_b32 m0, 70656
  s_mov_b32 s41, 77824
  buffer_load_dwordx4 v20, s[24:27], s41 offen nt lds
  s_mov_b32 m0, 71680
  s_mov_b32 s41, 106496
  buffer_load_dwordx4 v21, s[24:27], s41 offen nt lds
  s_mov_b32 m0, 72704
  s_mov_b32 s41, 110592
  buffer_load_dwordx4 v21, s[24:27], s41 offen nt lds
  v_xor_b32 v12, 0, v24
  v_add_u32 v12, 118784, v12
  ds_read_b64_tr_b16 v[136:137], v12 offset:0
  ds_read_b64_tr_b16 v[138:139], v12 offset:512
  v_xor_b32 v12, 64, v24
  v_add_u32 v12, 118784, v12
  ds_read_b64_tr_b16 v[168:169], v12 offset:0
  ds_read_b64_tr_b16 v[170:171], v12 offset:512
  v_xor_b32 v12, 128, v24
  v_add_u32 v12, 118784, v12
  ds_read_b64_tr_b16 v[200:201], v12 offset:0
  ds_read_b64_tr_b16 v[202:203], v12 offset:512
  v_xor_b32 v12, 192, v24
  v_add_u32 v12, 118784, v12
  ds_read_b64_tr_b16 v[232:233], v12 offset:0
  ds_read_b64_tr_b16 v[234:235], v12 offset:512
  s_waitcnt vmcnt(8) lgkmcnt(0)
  s_barrier
  s_mov_b32 m0, 118784
  s_mov_b32 s41, 81920
  buffer_load_dwordx4 v20, s[24:27], s41 offen nt lds
  s_mov_b32 m0, 119808
  s_mov_b32 s41, 86016
  buffer_load_dwordx4 v20, s[24:27], s41 offen nt lds
  s_mov_b32 m0, 120832
  s_mov_b32 s41, 114688
  buffer_load_dwordx4 v21, s[24:27], s41 offen nt lds
  s_mov_b32 m0, 121856
  s_mov_b32 s41, 118784
  buffer_load_dwordx4 v21, s[24:27], s41 offen nt lds
  v_lshl_or_b32 v49, v50, 16, v49
  buffer_store_dword v49, v2, s[4:7], s38 offen sc1
  v_xor_b32 v12, 0, v24
  v_add_u32 v12, 151552, v12
  ds_read_b64_tr_b16 v[140:141], v12 offset:0
  ds_read_b64_tr_b16 v[142:143], v12 offset:512
  v_xor_b32 v12, 64, v24
  v_add_u32 v12, 151552, v12
  ds_read_b64_tr_b16 v[172:173], v12 offset:0
  ds_read_b64_tr_b16 v[174:175], v12 offset:512
  v_xor_b32 v12, 128, v24
  v_add_u32 v12, 151552, v12
  ds_read_b64_tr_b16 v[204:205], v12 offset:0
  ds_read_b64_tr_b16 v[206:207], v12 offset:512
  v_xor_b32 v12, 192, v24
  v_add_u32 v12, 151552, v12
  ds_read_b64_tr_b16 v[236:237], v12 offset:0
  ds_read_b64_tr_b16 v[238:239], v12 offset:512
  s_waitcnt vmcnt(9) lgkmcnt(0)
  s_barrier
  s_mov_b32 m0, 151552
  s_mov_b32 s41, 90112
  buffer_load_dwordx4 v20, s[24:27], s41 offen nt lds
  s_mov_b32 m0, 152576
  s_mov_b32 s41, 94208
  buffer_load_dwordx4 v20, s[24:27], s41 offen nt lds
  s_mov_b32 m0, 153600
  s_mov_b32 s41, 122880
  buffer_load_dwordx4 v21, s[24:27], s41 offen nt lds
  s_mov_b32 m0, 154624
  s_mov_b32 s41, 126976
  buffer_load_dwordx4 v21, s[24:27], s41 offen nt lds
  v_xor_b32 v12, 0, v24
  v_add_u32 v12, 4096, v12
  ds_read_b64_tr_b16 v[144:145], v12 offset:0
  ds_read_b64_tr_b16 v[146:147], v12 offset:512
  v_xor_b32 v12, 64, v24
  v_add_u32 v12, 4096, v12
  ds_read_b64_tr_b16 v[176:177], v12 offset:0
  ds_read_b64_tr_b16 v[178:179], v12 offset:512
  v_xor_b32 v12, 128, v24
  v_add_u32 v12, 4096, v12
  ds_read_b64_tr_b16 v[208:209], v12 offset:0
  ds_read_b64_tr_b16 v[210:211], v12 offset:512
  v_xor_b32 v12, 192, v24
  v_add_u32 v12, 4096, v12
  ds_read_b64_tr_b16 v[240:241], v12 offset:0
  ds_read_b64_tr_b16 v[242:243], v12 offset:512
  s_waitcnt vmcnt(9) lgkmcnt(0)
  s_barrier
  s_mov_b32 m0, 4096
  s_mov_b32 s41, 131072
  buffer_load_dwordx4 v22, s[12:15], s41 offen nt lds
  s_mov_b32 m0, 5120
  s_mov_b32 s41, 163840
  buffer_load_dwordx4 v23, s[12:15], s41 offen nt lds
  s_mov_b32 m0, 6144
  s_mov_b32 s41, 196608
  buffer_load_dwordx4 v22, s[12:15], s41 offen nt lds
  s_mov_b32 m0, 7168
  s_mov_b32 s41, 229376
  buffer_load_dwordx4 v23, s[12:15], s41 offen nt lds
  v_xor_b32 v12, 0, v24
  v_add_u32 v12, 69632, v12
  ds_read_b64_tr_b16 v[148:149], v12 offset:0
  ds_read_b64_tr_b16 v[150:151], v12 offset:512
  v_xor_b32 v12, 64, v24
  v_add_u32 v12, 69632, v12
  ds_read_b64_tr_b16 v[180:181], v12 offset:0
  ds_read_b64_tr_b16 v[182:183], v12 offset:512
  v_xor_b32 v12, 128, v24
  v_add_u32 v12, 69632, v12
  ds_read_b64_tr_b16 v[212:213], v12 offset:0
  ds_read_b64_tr_b16 v[214:215], v12 offset:512
  v_xor_b32 v12, 192, v24
  v_add_u32 v12, 69632, v12
  ds_read_b64_tr_b16 v[244:245], v12 offset:0
  ds_read_b64_tr_b16 v[246:247], v12 offset:512
  s_waitcnt vmcnt(9) lgkmcnt(0)
  s_barrier
  s_mov_b32 m0, 69632
  s_mov_b32 s41, 2228224
  buffer_load_dwordx4 v22, s[12:15], s41 offen nt lds
  s_mov_b32 m0, 70656
  s_mov_b32 s41, 2260992
  buffer_load_dwordx4 v23, s[12:15], s41 offen nt lds
  s_mov_b32 m0, 71680
  s_mov_b32 s41, 2293760
  buffer_load_dwordx4 v22, s[12:15], s41 offen nt lds
  s_mov_b32 m0, 72704
  s_mov_b32 s41, 2326528
  buffer_load_dwordx4 v23, s[12:15], s41 offen nt lds
  v_xor_b32 v12, 0, v24
  v_add_u32 v12, 118784, v12
  ds_read_b64_tr_b16 v[152:153], v12 offset:0
  ds_read_b64_tr_b16 v[154:155], v12 offset:512
  v_xor_b32 v12, 64, v24
  v_add_u32 v12, 118784, v12
  ds_read_b64_tr_b16 v[184:185], v12 offset:0
  ds_read_b64_tr_b16 v[186:187], v12 offset:512
  v_xor_b32 v12, 128, v24
  v_add_u32 v12, 118784, v12
  ds_read_b64_tr_b16 v[216:217], v12 offset:0
  ds_read_b64_tr_b16 v[218:219], v12 offset:512
  v_xor_b32 v12, 192, v24
  v_add_u32 v12, 118784, v12
  ds_read_b64_tr_b16 v[248:249], v12 offset:0
  ds_read_b64_tr_b16 v[250:251], v12 offset:512
  s_waitcnt vmcnt(8) lgkmcnt(0)
  s_barrier
  s_mov_b32 m0, 118784
  s_mov_b32 s41, 393216
  buffer_load_dwordx4 v22, s[12:15], s41 offen nt lds
  s_mov_b32 m0, 119808
  s_mov_b32 s41, 425984
  buffer_load_dwordx4 v23, s[12:15], s41 offen nt lds
  s_mov_b32 m0, 120832
  s_mov_b32 s41, 458752
  buffer_load_dwordx4 v22, s[12:15], s41 offen nt lds
  s_mov_b32 m0, 121856
  s_mov_b32 s41, 491520
  buffer_load_dwordx4 v23, s[12:15], s41 offen nt lds
  v_xor_b32 v12, 0, v24
  v_add_u32 v12, 151552, v12
  ds_read_b64_tr_b16 v[156:157], v12 offset:0
  ds_read_b64_tr_b16 v[158:159], v12 offset:512
  v_xor_b32 v12, 64, v24
  v_add_u32 v12, 151552, v12
  ds_read_b64_tr_b16 v[188:189], v12 offset:0
  ds_read_b64_tr_b16 v[190:191], v12 offset:512
  v_xor_b32 v12, 128, v24
  v_add_u32 v12, 151552, v12
  ds_read_b64_tr_b16 v[220:221], v12 offset:0
  ds_read_b64_tr_b16 v[222:223], v12 offset:512
  v_xor_b32 v12, 192, v24
  v_add_u32 v12, 151552, v12
  ds_read_b64_tr_b16 v[252:253], v12 offset:0
  ds_read_b64_tr_b16 v[254:255], v12 offset:512
  s_waitcnt vmcnt(8) lgkmcnt(0)
  s_barrier
  s_mov_b32 m0, 151552
  s_mov_b32 s41, 2490368
  buffer_load_dwordx4 v22, s[12:15], s41 offen nt lds
  s_mov_b32 m0, 152576
  s_mov_b32 s41, 2523136
  buffer_load_dwordx4 v23, s[12:15], s41 offen nt lds
  s_mov_b32 m0, 153600
  s_mov_b32 s41, 2555904
  buffer_load_dwordx4 v22, s[12:15], s41 offen nt lds
  s_mov_b32 m0, 154624
  s_mov_b32 s41, 2588672
  buffer_load_dwordx4 v23, s[12:15], s41 offen nt lds
  v_xor_b32 v12, 64, v25
  v_add_u32 v12, 0, v12
  ds_read_b64_tr_b16 a[0:1], v12 offset:0
  ds_read_b64_tr_b16 a[2:3], v12 offset:256
  ds_read_b64_tr_b16 a[4:5], v12 offset:8192
  ds_read_b64_tr_b16 a[6:7], v12 offset:8448
  v_xor_b32 v12, 96, v25
  v_add_u32 v12, 0, v12
  ds_read_b64_tr_b16 a[64:65], v12 offset:0
  ds_read_b64_tr_b16 a[66:67], v12 offset:256
  ds_read_b64_tr_b16 a[68:69], v12 offset:8192
  ds_read_b64_tr_b16 a[70:71], v12 offset:8448
  s_waitcnt vmcnt(8) lgkmcnt(0)
  s_barrier
  s_mov_b32 m0, 4096
  s_mov_b32 s41, 655360
  buffer_load_dwordx4 v22, s[12:15], s41 offen nt lds
  s_mov_b32 m0, 5120
  s_mov_b32 s41, 688128
  buffer_load_dwordx4 v23, s[12:15], s41 offen nt lds
  s_mov_b32 m0, 6144
  s_mov_b32 s41, 720896
  buffer_load_dwordx4 v22, s[12:15], s41 offen nt lds
  s_mov_b32 m0, 7168
  s_mov_b32 s41, 753664
  buffer_load_dwordx4 v23, s[12:15], s41 offen nt lds
  v_xor_b32 v12, 64, v25
  v_add_u32 v12, 65536, v12
  ds_read_b64_tr_b16 a[8:9], v12 offset:0
  ds_read_b64_tr_b16 a[10:11], v12 offset:256
  ds_read_b64_tr_b16 a[12:13], v12 offset:8192
  ds_read_b64_tr_b16 a[14:15], v12 offset:8448
  v_xor_b32 v12, 96, v25
  v_add_u32 v12, 65536, v12
  ds_read_b64_tr_b16 a[72:73], v12 offset:0
  ds_read_b64_tr_b16 a[74:75], v12 offset:256
  ds_read_b64_tr_b16 a[76:77], v12 offset:8192
  ds_read_b64_tr_b16 a[78:79], v12 offset:8448
  s_waitcnt vmcnt(8) lgkmcnt(0)
  s_barrier
  s_mov_b32 m0, 69632
  s_mov_b32 s41, 2752512
  buffer_load_dwordx4 v22, s[12:15], s41 offen nt lds
  s_mov_b32 m0, 70656
  s_mov_b32 s41, 2785280
  buffer_load_dwordx4 v23, s[12:15], s41 offen nt lds
  s_mov_b32 m0, 71680
  s_mov_b32 s41, 2818048
  buffer_load_dwordx4 v22, s[12:15], s41 offen nt lds
  s_mov_b32 m0, 72704
  s_mov_b32 s41, 2850816
  buffer_load_dwordx4 v23, s[12:15], s41 offen nt lds
  v_xor_b32 v12, 64, v25
  v_add_u32 v12, 114688, v12
  ds_read_b64_tr_b16 a[16:17], v12 offset:0
  ds_read_b64_tr_b16 a[18:19], v12 offset:256
  ds_read_b64_tr_b16 a[20:21], v12 offset:8192
  ds_read_b64_tr_b16 a[22:23], v12 offset:8448
  v_xor_b32 v12, 96, v25
  v_add_u32 v12, 114688, v12
  ds_read_b64_tr_b16 a[80:81], v12 offset:0
  ds_read_b64_tr_b16 a[82:83], v12 offset:256
  ds_read_b64_tr_b16 a[84:85], v12 offset:8192
  ds_read_b64_tr_b16 a[86:87], v12 offset:8448
  s_waitcnt vmcnt(8) lgkmcnt(0)
  s_barrier
  s_mov_b32 m0, 118784
  s_mov_b32 s41, 917504
  buffer_load_dwordx4 v22, s[12:15], s41 offen nt lds
  s_mov_b32 m0, 119808
  s_mov_b32 s41, 950272
  buffer_load_dwordx4 v23, s[12:15], s41 offen nt lds
  s_mov_b32 m0, 120832
  s_mov_b32 s41, 983040
  buffer_load_dwordx4 v22, s[12:15], s41 offen nt lds
  s_mov_b32 m0, 121856
  s_mov_b32 s41, 1015808
  buffer_load_dwordx4 v23, s[12:15], s41 offen nt lds
  v_xor_b32 v12, 64, v25
  v_add_u32 v12, 147456, v12
  ds_read_b64_tr_b16 a[24:25], v12 offset:0
  ds_read_b64_tr_b16 a[26:27], v12 offset:256
  ds_read_b64_tr_b16 a[28:29], v12 offset:8192
  ds_read_b64_tr_b16 a[30:31], v12 offset:8448
  v_xor_b32 v12, 96, v25
  v_add_u32 v12, 147456, v12
  ds_read_b64_tr_b16 a[88:89], v12 offset:0
  ds_read_b64_tr_b16 a[90:91], v12 offset:256
  ds_read_b64_tr_b16 a[92:93], v12 offset:8192
  ds_read_b64_tr_b16 a[94:95], v12 offset:8448
  s_waitcnt vmcnt(8) lgkmcnt(0)
  s_barrier
  s_mov_b32 m0, 151552
  s_mov_b32 s41, 3014656
  buffer_load_dwordx4 v22, s[12:15], s41 offen nt lds
  s_mov_b32 m0, 152576
  s_mov_b32 s41, 3047424
  buffer_load_dwordx4 v23, s[12:15], s41 offen nt lds
  s_mov_b32 m0, 153600
  s_mov_b32 s41, 3080192
  buffer_load_dwordx4 v22, s[12:15], s41 offen nt lds
  s_mov_b32 m0, 154624
  s_mov_b32 s41, 3112960
  buffer_load_dwordx4 v23, s[12:15], s41 offen nt lds
  v_xor_b32 v12, 64, v25
  v_add_u32 v12, 0, v12
  ds_read_b64_tr_b16 a[32:33], v12 offset:0
  ds_read_b64_tr_b16 a[34:35], v12 offset:256
  ds_read_b64_tr_b16 a[36:37], v12 offset:8192
  ds_read_b64_tr_b16 a[38:39], v12 offset:8448
  v_xor_b32 v12, 96, v25
  v_add_u32 v12, 0, v12
  ds_read_b64_tr_b16 a[96:97], v12 offset:0
  ds_read_b64_tr_b16 a[98:99], v12 offset:256
  ds_read_b64_tr_b16 a[100:101], v12 offset:8192
  ds_read_b64_tr_b16 a[102:103], v12 offset:8448
  s_waitcnt vmcnt(8) lgkmcnt(0)
  s_barrier
  s_mov_b32 m0, 4096
  s_mov_b32 s41, 131072
  buffer_load_dwordx4 v22, s[16:19], s41 offen nt lds
  s_mov_b32 m0, 5120
  s_mov_b32 s41, 163840
  buffer_load_dwordx4 v23, s[16:19], s41 offen nt lds
  s_mov_b32 m0, 6144
  s_mov_b32 s41, 196608
  buffer_load_dwordx4 v22, s[16:19], s41 offen nt lds
  s_mov_b32 m0, 7168
  s_mov_b32 s41, 229376
  buffer_load_dwordx4 v23, s[16:19], s41 offen nt lds
  v_xor_b32 v12, 64, v25
  v_add_u32 v12, 65536, v12
  ds_read_b64_tr_b16 a[40:41], v12 offset:0
  ds_read_b64_tr_b16 a[42:43], v12 offset:256
  ds_read_b64_tr_b16 a[44:45], v12 offset:8192
  ds_read_b64_tr_b16 a[46:47], v12 offset:8448
  v_xor_b32 v12, 96, v25
  v_add_u32 v12, 65536, v12
  ds_read_b64_tr_b16 a[104:105], v12 offset:0
  ds_read_b64_tr_b16 a[106:107], v12 offset:256
  ds_read_b64_tr_b16 a[108:109], v12 offset:8192
  ds_read_b64_tr_b16 a[110:111], v12 offset:8448
  s_waitcnt vmcnt(8) lgkmcnt(0)
  s_barrier
  s_mov_b32 m0, 69632
  s_mov_b32 s41, 2228224
  buffer_load_dwordx4 v22, s[16:19], s41 offen nt lds
  s_mov_b32 m0, 70656
  s_mov_b32 s41, 2260992
  buffer_load_dwordx4 v23, s[16:19], s41 offen nt lds
  s_mov_b32 m0, 71680
  s_mov_b32 s41, 2293760
  buffer_load_dwordx4 v22, s[16:19], s41 offen nt lds
  s_mov_b32 m0, 72704
  s_mov_b32 s41, 2326528
  buffer_load_dwordx4 v23, s[16:19], s41 offen nt lds
  v_xor_b32 v12, 64, v25
  v_add_u32 v12, 114688, v12
  ds_read_b64_tr_b16 a[48:49], v12 offset:0
  ds_read_b64_tr_b16 a[50:51], v12 offset:256
  ds_read_b64_tr_b16 a[52:53], v12 offset:8192
  ds_read_b64_tr_b16 a[54:55], v12 offset:8448
  v_xor_b32 v12, 96, v25
  v_add_u32 v12, 114688, v12
  ds_read_b64_tr_b16 a[112:113], v12 offset:0
  ds_read_b64_tr_b16 a[114:115], v12 offset:256
  ds_read_b64_tr_b16 a[116:117], v12 offset:8192
  ds_read_b64_tr_b16 a[118:119], v12 offset:8448
  s_waitcnt vmcnt(8) lgkmcnt(0)
  s_barrier
  s_mov_b32 m0, 118784
  s_mov_b32 s41, 393216
  buffer_load_dwordx4 v22, s[16:19], s41 offen nt lds
  s_mov_b32 m0, 119808
  s_mov_b32 s41, 425984
  buffer_load_dwordx4 v23, s[16:19], s41 offen nt lds
  s_mov_b32 m0, 120832
  s_mov_b32 s41, 458752
  buffer_load_dwordx4 v22, s[16:19], s41 offen nt lds
  s_mov_b32 m0, 121856
  s_mov_b32 s41, 491520
  buffer_load_dwordx4 v23, s[16:19], s41 offen nt lds
  v_xor_b32 v12, 64, v25
  v_add_u32 v12, 147456, v12
  ds_read_b64_tr_b16 a[56:57], v12 offset:0
  ds_read_b64_tr_b16 a[58:59], v12 offset:256
  ds_read_b64_tr_b16 a[60:61], v12 offset:8192
  ds_read_b64_tr_b16 a[62:63], v12 offset:8448
  v_xor_b32 v12, 96, v25
  v_add_u32 v12, 147456, v12
  ds_read_b64_tr_b16 a[120:121], v12 offset:0
  ds_read_b64_tr_b16 a[122:123], v12 offset:256
  ds_read_b64_tr_b16 a[124:125], v12 offset:8192
  ds_read_b64_tr_b16 a[126:127], v12 offset:8448
  s_waitcnt vmcnt(8) lgkmcnt(0)
  s_barrier
  s_mov_b32 m0, 151552
  s_mov_b32 s41, 2490368
  buffer_load_dwordx4 v22, s[16:19], s41 offen nt lds
  s_mov_b32 m0, 152576
  s_mov_b32 s41, 2523136
  buffer_load_dwordx4 v23, s[16:19], s41 offen nt lds
  s_mov_b32 m0, 153600
  s_mov_b32 s41, 2555904
  buffer_load_dwordx4 v22, s[16:19], s41 offen nt lds
  s_mov_b32 m0, 154624
  s_mov_b32 s41, 2588672
  buffer_load_dwordx4 v23, s[16:19], s41 offen nt lds
  v_xor_b32 v12, 64, v25
  v_add_u32 v12, 0, v12
  ds_read_b64_tr_b16 a[128:129], v12 offset:0
  ds_read_b64_tr_b16 a[130:131], v12 offset:256
  ds_read_b64_tr_b16 a[132:133], v12 offset:8192
  ds_read_b64_tr_b16 a[134:135], v12 offset:8448
  v_xor_b32 v12, 96, v25
  v_add_u32 v12, 0, v12
  ds_read_b64_tr_b16 a[192:193], v12 offset:0
  ds_read_b64_tr_b16 a[194:195], v12 offset:256
  ds_read_b64_tr_b16 a[196:197], v12 offset:8192
  ds_read_b64_tr_b16 a[198:199], v12 offset:8448
  s_waitcnt vmcnt(8) lgkmcnt(0)
  s_barrier
  s_mov_b32 m0, 4096
  s_mov_b32 s41, 655360
  buffer_load_dwordx4 v22, s[16:19], s41 offen nt lds
  s_mov_b32 m0, 5120
  s_mov_b32 s41, 688128
  buffer_load_dwordx4 v23, s[16:19], s41 offen nt lds
  s_mov_b32 m0, 6144
  s_mov_b32 s41, 720896
  buffer_load_dwordx4 v22, s[16:19], s41 offen nt lds
  s_mov_b32 m0, 7168
  s_mov_b32 s41, 753664
  buffer_load_dwordx4 v23, s[16:19], s41 offen nt lds
  v_xor_b32 v12, 64, v25
  v_add_u32 v12, 65536, v12
  ds_read_b64_tr_b16 a[136:137], v12 offset:0
  ds_read_b64_tr_b16 a[138:139], v12 offset:256
  ds_read_b64_tr_b16 a[140:141], v12 offset:8192
  ds_read_b64_tr_b16 a[142:143], v12 offset:8448
  v_xor_b32 v12, 96, v25
  v_add_u32 v12, 65536, v12
  ds_read_b64_tr_b16 a[200:201], v12 offset:0
  ds_read_b64_tr_b16 a[202:203], v12 offset:256
  ds_read_b64_tr_b16 a[204:205], v12 offset:8192
  ds_read_b64_tr_b16 a[206:207], v12 offset:8448
  s_waitcnt vmcnt(8) lgkmcnt(0)
  s_barrier
  s_mov_b32 m0, 69632
  s_mov_b32 s41, 2752512
  buffer_load_dwordx4 v22, s[16:19], s41 offen nt lds
  s_mov_b32 m0, 70656
  s_mov_b32 s41, 2785280
  buffer_load_dwordx4 v23, s[16:19], s41 offen nt lds
  s_mov_b32 m0, 71680
  s_mov_b32 s41, 2818048
  buffer_load_dwordx4 v22, s[16:19], s41 offen nt lds
  s_mov_b32 m0, 72704
  s_mov_b32 s41, 2850816
  buffer_load_dwordx4 v23, s[16:19], s41 offen nt lds
  buffer_load_dwordx2 v[52:53], off, s[8:11], 0 sc1
  buffer_load_dword v54, off, s[8:11], 0 offset:16 sc1
  s_mov_b32 s40, 0
  v_xor_b32 v12, 64, v25
  v_add_u32 v12, 114688, v12
  ds_read_b64_tr_b16 a[144:145], v12 offset:0
  ds_read_b64_tr_b16 a[146:147], v12 offset:256
  ds_read_b64_tr_b16 a[148:149], v12 offset:8192
  ds_read_b64_tr_b16 a[150:151], v12 offset:8448
  v_xor_b32 v12, 96, v25
  v_add_u32 v12, 114688, v12
  ds_read_b64_tr_b16 a[208:209], v12 offset:0
  ds_read_b64_tr_b16 a[210:211], v12 offset:256
  ds_read_b64_tr_b16 a[212:213], v12 offset:8192
  ds_read_b64_tr_b16 a[214:215], v12 offset:8448
  s_waitcnt vmcnt(10) lgkmcnt(0)
  s_barrier
  s_mov_b32 m0, 118784
  s_mov_b32 s41, 917504
  buffer_load_dwordx4 v22, s[16:19], s41 offen nt lds
  s_mov_b32 m0, 119808
  s_mov_b32 s41, 950272
  buffer_load_dwordx4 v23, s[16:19], s41 offen nt lds
  s_mov_b32 m0, 120832
  s_mov_b32 s41, 983040
  buffer_load_dwordx4 v22, s[16:19], s41 offen nt lds
  s_mov_b32 m0, 121856
  s_mov_b32 s41, 1015808
  buffer_load_dwordx4 v23, s[16:19], s41 offen nt lds
  v_xor_b32 v12, 64, v25
  v_add_u32 v12, 147456, v12
  ds_read_b64_tr_b16 a[152:153], v12 offset:0
  ds_read_b64_tr_b16 a[154:155], v12 offset:256
  ds_read_b64_tr_b16 a[156:157], v12 offset:8192
  ds_read_b64_tr_b16 a[158:159], v12 offset:8448
  v_xor_b32 v12, 96, v25
  v_add_u32 v12, 147456, v12
  ds_read_b64_tr_b16 a[216:217], v12 offset:0
  ds_read_b64_tr_b16 a[218:219], v12 offset:256
  ds_read_b64_tr_b16 a[220:221], v12 offset:8192
  ds_read_b64_tr_b16 a[222:223], v12 offset:8448
  s_waitcnt vmcnt(10) lgkmcnt(0)
  s_barrier
  s_mov_b32 m0, 151552
  s_mov_b32 s41, 3014656
  buffer_load_dwordx4 v22, s[16:19], s41 offen nt lds
  s_mov_b32 m0, 152576
  s_mov_b32 s41, 3047424
  buffer_load_dwordx4 v23, s[16:19], s41 offen nt lds
  s_mov_b32 m0, 153600
  s_mov_b32 s41, 3080192
  buffer_load_dwordx4 v22, s[16:19], s41 offen nt lds
  s_mov_b32 m0, 154624
  s_mov_b32 s41, 3112960
  buffer_load_dwordx4 v23, s[16:19], s41 offen nt lds
  v_xor_b32 v12, 64, v25
  v_add_u32 v12, 0, v12
  ds_read_b64_tr_b16 a[160:161], v12 offset:0
  ds_read_b64_tr_b16 a[162:163], v12 offset:256
  ds_read_b64_tr_b16 a[164:165], v12 offset:8192
  ds_read_b64_tr_b16 a[166:167], v12 offset:8448
  v_xor_b32 v12, 96, v25
  v_add_u32 v12, 0, v12
  ds_read_b64_tr_b16 a[224:225], v12 offset:0
  ds_read_b64_tr_b16 a[226:227], v12 offset:256
  ds_read_b64_tr_b16 a[228:229], v12 offset:8192
  ds_read_b64_tr_b16 a[230:231], v12 offset:8448
  s_waitcnt vmcnt(10) lgkmcnt(0)
  s_barrier
  s_mov_b32 m0, 4096
  s_mov_b32 s41, 131072
  buffer_load_dwordx4 v22, s[20:23], s41 offen nt lds
  s_mov_b32 m0, 5120
  s_mov_b32 s41, 163840
  buffer_load_dwordx4 v23, s[20:23], s41 offen nt lds
  s_mov_b32 m0, 6144
  s_mov_b32 s41, 196608
  buffer_load_dwordx4 v22, s[20:23], s41 offen nt lds
  s_mov_b32 m0, 7168
  s_mov_b32 s41, 229376
  buffer_load_dwordx4 v23, s[20:23], s41 offen nt lds
  v_xor_b32 v12, 64, v25
  v_add_u32 v12, 65536, v12
  ds_read_b64_tr_b16 a[168:169], v12 offset:0
  ds_read_b64_tr_b16 a[170:171], v12 offset:256
  ds_read_b64_tr_b16 a[172:173], v12 offset:8192
  ds_read_b64_tr_b16 a[174:175], v12 offset:8448
  v_xor_b32 v12, 96, v25
  v_add_u32 v12, 65536, v12
  ds_read_b64_tr_b16 a[232:233], v12 offset:0
  ds_read_b64_tr_b16 a[234:235], v12 offset:256
  ds_read_b64_tr_b16 a[236:237], v12 offset:8192
  ds_read_b64_tr_b16 a[238:239], v12 offset:8448
  s_waitcnt vmcnt(8) lgkmcnt(0)
  s_barrier
  s_mov_b32 m0, 69632
  s_mov_b32 s41, 2228224
  buffer_load_dwordx4 v22, s[20:23], s41 offen nt lds
  s_mov_b32 m0, 70656
  s_mov_b32 s41, 2260992
  buffer_load_dwordx4 v23, s[20:23], s41 offen nt lds
  s_mov_b32 m0, 71680
  s_mov_b32 s41, 2293760
  buffer_load_dwordx4 v22, s[20:23], s41 offen nt lds
  s_mov_b32 m0, 72704
  s_mov_b32 s41, 2326528
  buffer_load_dwordx4 v23, s[20:23], s41 offen nt lds
c_cen1:
  s_getreg_b32 s50, hwreg(HW_REG_XCC_ID, 0, 3)
  s_mul_i32 s50, s50, 6
  s_lshl_b64 s[56:57], 32, s50
  v_readfirstlane_b32 s58, v52
  v_readfirstlane_b32 s59, v53
  v_readfirstlane_b32 s50, v54
  s_cmp_eq_u64 s[56:57], s[58:59]
  s_cselect_b32 s96, 1, 0
  s_mov_b32 s41, 0
  s_and_b32 s42, s58, 63
  s_add_u32 s41, s41, s42
  s_lshr_b64 s[58:59], s[58:59], 6
  s_and_b32 s42, s58, 63
  s_add_u32 s41, s41, s42
  s_lshr_b64 s[58:59], s[58:59], 6
  s_and_b32 s42, s58, 63
  s_add_u32 s41, s41, s42
  s_lshr_b64 s[58:59], s[58:59], 6
  s_and_b32 s42, s58, 63
  s_add_u32 s41, s41, s42
  s_lshr_b64 s[58:59], s[58:59], 6
  s_and_b32 s42, s58, 63
  s_add_u32 s41, s41, s42
  s_lshr_b64 s[58:59], s[58:59], 6
  s_and_b32 s42, s58, 63
  s_add_u32 s41, s41, s42
  s_lshr_b64 s[58:59], s[58:59], 6
  s_and_b32 s42, s58, 63
  s_add_u32 s41, s41, s42
  s_lshr_b64 s[58:59], s[58:59], 6
  s_and_b32 s42, s58, 63
  s_add_u32 s41, s41, s42
  s_lshr_b64 s[58:59], s[58:59], 6
  s_mul_i32 s41, s41, s50
  s_cmp_lg_u32 s41, 32
  s_cbranch_scc1 c_cenw1
c_cend1:
  v_and_b32 v9, 1, v0
  v_lshlrev_b32 v9, 6, v9
  v_bfe_u32 v11, v0, 1, 1
  v_lshl_add_u32 v9, v11, 12, v9
  buffer_load_dword v11, v9, s[4:7], s71 offen sc1
  v_xor_b32 v12, 64, v25
  v_add_u32 v12, 114688, v12
  ds_read_b64_tr_b16 a[176:177], v12 offset:0
  ds_read_b64_tr_b16 a[178:179], v12 offset:256
  ds_read_b64_tr_b16 a[180:181], v12 offset:8192
  ds_read_b64_tr_b16 a[182:183], v12 offset:8448
  v_xor_b32 v12, 96, v25
  v_add_u32 v12, 114688, v12
  ds_read_b64_tr_b16 a[240:241], v12 offset:0
  ds_read_b64_tr_b16 a[242:243], v12 offset:256
  ds_read_b64_tr_b16 a[244:245], v12 offset:8192
  ds_read_b64_tr_b16 a[246:247], v12 offset:8448
  s_waitcnt vmcnt(9) lgkmcnt(0)
  s_barrier
  s_mov_b32 m0, 118784
  s_mov_b32 s41, 393216
  buffer_load_dwordx4 v22, s[20:23], s41 offen nt lds
  s_mov_b32 m0, 119808
  s_mov_b32 s41, 425984
  buffer_load_dwordx4 v23, s[20:23], s41 offen nt lds
  s_mov_b32 m0, 120832
  s_mov_b32 s41, 458752
  buffer_load_dwordx4 v22, s[20:23], s41 offen nt lds
  s_mov_b32 m0, 121856
  s_mov_b32 s41, 491520
  buffer_load_dwordx4 v23, s[20:23], s41 offen nt lds
  v_xor_b32 v12, 64, v25
  v_add_u32 v12, 147456, v12
  ds_read_b64_tr_b16 a[184:185], v12 offset:0
  ds_read_b64_tr_b16 a[186:187], v12 offset:256
  ds_read_b64_tr_b16 a[188:189], v12 offset:8192
  ds_read_b64_tr_b16 a[190:191], v12 offset:8448
  v_xor_b32 v12, 96, v25
  v_add_u32 v12, 147456, v12
  ds_read_b64_tr_b16 a[248:249], v12 offset:0
  ds_read_b64_tr_b16 a[250:251], v12 offset:256
  ds_read_b64_tr_b16 a[252:253], v12 offset:8192
  ds_read_b64_tr_b16 a[254:255], v12 offset:8448
  s_waitcnt vmcnt(9) lgkmcnt(0)
  s_barrier
  s_mov_b32 m0, 151552
  s_mov_b32 s41, 2490368
  buffer_load_dwordx4 v22, s[20:23], s41 offen nt lds
  s_mov_b32 m0, 152576
  s_mov_b32 s41, 2523136
  buffer_load_dwordx4 v23, s[20:23], s41 offen nt lds
  s_mov_b32 m0, 153600
  s_mov_b32 s41, 2555904
  buffer_load_dwordx4 v22, s[20:23], s41 offen nt lds
  s_mov_b32 m0, 154624
  s_mov_b32 s41, 2588672
  buffer_load_dwordx4 v23, s[20:23], s41 offen nt lds
  v_xor_b32 v12, 0, v25
  v_add_u32 v12, 0, v12
  ds_read_b64_tr_b16 v[32:33], v12 offset:0
  ds_read_b64_tr_b16 v[34:35], v12 offset:256
  ds_read_b64_tr_b16 v[36:37], v12 offset:8192
  ds_read_b64_tr_b16 v[38:39], v12 offset:8448
  v_xor_b32 v12, 32, v25
  v_add_u32 v12, 0, v12
  ds_read_b64_tr_b16 v[64:65], v12 offset:0
  ds_read_b64_tr_b16 v[66:67], v12 offset:256
  ds_read_b64_tr_b16 v[68:69], v12 offset:8192
  ds_read_b64_tr_b16 v[70:71], v12 offset:8448
  v_xor_b32 v12, 192, v25
  v_add_u32 v12, 0, v12
  ds_read_b64_tr_b16 v[40:41], v12 offset:0
  ds_read_b64_tr_b16 v[42:43], v12 offset:256
  ds_read_b64_tr_b16 v[44:45], v12 offset:8192
  ds_read_b64_tr_b16 v[46:47], v12 offset:8448
  s_waitcnt lgkmcnt(0)
  ds_write_b128 v7, v[32:35] offset:0
  ds_write_b128 v7, v[36:39] offset:1024
  ds_write_b128 v7, v[40:43] offset:16384
  ds_write_b128 v7, v[44:47] offset:17408
  s_waitcnt vmcnt(9) lgkmcnt(0)
  s_barrier
  s_mov_b32 m0, 4096
  s_mov_b32 s41, 655360
  buffer_load_dwordx4 v22, s[20:23], s41 offen nt lds
  s_mov_b32 m0, 5120
  s_mov_b32 s41, 688128
  buffer_load_dwordx4 v23, s[20:23], s41 offen nt lds
  s_mov_b32 m0, 6144
  s_mov_b32 s41, 720896
  buffer_load_dwordx4 v22, s[20:23], s41 offen nt lds
  s_mov_b32 m0, 7168
  s_mov_b32 s41, 753664
  buffer_load_dwordx4 v23, s[20:23], s41 offen nt lds
  v_xor_b32 v12, 0, v25
  v_add_u32 v12, 65536, v12
  ds_read_b64_tr_b16 v[32:33], v12 offset:0
  ds_read_b64_tr_b16 v[34:35], v12 offset:256
  ds_read_b64_tr_b16 v[36:37], v12 offset:8192
  ds_read_b64_tr_b16 v[38:39], v12 offset:8448
  v_xor_b32 v12, 32, v25
  v_add_u32 v12, 65536, v12
  ds_read_b64_tr_b16 v[72:73], v12 offset:0
  ds_read_b64_tr_b16 v[74:75], v12 offset:256
  ds_read_b64_tr_b16 v[76:77], v12 offset:8192
  ds_read_b64_tr_b16 v[78:79], v12 offset:8448
  v_xor_b32 v12, 192, v25
  v_add_u32 v12, 65536, v12
  ds_read_b64_tr_b16 v[40:41], v12 offset:0
  ds_read_b64_tr_b16 v[42:43], v12 offset:256
  ds_read_b64_tr_b16 v[44:45], v12 offset:8192
  ds_read_b64_tr_b16 v[46:47], v12 offset:8448
  s_waitcnt lgkmcnt(0)
  ds_write_b128 v7, v[32:35] offset:2048
  ds_write_b128 v7, v[36:39] offset:3072
  ds_write_b128 v7, v[40:43] offset:18432
  ds_write_b128 v7, v[44:47] offset:19456
  s_waitcnt vmcnt(8) lgkmcnt(0)
  s_barrier
  s_mov_b32 m0, 69632
  s_mov_b32 s41, 2752512
  buffer_load_dwordx4 v22, s[20:23], s41 offen nt lds
  s_mov_b32 m0, 70656
  s_mov_b32 s41, 2785280
  buffer_load_dwordx4 v23, s[20:23], s41 offen nt lds
  s_mov_b32 m0, 71680
  s_mov_b32 s41, 2818048
  buffer_load_dwordx4 v22, s[20:23], s41 offen nt lds
  s_mov_b32 m0, 72704
  s_mov_b32 s41, 2850816
  buffer_load_dwordx4 v23, s[20:23], s41 offen nt lds
  s_branch c_p1w
c_p1d:
  v_xor_b32 v12, 0, v25
  v_add_u32 v12, 114688, v12
  ds_read_b64_tr_b16 v[32:33], v12 offset:0
  ds_read_b64_tr_b16 v[34:35], v12 offset:256
  ds_read_b64_tr_b16 v[36:37], v12 offset:8192
  ds_read_b64_tr_b16 v[38:39], v12 offset:8448
  v_xor_b32 v12, 32, v25
  v_add_u32 v12, 114688, v12
  ds_read_b64_tr_b16 v[80:81], v12 offset:0
  ds_read_b64_tr_b16 v[82:83], v12 offset:256
  ds_read_b64_tr_b16 v[84:85], v12 offset:8192
  ds_read_b64_tr_b16 v[86:87], v12 offset:8448
  v_xor_b32 v12, 192, v25
  v_add_u32 v12, 114688, v12
  ds_read_b64_tr_b16 v[40:41], v12 offset:0
  ds_read_b64_tr_b16 v[42:43], v12 offset:256
  ds_read_b64_tr_b16 v[44:45], v12 offset:8192
  ds_read_b64_tr_b16 v[46:47], v12 offset:8448
  s_waitcnt lgkmcnt(0)
  ds_write_b128 v7, v[32:35] offset:4096
  ds_write_b128 v7, v[36:39] offset:5120
  ds_write_b128 v7, v[40:43] offset:20480
  ds_write_b128 v7, v[44:47] offset:21504
  s_waitcnt vmcnt(8) lgkmcnt(0)
  s_barrier
  s_mov_b32 m0, 118784
  s_mov_b32 s41, 917504
  buffer_load_dwordx4 v22, s[20:23], s41 offen nt lds
  s_mov_b32 m0, 119808
  s_mov_b32 s41, 950272
  buffer_load_dwordx4 v23, s[20:23], s41 offen nt lds
  s_mov_b32 m0, 120832
  s_mov_b32 s41, 983040
  buffer_load_dwordx4 v22, s[20:23], s41 offen nt lds
  s_mov_b32 m0, 121856
  s_mov_b32 s41, 1015808
  buffer_load_dwordx4 v23, s[20:23], s41 offen nt lds
  v_xor_b32 v12, 0, v25
  v_add_u32 v12, 147456, v12
  ds_read_b64_tr_b16 v[32:33], v12 offset:0
  ds_read_b64_tr_b16 v[34:35], v12 offset:256
  ds_read_b64_tr_b16 v[36:37], v12 offset:8192
  ds_read_b64_tr_b16 v[38:39], v12 offset:8448
  v_xor_b32 v12, 32, v25
  v_add_u32 v12, 147456, v12
  ds_read_b64_tr_b16 v[88:89], v12 offset:0
  ds_read_b64_tr_b16 v[90:91], v12 offset:256
  ds_read_b64_tr_b16 v[92:93], v12 offset:8192
  ds_read_b64_tr_b16 v[94:95], v12 offset:8448
  v_xor_b32 v12, 192, v25
  v_add_u32 v12, 147456, v12
  ds_read_b64_tr_b16 v[40:41], v12 offset:0
  ds_read_b64_tr_b16 v[42:43], v12 offset:256
  ds_read_b64_tr_b16 v[44:45], v12 offset:8192
  ds_read_b64_tr_b16 v[46:47], v12 offset:8448
  s_waitcnt lgkmcnt(0)
  ds_write_b128 v7, v[32:35] offset:6144
  ds_write_b128 v7, v[36:39] offset:7168
  ds_write_b128 v7, v[40:43] offset:22528
  ds_write_b128 v7, v[44:47] offset:23552
  s_waitcnt vmcnt(8) lgkmcnt(0)
  s_barrier
  s_mov_b32 m0, 151552
  s_mov_b32 s41, 3014656
  buffer_load_dwordx4 v22, s[20:23], s41 offen nt lds
  s_mov_b32 m0, 152576
  s_mov_b32 s41, 3047424
  buffer_load_dwordx4 v23, s[20:23], s41 offen nt lds
  s_mov_b32 m0, 153600
  s_mov_b32 s41, 3080192
  buffer_load_dwordx4 v22, s[20:23], s41 offen nt lds
  s_mov_b32 m0, 154624
  s_mov_b32 s41, 3112960
  buffer_load_dwordx4 v23, s[20:23], s41 offen nt lds
  v_xor_b32 v12, 0, v25
  v_add_u32 v12, 0, v12
  ds_read_b64_tr_b16 v[32:33], v12 offset:0
  ds_read_b64_tr_b16 v[34:35], v12 offset:256
  ds_read_b64_tr_b16 v[36:37], v12 offset:8192
  ds_read_b64_tr_b16 v[38:39], v12 offset:8448
  v_xor_b32 v12, 32, v25
  v_add_u32 v12, 0, v12
  ds_read_b64_tr_b16 v[96:97], v12 offset:0
  ds_read_b64_tr_b16 v[98:99], v12 offset:256
  ds_read_b64_tr_b16 v[100:101], v12 offset:8192
  ds_read_b64_tr_b16 v[102:103], v12 offset:8448
  v_xor_b32 v12, 192, v25
  v_add_u32 v12, 0, v12
  ds_read_b64_tr_b16 v[40:41], v12 offset:0
  ds_read_b64_tr_b16 v[42:43], v12 offset:256
  ds_read_b64_tr_b16 v[44:45], v12 offset:8192
  ds_read_b64_tr_b16 v[46:47], v12 offset:8448
  s_waitcnt lgkmcnt(0)
  ds_write_b128 v7, v[32:35] offset:8192
  ds_write_b128 v7, v[36:39] offset:9216
  ds_write_b128 v7, v[40:43] offset:24576
  ds_write_b128 v7, v[44:47] offset:25600
  s_waitcnt vmcnt(8) lgkmcnt(0)
  s_barrier
  v_lshrrev_b32 v55, 4, v0
  v_and_b32 v55, 1, v55
  v_lshlrev_b32 v55, 18, v55
  v_and_b32 v56, 15, v0
  v_lshl_add_u32 v55, v56, 7, v55
  s_lshl_b32 s41, s32, 13
  s_add_u32 s41, s41, 83888128
  v_and_b32 v56, 1, v0
  v_lshlrev_b32 v56, 7, v56
  s_lshl_b32 s42, s32, 8
  s_add_u32 s42, s42, 84967424
  buffer_load_dword v57, v55, s[4:7], s41 offen sc1
  buffer_load_dword v57, v56, s[4:7], s42 offen sc1
  v_xor_b32 v12, 0, v25
  v_add_u32 v12, 65536, v12
  ds_read_b64_tr_b16 v[32:33], v12 offset:0
  ds_read_b64_tr_b16 v[34:35], v12 offset:256
  ds_read_b64_tr_b16 v[36:37], v12 offset:8192
  ds_read_b64_tr_b16 v[38:39], v12 offset:8448
  v_xor_b32 v12, 32, v25
  v_add_u32 v12, 65536, v12
  ds_read_b64_tr_b16 v[104:105], v12 offset:0
  ds_read_b64_tr_b16 v[106:107], v12 offset:256
  ds_read_b64_tr_b16 v[108:109], v12 offset:8192
  ds_read_b64_tr_b16 v[110:111], v12 offset:8448
  v_xor_b32 v12, 192, v25
  v_add_u32 v12, 65536, v12
  ds_read_b64_tr_b16 v[40:41], v12 offset:0
  ds_read_b64_tr_b16 v[42:43], v12 offset:256
  ds_read_b64_tr_b16 v[44:45], v12 offset:8192
  ds_read_b64_tr_b16 v[46:47], v12 offset:8448
  s_waitcnt lgkmcnt(0)
  ds_write_b128 v7, v[32:35] offset:10240
  ds_write_b128 v7, v[36:39] offset:11264
  ds_write_b128 v7, v[40:43] offset:26624
  ds_write_b128 v7, v[44:47] offset:27648
  s_waitcnt vmcnt(6) lgkmcnt(0)
  s_barrier
  v_xor_b32 v12, 0, v25
  v_add_u32 v12, 114688, v12
  ds_read_b64_tr_b16 v[32:33], v12 offset:0
  ds_read_b64_tr_b16 v[34:35], v12 offset:256
  ds_read_b64_tr_b16 v[36:37], v12 offset:8192
  ds_read_b64_tr_b16 v[38:39], v12 offset:8448
  v_xor_b32 v12, 32, v25
  v_add_u32 v12, 114688, v12
  ds_read_b64_tr_b16 v[112:113], v12 offset:0
  ds_read_b64_tr_b16 v[114:115], v12 offset:256
  ds_read_b64_tr_b16 v[116:117], v12 offset:8192
  ds_read_b64_tr_b16 v[118:119], v12 offset:8448
  v_xor_b32 v12, 192, v25
  v_add_u32 v12, 114688, v12
  ds_read_b64_tr_b16 v[40:41], v12 offset:0
  ds_read_b64_tr_b16 v[42:43], v12 offset:256
  ds_read_b64_tr_b16 v[44:45], v12 offset:8192
  ds_read_b64_tr_b16 v[46:47], v12 offset:8448
  s_waitcnt lgkmcnt(0)
  ds_write_b128 v7, v[32:35] offset:12288
  ds_write_b128 v7, v[36:39] offset:13312
  ds_write_b128 v7, v[40:43] offset:28672
  ds_write_b128 v7, v[44:47] offset:29696
  s_waitcnt vmcnt(2) lgkmcnt(0)
  s_barrier
  v_xor_b32 v12, 0, v25
  v_add_u32 v12, 147456, v12
  ds_read_b64_tr_b16 v[32:33], v12 offset:0
  ds_read_b64_tr_b16 v[34:35], v12 offset:256
  ds_read_b64_tr_b16 v[36:37], v12 offset:8192
  ds_read_b64_tr_b16 v[38:39], v12 offset:8448
  v_xor_b32 v12, 32, v25
  v_add_u32 v12, 147456, v12
  ds_read_b64_tr_b16 v[120:121], v12 offset:0
  ds_read_b64_tr_b16 v[122:123], v12 offset:256
  ds_read_b64_tr_b16 v[124:125], v12 offset:8192
  ds_read_b64_tr_b16 v[126:127], v12 offset:8448
  v_xor_b32 v12, 192, v25
  v_add_u32 v12, 147456, v12
  ds_read_b64_tr_b16 v[40:41], v12 offset:0
  ds_read_b64_tr_b16 v[42:43], v12 offset:256
  ds_read_b64_tr_b16 v[44:45], v12 offset:8192
  ds_read_b64_tr_b16 v[46:47], v12 offset:8448
  s_waitcnt lgkmcnt(0)
  ds_write_b128 v7, v[32:35] offset:14336
  ds_write_b128 v7, v[36:39] offset:15360
  ds_write_b128 v7, v[40:43] offset:30720
  ds_write_b128 v7, v[44:47] offset:31744
  s_waitcnt lgkmcnt(0)
  s_barrier
  ds_write_b128 v7, v[192:195] offset:32768
  ds_write_b128 v7, v[196:199] offset:33792
  ds_write_b128 v7, v[200:203] offset:34816
  ds_write_b128 v7, v[204:207] offset:35840
  ds_write_b128 v7, v[208:211] offset:36864
  ds_write_b128 v7, v[212:215] offset:37888
  ds_write_b128 v7, v[216:219] offset:38912
  ds_write_b128 v7, v[220:223] offset:39936
  ds_write_b128 v7, v[224:227] offset:40960
  ds_write_b128 v7, v[228:231] offset:41984
  ds_write_b128 v7, v[232:235] offset:43008
  ds_write_b128 v7, v[236:239] offset:44032
  ds_write_b128 v7, v[240:243] offset:45056
  ds_write_b128 v7, v[244:247] offset:46080
  ds_write_b128 v7, v[248:251] offset:47104
  ds_write_b128 v7, v[252:255] offset:48128
  v_lshrrev_b32 v16, 4, v0
  v_and_b32 v17, 15, v0
  v_bfe_u32 v18, v0, 2, 1
  v_and_b32 v19, 3, v0
  v_bfe_u32 v21, v0, 1, 1
  v_lshl_add_u32 v19, v18, 1, v19
  v_lshl_add_u32 v19, v21, 3, v19
  v_bfe_u32 v20, v0, 3, 1
  v_lshlrev_b32 v20, 4, v20
  v_mov_b32 v21, 0x3f80
  v_lshlrev_b32 v20, v20, v21
  v_cmp_eq_u32 vcc, 0, v19
  s_nop 1
  v_cndmask_b32 v28, 0, v20, vcc
  v_cmp_eq_u32 vcc, 1, v19
  s_nop 1
  v_cndmask_b32 v29, 0, v20, vcc
  v_cmp_eq_u32 vcc, 2, v19
  s_nop 1
  v_cndmask_b32 v30, 0, v20, vcc
  v_cmp_eq_u32 vcc, 3, v19
  s_nop 1
  v_cndmask_b32 v31, 0, v20, vcc
  ds_write_b32 v3, v28 offset:10244
  ds_write_b32 v3, v29 offset:10252
  ds_write_b32 v3, v30 offset:11268
  ds_write_b32 v3, v31 offset:11276
  v_lshrrev_b32 v18, 3, v17
  v_and_b32 v19, 7, v0
  v_lshlrev_b32 v4, 9, v18
  v_lshl_add_u32 v4, v16, 7, v4
  v_lshl_add_u32 v4, v19, 4, v4
  s_lshl_b32 s45, s32, 11
  s_add_u32 s45, s45, 79626240
  s_lshl_b32 s47, s32, 13
  s_add_u32 s47, s47, 83886080
  s_lshl_b32 s36, s32, 6
  s_add_u32 s36, s36, 84213760
  s_mov_b32 s35, 84936704
  s_mov_b32 s67, 0
  s_mov_b32 s68, 0
  s_add_u32 s46, s46, 4096
  s_add_u32 s70, s70, 4096
  s_mov_b32 m0, 20480
  s_waitcnt vmcnt(0) lgkmcnt(0)
  ds_read_b128 v[192:195], v7 offset:0
  ds_read_b128 v[196:199], v7 offset:1024
  ds_read_b128 v[200:203], v7 offset:2048
  ds_read_b128 v[204:207], v7 offset:3072
  ds_read_b128 v[208:211], v7 offset:4096
  ds_read_b128 v[212:215], v7 offset:5120
  ds_read_b128 v[216:219], v7 offset:6144
  ds_read_b128 v[220:223], v7 offset:7168
  ds_read_b128 v[224:227], v7 offset:8192
  ds_read_b128 v[228:231], v7 offset:9216
  ds_read_b128 v[232:235], v7 offset:10240
  ds_read_b128 v[236:239], v7 offset:11264
  ds_read_b128 v[240:243], v7 offset:12288
  ds_read_b128 v[244:247], v7 offset:13312
  ds_read_b128 v[248:251], v7 offset:14336
  ds_read_b128 v[252:255], v7 offset:15360
  s_cmp_eq_u32 s96, 1
  s_cbranch_scc1 cf1_step
  s_branch cs1_step
c_cenw1:
  s_add_u32 s40, s40, 1
  s_cmp_gt_u32 s40, 131072
  s_cbranch_scc1 c_cend1
  buffer_load_dwordx2 v[52:53], off, s[8:11], 0 sc1
  buffer_load_dword v54, off, s[8:11], 0 offset:16 sc1
  s_waitcnt vmcnt(0)
  s_branch c_cen1
c_p1w:
  s_mov_b32 s51, 0
L_p1w_1:
  v_readlane_b32 s41, v11, 0
  v_readlane_b32 s42, v11, 1
  v_readlane_b32 s50, v11, 2
  v_readlane_b32 s48, v11, 3
  s_min_u32 s41, s41, s50
  s_min_u32 s42, s42, s48
  s_lshl_b32 s41, s41, 2
  s_lshl_b32 s42, s42, 2
  s_add_u32 s42, s42, 2
  s_min_u32 s48, s41, s42
  s_max_u32 s48, s48, 1
  s_sub_u32 s48, s48, 1
  s_cmp_eq_u32 s48, 63
  s_cselect_b32 s48, 64, s48
  s_cmp_lt_u32 s34, s48
  s_cbranch_scc1 c_p1d
  s_cmp_gt_u32 s51, 131072
  s_cbranch_scc1 c_p1d
  s_add_u32 s51, s51, 1
  buffer_load_dword v11, v9, s[4:7], s71 offen sc1
  s_waitcnt vmcnt(0)
  s_branch L_p1w_1
c_pro2:
  v_lshrrev_b32 v16, 4, v0
  v_bfe_u32 v17, v0, 1, 3
  v_and_b32 v18, 1, v0
  v_and_b32 v19, 1, v16
  v_lshlrev_b32 v19, 1, v19
  v_xor_b32 v19, v19, v17
  v_lshlrev_b32 v19, 5, v19
  v_lshl_add_u32 v19, v18, 4, v19
  v_lshl_add_u32 v20, v16, 10, v19
  s_lshl_b32 s41, s32, 17
  s_add_u32 s41, s41, 512
  v_xor_b32 v21, 128, v20
  v_add_u32 v20, s41, v20
  v_add_u32 v21, s41, v21
  s_mov_b32 m0, 8192
  s_mov_b32 s41, 0
  buffer_load_dwordx4 v20, s[24:27], s41 offen nt lds
  s_mov_b32 m0, 9216
  s_mov_b32 s41, 4096
  buffer_load_dwordx4 v20, s[24:27], s41 offen nt lds
  s_mov_b32 m0, 10240
  s_mov_b32 s41, 32768
  buffer_load_dwordx4 v21, s[24:27], s41 offen nt lds
  s_mov_b32 m0, 11264
  s_mov_b32 s41, 36864
  buffer_load_dwordx4 v21, s[24:27], s41 offen nt lds
  s_mov_b32 m0, 73728
  s_mov_b32 s41, 8192
  buffer_load_dwordx4 v20, s[24:27], s41 offen nt lds
  s_mov_b32 m0, 74752
  s_mov_b32 s41, 12288
  buffer_load_dwordx4 v20, s[24:27], s41 offen nt lds
  s_mov_b32 m0, 75776
  s_mov_b32 s41, 40960
  buffer_load_dwordx4 v21, s[24:27], s41 offen nt lds
  s_mov_b32 m0, 76800
  s_mov_b32 s41, 45056
  buffer_load_dwordx4 v21, s[24:27], s41 offen nt lds
  s_mov_b32 m0, 122880
  s_mov_b32 s41, 16384
  buffer_load_dwordx4 v20, s[24:27], s41 offen nt lds
  s_mov_b32 m0, 123904
  s_mov_b32 s41, 20480
  buffer_load_dwordx4 v20, s[24:27], s41 offen nt lds
  s_mov_b32 m0, 124928
  s_mov_b32 s41, 49152
  buffer_load_dwordx4 v21, s[24:27], s41 offen nt lds
  s_mov_b32 m0, 125952
  s_mov_b32 s41, 53248
  buffer_load_dwordx4 v21, s[24:27], s41 offen nt lds
  v_mov_b64 v[28:29], -1
  v_mov_b64 v[30:31], -1
  s_lshl_b32 s41, s32, 13
  s_add_u32 s41, s41, 83890176
  buffer_store_dwordx4 v[28:31], v3, s[4:7], s41 offen sc1
  buffer_store_dwordx4 v[28:31], v3, s[4:7], s41 offen offset:1024 sc1
  s_add_u32 s41, s41, 0x40000
  buffer_store_dwordx4 v[28:31], v3, s[4:7], s41 offen sc1
  buffer_store_dwordx4 v[28:31], v3, s[4:7], s41 offen offset:1024 sc1
  s_lshl_b32 s41, s32, 8
  s_add_u32 s41, s41, 85000192
  v_lshlrev_b32 v19, 2, v0
  buffer_store_dword v28, v19, s[4:7], s41 offen sc1
  s_bfe_u32 s41, s32, 0x20001
  s_lshl_b32 s38, s41, 6
  s_lshl_b32 s41, s41, 11
  s_lshr_b32 s42, s32, 3
  s_lshl_b32 s50, s42, 9
  s_add_u32 s38, s38, s50
  s_lshl_b32 s42, s42, 8
  s_add_u32 s41, s41, s42
  s_and_b32 s42, s32, 1
  s_lshl_b32 s50, s42, 8
  s_add_u32 s38, s38, s50
  s_lshl_b32 s42, s42, 4
  s_add_u32 s41, s41, s42
  v_lshrrev_b32 v19, 5, v0
  v_lshlrev_b32 v48, 10, v19
  v_and_b32 v19, 3, v0
  v_lshl_add_u32 v48, v19, 2, v48
  v_and_b32 v19, 1, v16
  v_lshl_add_u32 v48, v19, 1, v48
  buffer_load_ushort v49, v48, s[28:31], s41 offen offset:128
  buffer_load_ushort v50, v48, s[28:31], s41 offen offset:160
  s_lshl_b32 s37, s32, 13
  s_add_u32 s37, s37, 84152320
  s_add_u32 s39, s38, 85004288
  s_add_u32 s38, s38, 84938752
  s_lshl_b32 s46, s32, 13
  s_add_u32 s46, s46, 16777216
  s_add_u32 s70, s46, 16515072
  s_mov_b32 s34, 0
  s_lshl_b32 s71, s32, 7
  s_add_u32 s71, s71, 85200896
  v_lshrrev_b32 v19, 5, v0
  v_xor_b32 v19, 0, v19
  v_xor_b32 v19, v19, v17
  v_lshlrev_b32 v19, 5, v19
  v_lshl_add_u32 v19, v18, 4, v19
  v_lshl_add_u32 v22, v16, 13, v19
  s_lshl_b32 s41, s32, 8
  v_xor_b32 v23, 64, v22
  v_add_u32 v22, s41, v22
  v_add_u32 v23, s41, v23
  v_bfe_u32 v26, v0, 4, 1
  v_lshrrev_b32 v27, 5, v0
  v_bfe_u32 v12, v0, 2, 1
  v_bfe_u32 v13, v0, 3, 1
  v_and_b32 v14, 3, v0
  v_lshlrev_b32 v15, 3, v26
  v_lshl_add_u32 v15, v27, 2, v15
  v_add_u32 v15, v15, v13
  v_lshlrev_b32 v24, 8, v15
  v_lshl_add_u32 v24, v12, 5, v24
  v_lshl_add_u32 v24, v13, 6, v24
  v_lshl_add_u32 v24, v26, 7, v24
  v_lshl_add_u32 v24, v14, 3, v24
  v_lshlrev_b32 v15, 3, v27
  v_lshl_add_u32 v15, v26, 1, v15
  v_lshl_add_u32 v15, v12, 4, v15
  v_lshl_add_u32 v15, v13, 2, v15
  v_lshlrev_b32 v25, 8, v15
  v_lshl_add_u32 v25, v26, 5, v25
  v_lshl_add_u32 v25, v13, 6, v25
  v_lshl_add_u32 v25, v12, 7, v25
  v_lshl_add_u32 v25, v14, 3, v25
  v_lshrrev_b32 v16, 4, v0
  v_and_b32 v17, 15, v0
  v_bfe_u32 v18, v0, 1, 1
  v_mov_b32 v1, 0x88884444
  v_mov_b32 v19, 0xddddeeee
  v_cmp_eq_u32 vcc, 1, v18
  s_nop 1
  v_cndmask_b32 v1, v1, v19, vcc
  v_lshrrev_b32 v18, 2, v17
  v_bfe_u32 v19, v0, 1, 1
  v_lshlrev_b32 v2, 5, v19
  v_lshrrev_b32 v19, 1, v16
  v_lshl_add_u32 v2, v19, 4, v2
  v_and_b32 v19, 1, v0
  v_lshl_add_u32 v2, v19, 3, v2
  v_and_b32 v19, 1, v16
  v_lshl_add_u32 v2, v19, 2, v2
  v_lshlrev_b32 v5, 4, v17
  v_lshl_add_u32 v5, v16, 2, v5
  v_lshlrev_b32 v6, 1, v5
  v_and_b32 v19, 1, v0
  v_lshl_add_u32 v19, v18, 1, v19
  v_lshlrev_b32 v8, 4, v19
  v_lshl_add_u32 v8, v16, 7, v8
  v_and_b32 v19, 7, v0
  v_lshlrev_b32 v10, 3, v19
  v_lshrrev_b32 v19, 3, v0
  v_lshl_add_u32 v10, v19, 13, v10
  s_mov_b32 s43, 0x3e0293ee
  s_mov_b32 s44, 0x35800000
  s_mov_b32 s69, 0x14000000
  v_add_u32 v7, 81920, v3
  s_waitcnt vmcnt(15) lgkmcnt(0)
  s_barrier
  s_mov_b32 m0, 155648
  s_mov_b32 s41, 24576
  buffer_load_dwordx4 v20, s[24:27], s41 offen nt lds
  s_mov_b32 m0, 156672
  s_mov_b32 s41, 28672
  buffer_load_dwordx4 v20, s[24:27], s41 offen nt lds
  s_mov_b32 m0, 157696
  s_mov_b32 s41, 57344
  buffer_load_dwordx4 v21, s[24:27], s41 offen nt lds
  s_mov_b32 m0, 158720
  s_mov_b32 s41, 61440
  buffer_load_dwordx4 v21, s[24:27], s41 offen nt lds
  v_xor_b32 v12, 0, v24
  v_add_u32 v12, 8192, v12
  ds_read_b64_tr_b16 v[128:129], v12 offset:0
  ds_read_b64_tr_b16 v[130:131], v12 offset:512
  v_xor_b32 v12, 64, v24
  v_add_u32 v12, 8192, v12
  ds_read_b64_tr_b16 v[160:161], v12 offset:0
  ds_read_b64_tr_b16 v[162:163], v12 offset:512
  v_xor_b32 v12, 128, v24
  v_add_u32 v12, 8192, v12
  ds_read_b64_tr_b16 v[192:193], v12 offset:0
  ds_read_b64_tr_b16 v[194:195], v12 offset:512
  v_xor_b32 v12, 192, v24
  v_add_u32 v12, 8192, v12
  ds_read_b64_tr_b16 v[224:225], v12 offset:0
  ds_read_b64_tr_b16 v[226:227], v12 offset:512
  s_waitcnt vmcnt(15) lgkmcnt(0)
  s_barrier
  s_mov_b32 m0, 8192
  s_mov_b32 s41, 65536
  buffer_load_dwordx4 v20, s[24:27], s41 offen nt lds
  s_mov_b32 m0, 9216
  s_mov_b32 s41, 69632
  buffer_load_dwordx4 v20, s[24:27], s41 offen nt lds
  s_mov_b32 m0, 10240
  s_mov_b32 s41, 98304
  buffer_load_dwordx4 v21, s[24:27], s41 offen nt lds
  s_mov_b32 m0, 11264
  s_mov_b32 s41, 102400
  buffer_load_dwordx4 v21, s[24:27], s41 offen nt lds
  v_xor_b32 v12, 0, v24
  v_add_u32 v12, 73728, v12
  ds_read_b64_tr_b16 v[132:133], v12 offset:0
  ds_read_b64_tr_b16 v[134:135], v12 offset:512
  v_xor_b32 v12, 64, v24
  v_add_u32 v12, 73728, v12
  ds_read_b64_tr_b16 v[164:165], v12 offset:0
  ds_read_b64_tr_b16 v[166:167], v12 offset:512
  v_xor_b32 v12, 128, v24
  v_add_u32 v12, 73728, v12
  ds_read_b64_tr_b16 v[196:197], v12 offset:0
  ds_read_b64_tr_b16 v[198:199], v12 offset:512
  v_xor_b32 v12, 192, v24
  v_add_u32 v12, 73728, v12
  ds_read_b64_tr_b16 v[228:229], v12 offset:0
  ds_read_b64_tr_b16 v[230:231], v12 offset:512
  s_waitcnt vmcnt(15) lgkmcnt(0)
  s_barrier
  s_mov_b32 m0, 73728
  s_mov_b32 s41, 73728
  buffer_load_dwordx4 v20, s[24:27], s41 offen nt lds
  s_mov_b32 m0, 74752
  s_mov_b32 s41, 77824
  buffer_load_dwordx4 v20, s[24:27], s41 offen nt lds
  s_mov_b32 m0, 75776
  s_mov_b32 s41, 106496
  buffer_load_dwordx4 v21, s[24:27], s41 offen nt lds
  s_mov_b32 m0, 76800
  s_mov_b32 s41, 110592
  buffer_load_dwordx4 v21, s[24:27], s41 offen nt lds
  v_xor_b32 v12, 0, v24
  v_add_u32 v12, 122880, v12
  ds_read_b64_tr_b16 v[136:137], v12 offset:0
  ds_read_b64_tr_b16 v[138:139], v12 offset:512
  v_xor_b32 v12, 64, v24
  v_add_u32 v12, 122880, v12
  ds_read_b64_tr_b16 v[168:169], v12 offset:0
  ds_read_b64_tr_b16 v[170:171], v12 offset:512
  v_xor_b32 v12, 128, v24
  v_add_u32 v12, 122880, v12
  ds_read_b64_tr_b16 v[200:201], v12 offset:0
  ds_read_b64_tr_b16 v[202:203], v12 offset:512
  v_xor_b32 v12, 192, v24
  v_add_u32 v12, 122880, v12
  ds_read_b64_tr_b16 v[232:233], v12 offset:0
  ds_read_b64_tr_b16 v[234:235], v12 offset:512
  s_waitcnt vmcnt(8) lgkmcnt(0)
  s_barrier
  s_mov_b32 m0, 122880
  s_mov_b32 s41, 81920
  buffer_load_dwordx4 v20, s[24:27], s41 offen nt lds
  s_mov_b32 m0, 123904
  s_mov_b32 s41, 86016
  buffer_load_dwordx4 v20, s[24:27], s41 offen nt lds
  s_mov_b32 m0, 124928
  s_mov_b32 s41, 114688
  buffer_load_dwordx4 v21, s[24:27], s41 offen nt lds
  s_mov_b32 m0, 125952
  s_mov_b32 s41, 118784
  buffer_load_dwordx4 v21, s[24:27], s41 offen nt lds
  v_lshl_or_b32 v49, v50, 16, v49
  buffer_store_dword v49, v2, s[4:7], s38 offen sc1
  v_xor_b32 v12, 0, v24
  v_add_u32 v12, 155648, v12
  ds_read_b64_tr_b16 v[140:141], v12 offset:0
  ds_read_b64_tr_b16 v[142:143], v12 offset:512
  v_xor_b32 v12, 64, v24
  v_add_u32 v12, 155648, v12
  ds_read_b64_tr_b16 v[172:173], v12 offset:0
  ds_read_b64_tr_b16 v[174:175], v12 offset:512
  v_xor_b32 v12, 128, v24
  v_add_u32 v12, 155648, v12
  ds_read_b64_tr_b16 v[204:205], v12 offset:0
  ds_read_b64_tr_b16 v[206:207], v12 offset:512
  v_xor_b32 v12, 192, v24
  v_add_u32 v12, 155648, v12
  ds_read_b64_tr_b16 v[236:237], v12 offset:0
  ds_read_b64_tr_b16 v[238:239], v12 offset:512
  s_waitcnt vmcnt(9) lgkmcnt(0)
  s_barrier
  s_mov_b32 m0, 155648
  s_mov_b32 s41, 90112
  buffer_load_dwordx4 v20, s[24:27], s41 offen nt lds
  s_mov_b32 m0, 156672
  s_mov_b32 s41, 94208
  buffer_load_dwordx4 v20, s[24:27], s41 offen nt lds
  s_mov_b32 m0, 157696
  s_mov_b32 s41, 122880
  buffer_load_dwordx4 v21, s[24:27], s41 offen nt lds
  s_mov_b32 m0, 158720
  s_mov_b32 s41, 126976
  buffer_load_dwordx4 v21, s[24:27], s41 offen nt lds
  v_xor_b32 v12, 0, v24
  v_add_u32 v12, 8192, v12
  ds_read_b64_tr_b16 v[144:145], v12 offset:0
  ds_read_b64_tr_b16 v[146:147], v12 offset:512
  v_xor_b32 v12, 64, v24
  v_add_u32 v12, 8192, v12
  ds_read_b64_tr_b16 v[176:177], v12 offset:0
  ds_read_b64_tr_b16 v[178:179], v12 offset:512
  v_xor_b32 v12, 128, v24
  v_add_u32 v12, 8192, v12
  ds_read_b64_tr_b16 v[208:209], v12 offset:0
  ds_read_b64_tr_b16 v[210:211], v12 offset:512
  v_xor_b32 v12, 192, v24
  v_add_u32 v12, 8192, v12
  ds_read_b64_tr_b16 v[240:241], v12 offset:0
  ds_read_b64_tr_b16 v[242:243], v12 offset:512
  s_waitcnt vmcnt(9) lgkmcnt(0)
  s_barrier
  s_mov_b32 m0, 8192
  s_mov_b32 s41, 1048576
  buffer_load_dwordx4 v22, s[12:15], s41 offen nt lds
  s_mov_b32 m0, 9216
  s_mov_b32 s41, 1081344
  buffer_load_dwordx4 v23, s[12:15], s41 offen nt lds
  s_mov_b32 m0, 10240
  s_mov_b32 s41, 1114112
  buffer_load_dwordx4 v22, s[12:15], s41 offen nt lds
  s_mov_b32 m0, 11264
  s_mov_b32 s41, 1146880
  buffer_load_dwordx4 v23, s[12:15], s41 offen nt lds
  v_xor_b32 v12, 0, v24
  v_add_u32 v12, 73728, v12
  ds_read_b64_tr_b16 v[148:149], v12 offset:0
  ds_read_b64_tr_b16 v[150:151], v12 offset:512
  v_xor_b32 v12, 64, v24
  v_add_u32 v12, 73728, v12
  ds_read_b64_tr_b16 v[180:181], v12 offset:0
  ds_read_b64_tr_b16 v[182:183], v12 offset:512
  v_xor_b32 v12, 128, v24
  v_add_u32 v12, 73728, v12
  ds_read_b64_tr_b16 v[212:213], v12 offset:0
  ds_read_b64_tr_b16 v[214:215], v12 offset:512
  v_xor_b32 v12, 192, v24
  v_add_u32 v12, 73728, v12
  ds_read_b64_tr_b16 v[244:245], v12 offset:0
  ds_read_b64_tr_b16 v[246:247], v12 offset:512
  s_waitcnt vmcnt(9) lgkmcnt(0)
  s_barrier
  s_mov_b32 m0, 73728
  s_mov_b32 s41, 3145728
  buffer_load_dwordx4 v22, s[12:15], s41 offen nt lds
  s_mov_b32 m0, 74752
  s_mov_b32 s41, 3178496
  buffer_load_dwordx4 v23, s[12:15], s41 offen nt lds
  s_mov_b32 m0, 75776
  s_mov_b32 s41, 3211264
  buffer_load_dwordx4 v22, s[12:15], s41 offen nt lds
  s_mov_b32 m0, 76800
  s_mov_b32 s41, 3244032
  buffer_load_dwordx4 v23, s[12:15], s41 offen nt lds
  v_xor_b32 v12, 0, v24
  v_add_u32 v12, 122880, v12
  ds_read_b64_tr_b16 v[152:153], v12 offset:0
  ds_read_b64_tr_b16 v[154:155], v12 offset:512
  v_xor_b32 v12, 64, v24
  v_add_u32 v12, 122880, v12
  ds_read_b64_tr_b16 v[184:185], v12 offset:0
  ds_read_b64_tr_b16 v[186:187], v12 offset:512
  v_xor_b32 v12, 128, v24
  v_add_u32 v12, 122880, v12
  ds_read_b64_tr_b16 v[216:217], v12 offset:0
  ds_read_b64_tr_b16 v[218:219], v12 offset:512
  v_xor_b32 v12, 192, v24
  v_add_u32 v12, 122880, v12
  ds_read_b64_tr_b16 v[248:249], v12 offset:0
  ds_read_b64_tr_b16 v[250:251], v12 offset:512
  s_waitcnt vmcnt(8) lgkmcnt(0)
  s_barrier
  s_mov_b32 m0, 122880
  s_mov_b32 s41, 1310720
  buffer_load_dwordx4 v22, s[12:15], s41 offen nt lds
  s_mov_b32 m0, 123904
  s_mov_b32 s41, 1343488
  buffer_load_dwordx4 v23, s[12:15], s41 offen nt lds
  s_mov_b32 m0, 124928
  s_mov_b32 s41, 1376256
  buffer_load_dwordx4 v22, s[12:15], s41 offen nt lds
  s_mov_b32 m0, 125952
  s_mov_b32 s41, 1409024
  buffer_load_dwordx4 v23, s[12:15], s41 offen nt lds
  v_xor_b32 v12, 0, v24
  v_add_u32 v12, 155648, v12
  ds_read_b64_tr_b16 v[156:157], v12 offset:0
  ds_read_b64_tr_b16 v[158:159], v12 offset:512
  v_xor_b32 v12, 64, v24
  v_add_u32 v12, 155648, v12
  ds_read_b64_tr_b16 v[188:189], v12 offset:0
  ds_read_b64_tr_b16 v[190:191], v12 offset:512
  v_xor_b32 v12, 128, v24
  v_add_u32 v12, 155648, v12
  ds_read_b64_tr_b16 v[220:221], v12 offset:0
  ds_read_b64_tr_b16 v[222:223], v12 offset:512
  v_xor_b32 v12, 192, v24
  v_add_u32 v12, 155648, v12
  ds_read_b64_tr_b16 v[252:253], v12 offset:0
  ds_read_b64_tr_b16 v[254:255], v12 offset:512
  s_waitcnt vmcnt(8) lgkmcnt(0)
  s_barrier
  s_mov_b32 m0, 155648
  s_mov_b32 s41, 3407872
  buffer_load_dwordx4 v22, s[12:15], s41 offen nt lds
  s_mov_b32 m0, 156672
  s_mov_b32 s41, 3440640
  buffer_load_dwordx4 v23, s[12:15], s41 offen nt lds
  s_mov_b32 m0, 157696
  s_mov_b32 s41, 3473408
  buffer_load_dwordx4 v22, s[12:15], s41 offen nt lds
  s_mov_b32 m0, 158720
  s_mov_b32 s41, 3506176
  buffer_load_dwordx4 v23, s[12:15], s41 offen nt lds
  v_xor_b32 v12, 128, v25
  v_add_u32 v12, 0, v12
  ds_read_b64_tr_b16 a[0:1], v12 offset:0
  ds_read_b64_tr_b16 a[2:3], v12 offset:256
  ds_read_b64_tr_b16 a[4:5], v12 offset:8192
  ds_read_b64_tr_b16 a[6:7], v12 offset:8448
  v_xor_b32 v12, 160, v25
  v_add_u32 v12, 0, v12
  ds_read_b64_tr_b16 a[64:65], v12 offset:0
  ds_read_b64_tr_b16 a[66:67], v12 offset:256
  ds_read_b64_tr_b16 a[68:69], v12 offset:8192
  ds_read_b64_tr_b16 a[70:71], v12 offset:8448
  s_waitcnt vmcnt(8) lgkmcnt(0)
  s_barrier
  s_mov_b32 m0, 8192
  s_mov_b32 s41, 1572864
  buffer_load_dwordx4 v22, s[12:15], s41 offen nt lds
  s_mov_b32 m0, 9216
  s_mov_b32 s41, 1605632
  buffer_load_dwordx4 v23, s[12:15], s41 offen nt lds
  s_mov_b32 m0, 10240
  s_mov_b32 s41, 1638400
  buffer_load_dwordx4 v22, s[12:15], s41 offen nt lds
  s_mov_b32 m0, 11264
  s_mov_b32 s41, 1671168
  buffer_load_dwordx4 v23, s[12:15], s41 offen nt lds
  v_xor_b32 v12, 128, v25
  v_add_u32 v12, 65536, v12
  ds_read_b64_tr_b16 a[8:9], v12 offset:0
  ds_read_b64_tr_b16 a[10:11], v12 offset:256
  ds_read_b64_tr_b16 a[12:13], v12 offset:8192
  ds_read_b64_tr_b16 a[14:15], v12 offset:8448
  v_xor_b32 v12, 160, v25
  v_add_u32 v12, 65536, v12
  ds_read_b64_tr_b16 a[72:73], v12 offset:0
  ds_read_b64_tr_b16 a[74:75], v12 offset:256
  ds_read_b64_tr_b16 a[76:77], v12 offset:8192
  ds_read_b64_tr_b16 a[78:79], v12 offset:8448
  s_waitcnt vmcnt(8) lgkmcnt(0)
  s_barrier
  s_mov_b32 m0, 73728
  s_mov_b32 s41, 3670016
  buffer_load_dwordx4 v22, s[12:15], s41 offen nt lds
  s_mov_b32 m0, 74752
  s_mov_b32 s41, 3702784
  buffer_load_dwordx4 v23, s[12:15], s41 offen nt lds
  s_mov_b32 m0, 75776
  s_mov_b32 s41, 3735552
  buffer_load_dwordx4 v22, s[12:15], s41 offen nt lds
  s_mov_b32 m0, 76800
  s_mov_b32 s41, 3768320
  buffer_load_dwordx4 v23, s[12:15], s41 offen nt lds
  v_xor_b32 v12, 128, v25
  v_add_u32 v12, 114688, v12
  ds_read_b64_tr_b16 a[16:17], v12 offset:0
  ds_read_b64_tr_b16 a[18:19], v12 offset:256
  ds_read_b64_tr_b16 a[20:21], v12 offset:8192
  ds_read_b64_tr_b16 a[22:23], v12 offset:8448
  v_xor_b32 v12, 160, v25
  v_add_u32 v12, 114688, v12
  ds_read_b64_tr_b16 a[80:81], v12 offset:0
  ds_read_b64_tr_b16 a[82:83], v12 offset:256
  ds_read_b64_tr_b16 a[84:85], v12 offset:8192
  ds_read_b64_tr_b16 a[86:87], v12 offset:8448
  s_waitcnt vmcnt(8) lgkmcnt(0)
  s_barrier
  s_mov_b32 m0, 122880
  s_mov_b32 s41, 1835008
  buffer_load_dwordx4 v22, s[12:15], s41 offen nt lds
  s_mov_b32 m0, 123904
  s_mov_b32 s41, 1867776
  buffer_load_dwordx4 v23, s[12:15], s41 offen nt lds
  s_mov_b32 m0, 124928
  s_mov_b32 s41, 1900544
  buffer_load_dwordx4 v22, s[12:15], s41 offen nt lds
  s_mov_b32 m0, 125952
  s_mov_b32 s41, 1933312
  buffer_load_dwordx4 v23, s[12:15], s41 offen nt lds
  v_xor_b32 v12, 128, v25
  v_add_u32 v12, 147456, v12
  ds_read_b64_tr_b16 a[24:25], v12 offset:0
  ds_read_b64_tr_b16 a[26:27], v12 offset:256
  ds_read_b64_tr_b16 a[28:29], v12 offset:8192
  ds_read_b64_tr_b16 a[30:31], v12 offset:8448
  v_xor_b32 v12, 160, v25
  v_add_u32 v12, 147456, v12
  ds_read_b64_tr_b16 a[88:89], v12 offset:0
  ds_read_b64_tr_b16 a[90:91], v12 offset:256
  ds_read_b64_tr_b16 a[92:93], v12 offset:8192
  ds_read_b64_tr_b16 a[94:95], v12 offset:8448
  s_waitcnt vmcnt(8) lgkmcnt(0)
  s_barrier
  s_mov_b32 m0, 155648
  s_mov_b32 s41, 3932160
  buffer_load_dwordx4 v22, s[12:15], s41 offen nt lds
  s_mov_b32 m0, 156672
  s_mov_b32 s41, 3964928
  buffer_load_dwordx4 v23, s[12:15], s41 offen nt lds
  s_mov_b32 m0, 157696
  s_mov_b32 s41, 3997696
  buffer_load_dwordx4 v22, s[12:15], s41 offen nt lds
  s_mov_b32 m0, 158720
  s_mov_b32 s41, 4030464
  buffer_load_dwordx4 v23, s[12:15], s41 offen nt lds
  v_xor_b32 v12, 128, v25
  v_add_u32 v12, 0, v12
  ds_read_b64_tr_b16 a[32:33], v12 offset:0
  ds_read_b64_tr_b16 a[34:35], v12 offset:256
  ds_read_b64_tr_b16 a[36:37], v12 offset:8192
  ds_read_b64_tr_b16 a[38:39], v12 offset:8448
  v_xor_b32 v12, 160, v25
  v_add_u32 v12, 0, v12
  ds_read_b64_tr_b16 a[96:97], v12 offset:0
  ds_read_b64_tr_b16 a[98:99], v12 offset:256
  ds_read_b64_tr_b16 a[100:101], v12 offset:8192
  ds_read_b64_tr_b16 a[102:103], v12 offset:8448
  s_waitcnt vmcnt(8) lgkmcnt(0)
  s_barrier
  s_mov_b32 m0, 8192
  s_mov_b32 s41, 1048576
  buffer_load_dwordx4 v22, s[16:19], s41 offen nt lds
  s_mov_b32 m0, 9216
  s_mov_b32 s41, 1081344
  buffer_load_dwordx4 v23, s[16:19], s41 offen nt lds
  s_mov_b32 m0, 10240
  s_mov_b32 s41, 1114112
  buffer_load_dwordx4 v22, s[16:19], s41 offen nt lds
  s_mov_b32 m0, 11264
  s_mov_b32 s41, 1146880
  buffer_load_dwordx4 v23, s[16:19], s41 offen nt lds
  v_xor_b32 v12, 128, v25
  v_add_u32 v12, 65536, v12
  ds_read_b64_tr_b16 a[40:41], v12 offset:0
  ds_read_b64_tr_b16 a[42:43], v12 offset:256
  ds_read_b64_tr_b16 a[44:45], v12 offset:8192
  ds_read_b64_tr_b16 a[46:47], v12 offset:8448
  v_xor_b32 v12, 160, v25
  v_add_u32 v12, 65536, v12
  ds_read_b64_tr_b16 a[104:105], v12 offset:0
  ds_read_b64_tr_b16 a[106:107], v12 offset:256
  ds_read_b64_tr_b16 a[108:109], v12 offset:8192
  ds_read_b64_tr_b16 a[110:111], v12 offset:8448
  s_waitcnt vmcnt(8) lgkmcnt(0)
  s_barrier
  s_mov_b32 m0, 73728
  s_mov_b32 s41, 3145728
  buffer_load_dwordx4 v22, s[16:19], s41 offen nt lds
  s_mov_b32 m0, 74752
  s_mov_b32 s41, 3178496
  buffer_load_dwordx4 v23, s[16:19], s41 offen nt lds
  s_mov_b32 m0, 75776
  s_mov_b32 s41, 3211264
  buffer_load_dwordx4 v22, s[16:19], s41 offen nt lds
  s_mov_b32 m0, 76800
  s_mov_b32 s41, 3244032
  buffer_load_dwordx4 v23, s[16:19], s41 offen nt lds
  v_xor_b32 v12, 128, v25
  v_add_u32 v12, 114688, v12
  ds_read_b64_tr_b16 a[48:49], v12 offset:0
  ds_read_b64_tr_b16 a[50:51], v12 offset:256
  ds_read_b64_tr_b16 a[52:53], v12 offset:8192
  ds_read_b64_tr_b16 a[54:55], v12 offset:8448
  v_xor_b32 v12, 160, v25
  v_add_u32 v12, 114688, v12
  ds_read_b64_tr_b16 a[112:113], v12 offset:0
  ds_read_b64_tr_b16 a[114:115], v12 offset:256
  ds_read_b64_tr_b16 a[116:117], v12 offset:8192
  ds_read_b64_tr_b16 a[118:119], v12 offset:8448
  s_waitcnt vmcnt(8) lgkmcnt(0)
  s_barrier
  s_mov_b32 m0, 122880
  s_mov_b32 s41, 1310720
  buffer_load_dwordx4 v22, s[16:19], s41 offen nt lds
  s_mov_b32 m0, 123904
  s_mov_b32 s41, 1343488
  buffer_load_dwordx4 v23, s[16:19], s41 offen nt lds
  s_mov_b32 m0, 124928
  s_mov_b32 s41, 1376256
  buffer_load_dwordx4 v22, s[16:19], s41 offen nt lds
  s_mov_b32 m0, 125952
  s_mov_b32 s41, 1409024
  buffer_load_dwordx4 v23, s[16:19], s41 offen nt lds
  v_xor_b32 v12, 128, v25
  v_add_u32 v12, 147456, v12
  ds_read_b64_tr_b16 a[56:57], v12 offset:0
  ds_read_b64_tr_b16 a[58:59], v12 offset:256
  ds_read_b64_tr_b16 a[60:61], v12 offset:8192
  ds_read_b64_tr_b16 a[62:63], v12 offset:8448
  v_xor_b32 v12, 160, v25
  v_add_u32 v12, 147456, v12
  ds_read_b64_tr_b16 a[120:121], v12 offset:0
  ds_read_b64_tr_b16 a[122:123], v12 offset:256
  ds_read_b64_tr_b16 a[124:125], v12 offset:8192
  ds_read_b64_tr_b16 a[126:127], v12 offset:8448
  s_waitcnt vmcnt(8) lgkmcnt(0)
  s_barrier
  s_mov_b32 m0, 155648
  s_mov_b32 s41, 3407872
  buffer_load_dwordx4 v22, s[16:19], s41 offen nt lds
  s_mov_b32 m0, 156672
  s_mov_b32 s41, 3440640
  buffer_load_dwordx4 v23, s[16:19], s41 offen nt lds
  s_mov_b32 m0, 157696
  s_mov_b32 s41, 3473408
  buffer_load_dwordx4 v22, s[16:19], s41 offen nt lds
  s_mov_b32 m0, 158720
  s_mov_b32 s41, 3506176
  buffer_load_dwordx4 v23, s[16:19], s41 offen nt lds
  v_xor_b32 v12, 128, v25
  v_add_u32 v12, 0, v12
  ds_read_b64_tr_b16 a[128:129], v12 offset:0
  ds_read_b64_tr_b16 a[130:131], v12 offset:256
  ds_read_b64_tr_b16 a[132:133], v12 offset:8192
  ds_read_b64_tr_b16 a[134:135], v12 offset:8448
  v_xor_b32 v12, 160, v25
  v_add_u32 v12, 0, v12
  ds_read_b64_tr_b16 a[192:193], v12 offset:0
  ds_read_b64_tr_b16 a[194:195], v12 offset:256
  ds_read_b64_tr_b16 a[196:197], v12 offset:8192
  ds_read_b64_tr_b16 a[198:199], v12 offset:8448
  s_waitcnt vmcnt(8) lgkmcnt(0)
  s_barrier
  s_mov_b32 m0, 8192
  s_mov_b32 s41, 1572864
  buffer_load_dwordx4 v22, s[16:19], s41 offen nt lds
  s_mov_b32 m0, 9216
  s_mov_b32 s41, 1605632
  buffer_load_dwordx4 v23, s[16:19], s41 offen nt lds
  s_mov_b32 m0, 10240
  s_mov_b32 s41, 1638400
  buffer_load_dwordx4 v22, s[16:19], s41 offen nt lds
  s_mov_b32 m0, 11264
  s_mov_b32 s41, 1671168
  buffer_load_dwordx4 v23, s[16:19], s41 offen nt lds
  v_xor_b32 v12, 128, v25
  v_add_u32 v12, 65536, v12
  ds_read_b64_tr_b16 a[136:137], v12 offset:0
  ds_read_b64_tr_b16 a[138:139], v12 offset:256
  ds_read_b64_tr_b16 a[140:141], v12 offset:8192
  ds_read_b64_tr_b16 a[142:143], v12 offset:8448
  v_xor_b32 v12, 160, v25
  v_add_u32 v12, 65536, v12
  ds_read_b64_tr_b16 a[200:201], v12 offset:0
  ds_read_b64_tr_b16 a[202:203], v12 offset:256
  ds_read_b64_tr_b16 a[204:205], v12 offset:8192
  ds_read_b64_tr_b16 a[206:207], v12 offset:8448
  s_waitcnt vmcnt(8) lgkmcnt(0)
  s_barrier
  s_mov_b32 m0, 73728
  s_mov_b32 s41, 3670016
  buffer_load_dwordx4 v22, s[16:19], s41 offen nt lds
  s_mov_b32 m0, 74752
  s_mov_b32 s41, 3702784
  buffer_load_dwordx4 v23, s[16:19], s41 offen nt lds
  s_mov_b32 m0, 75776
  s_mov_b32 s41, 3735552
  buffer_load_dwordx4 v22, s[16:19], s41 offen nt lds
  s_mov_b32 m0, 76800
  s_mov_b32 s41, 3768320
  buffer_load_dwordx4 v23, s[16:19], s41 offen nt lds
  buffer_load_dwordx2 v[52:53], off, s[8:11], 0 sc1
  buffer_load_dword v54, off, s[8:11], 0 offset:16 sc1
  s_mov_b32 s40, 0
  v_xor_b32 v12, 128, v25
  v_add_u32 v12, 114688, v12
  ds_read_b64_tr_b16 a[144:145], v12 offset:0
  ds_read_b64_tr_b16 a[146:147], v12 offset:256
  ds_read_b64_tr_b16 a[148:149], v12 offset:8192
  ds_read_b64_tr_b16 a[150:151], v12 offset:8448
  v_xor_b32 v12, 160, v25
  v_add_u32 v12, 114688, v12
  ds_read_b64_tr_b16 a[208:209], v12 offset:0
  ds_read_b64_tr_b16 a[210:211], v12 offset:256
  ds_read_b64_tr_b16 a[212:213], v12 offset:8192
  ds_read_b64_tr_b16 a[214:215], v12 offset:8448
  s_waitcnt vmcnt(10) lgkmcnt(0)
  s_barrier
  s_mov_b32 m0, 122880
  s_mov_b32 s41, 1835008
  buffer_load_dwordx4 v22, s[16:19], s41 offen nt lds
  s_mov_b32 m0, 123904
  s_mov_b32 s41, 1867776
  buffer_load_dwordx4 v23, s[16:19], s41 offen nt lds
  s_mov_b32 m0, 124928
  s_mov_b32 s41, 1900544
  buffer_load_dwordx4 v22, s[16:19], s41 offen nt lds
  s_mov_b32 m0, 125952
  s_mov_b32 s41, 1933312
  buffer_load_dwordx4 v23, s[16:19], s41 offen nt lds
  v_xor_b32 v12, 128, v25
  v_add_u32 v12, 147456, v12
  ds_read_b64_tr_b16 a[152:153], v12 offset:0
  ds_read_b64_tr_b16 a[154:155], v12 offset:256
  ds_read_b64_tr_b16 a[156:157], v12 offset:8192
  ds_read_b64_tr_b16 a[158:159], v12 offset:8448
  v_xor_b32 v12, 160, v25
  v_add_u32 v12, 147456, v12
  ds_read_b64_tr_b16 a[216:217], v12 offset:0
  ds_read_b64_tr_b16 a[218:219], v12 offset:256
  ds_read_b64_tr_b16 a[220:221], v12 offset:8192
  ds_read_b64_tr_b16 a[222:223], v12 offset:8448
  s_waitcnt vmcnt(10) lgkmcnt(0)
  s_barrier
  s_mov_b32 m0, 155648
  s_mov_b32 s41, 3932160
  buffer_load_dwordx4 v22, s[16:19], s41 offen nt lds
  s_mov_b32 m0, 156672
  s_mov_b32 s41, 3964928
  buffer_load_dwordx4 v23, s[16:19], s41 offen nt lds
  s_mov_b32 m0, 157696
  s_mov_b32 s41, 3997696
  buffer_load_dwordx4 v22, s[16:19], s41 offen nt lds
  s_mov_b32 m0, 158720
  s_mov_b32 s41, 4030464
  buffer_load_dwordx4 v23, s[16:19], s41 offen nt lds
  v_xor_b32 v12, 128, v25
  v_add_u32 v12, 0, v12
  ds_read_b64_tr_b16 a[160:161], v12 offset:0
  ds_read_b64_tr_b16 a[162:163], v12 offset:256
  ds_read_b64_tr_b16 a[164:165], v12 offset:8192
  ds_read_b64_tr_b16 a[166:167], v12 offset:8448
  v_xor_b32 v12, 160, v25
  v_add_u32 v12, 0, v12
  ds_read_b64_tr_b16 a[224:225], v12 offset:0
  ds_read_b64_tr_b16 a[226:227], v12 offset:256
  ds_read_b64_tr_b16 a[228:229], v12 offset:8192
  ds_read_b64_tr_b16 a[230:231], v12 offset:8448
  s_waitcnt vmcnt(10) lgkmcnt(0)
  s_barrier
  s_mov_b32 m0, 8192
  s_mov_b32 s41, 1048576
  buffer_load_dwordx4 v22, s[20:23], s41 offen nt lds
  s_mov_b32 m0, 9216
  s_mov_b32 s41, 1081344
  buffer_load_dwordx4 v23, s[20:23], s41 offen nt lds
  s_mov_b32 m0, 10240
  s_mov_b32 s41, 1114112
  buffer_load_dwordx4 v22, s[20:23], s41 offen nt lds
  s_mov_b32 m0, 11264
  s_mov_b32 s41, 1146880
  buffer_load_dwordx4 v23, s[20:23], s41 offen nt lds
  v_xor_b32 v12, 128, v25
  v_add_u32 v12, 65536, v12
  ds_read_b64_tr_b16 a[168:169], v12 offset:0
  ds_read_b64_tr_b16 a[170:171], v12 offset:256
  ds_read_b64_tr_b16 a[172:173], v12 offset:8192
  ds_read_b64_tr_b16 a[174:175], v12 offset:8448
  v_xor_b32 v12, 160, v25
  v_add_u32 v12, 65536, v12
  ds_read_b64_tr_b16 a[232:233], v12 offset:0
  ds_read_b64_tr_b16 a[234:235], v12 offset:256
  ds_read_b64_tr_b16 a[236:237], v12 offset:8192
  ds_read_b64_tr_b16 a[238:239], v12 offset:8448
  s_waitcnt vmcnt(8) lgkmcnt(0)
  s_barrier
  s_mov_b32 m0, 73728
  s_mov_b32 s41, 3145728
  buffer_load_dwordx4 v22, s[20:23], s41 offen nt lds
  s_mov_b32 m0, 74752
  s_mov_b32 s41, 3178496
  buffer_load_dwordx4 v23, s[20:23], s41 offen nt lds
  s_mov_b32 m0, 75776
  s_mov_b32 s41, 3211264
  buffer_load_dwordx4 v22, s[20:23], s41 offen nt lds
  s_mov_b32 m0, 76800
  s_mov_b32 s41, 3244032
  buffer_load_dwordx4 v23, s[20:23], s41 offen nt lds
c_cen2:
  s_getreg_b32 s50, hwreg(HW_REG_XCC_ID, 0, 3)
  s_mul_i32 s50, s50, 6
  s_lshl_b64 s[56:57], 32, s50
  v_readfirstlane_b32 s58, v52
  v_readfirstlane_b32 s59, v53
  v_readfirstlane_b32 s50, v54
  s_cmp_eq_u64 s[56:57], s[58:59]
  s_cselect_b32 s96, 1, 0
  s_mov_b32 s41, 0
  s_and_b32 s42, s58, 63
  s_add_u32 s41, s41, s42
  s_lshr_b64 s[58:59], s[58:59], 6
  s_and_b32 s42, s58, 63
  s_add_u32 s41, s41, s42
  s_lshr_b64 s[58:59], s[58:59], 6
  s_and_b32 s42, s58, 63
  s_add_u32 s41, s41, s42
  s_lshr_b64 s[58:59], s[58:59], 6
  s_and_b32 s42, s58, 63
  s_add_u32 s41, s41, s42
  s_lshr_b64 s[58:59], s[58:59], 6
  s_and_b32 s42, s58, 63
  s_add_u32 s41, s41, s42
  s_lshr_b64 s[58:59], s[58:59], 6
  s_and_b32 s42, s58, 63
  s_add_u32 s41, s41, s42
  s_lshr_b64 s[58:59], s[58:59], 6
  s_and_b32 s42, s58, 63
  s_add_u32 s41, s41, s42
  s_lshr_b64 s[58:59], s[58:59], 6
  s_and_b32 s42, s58, 63
  s_add_u32 s41, s41, s42
  s_lshr_b64 s[58:59], s[58:59], 6
  s_mul_i32 s41, s41, s50
  s_cmp_lg_u32 s41, 32
  s_cbranch_scc1 c_cenw2
c_cend2:
  v_xor_b32 v12, 128, v25
  v_add_u32 v12, 114688, v12
  ds_read_b64_tr_b16 a[176:177], v12 offset:0
  ds_read_b64_tr_b16 a[178:179], v12 offset:256
  ds_read_b64_tr_b16 a[180:181], v12 offset:8192
  ds_read_b64_tr_b16 a[182:183], v12 offset:8448
  v_xor_b32 v12, 160, v25
  v_add_u32 v12, 114688, v12
  ds_read_b64_tr_b16 a[240:241], v12 offset:0
  ds_read_b64_tr_b16 a[242:243], v12 offset:256
  ds_read_b64_tr_b16 a[244:245], v12 offset:8192
  ds_read_b64_tr_b16 a[246:247], v12 offset:8448
  s_waitcnt vmcnt(8) lgkmcnt(0)
  s_barrier
  s_mov_b32 m0, 122880
  s_mov_b32 s41, 1310720
  buffer_load_dwordx4 v22, s[20:23], s41 offen nt lds
  s_mov_b32 m0, 123904
  s_mov_b32 s41, 1343488
  buffer_load_dwordx4 v23, s[20:23], s41 offen nt lds
  s_mov_b32 m0, 124928
  s_mov_b32 s41, 1376256
  buffer_load_dwordx4 v22, s[20:23], s41 offen nt lds
  s_mov_b32 m0, 125952
  s_mov_b32 s41, 1409024
  buffer_load_dwordx4 v23, s[20:23], s41 offen nt lds
  v_xor_b32 v12, 128, v25
  v_add_u32 v12, 147456, v12
  ds_read_b64_tr_b16 a[184:185], v12 offset:0
  ds_read_b64_tr_b16 a[186:187], v12 offset:256
  ds_read_b64_tr_b16 a[188:189], v12 offset:8192
  ds_read_b64_tr_b16 a[190:191], v12 offset:8448
  v_xor_b32 v12, 160, v25
  v_add_u32 v12, 147456, v12
  ds_read_b64_tr_b16 a[248:249], v12 offset:0
  ds_read_b64_tr_b16 a[250:251], v12 offset:256
  ds_read_b64_tr_b16 a[252:253], v12 offset:8192
  ds_read_b64_tr_b16 a[254:255], v12 offset:8448
  s_waitcnt vmcnt(8) lgkmcnt(0)
  s_barrier
  s_mov_b32 m0, 155648
  s_mov_b32 s41, 3407872
  buffer_load_dwordx4 v22, s[20:23], s41 offen nt lds
  s_mov_b32 m0, 156672
  s_mov_b32 s41, 3440640
  buffer_load_dwordx4 v23, s[20:23], s41 offen nt lds
  s_mov_b32 m0, 157696
  s_mov_b32 s41, 3473408
  buffer_load_dwordx4 v22, s[20:23], s41 offen nt lds
  s_mov_b32 m0, 158720
  s_mov_b32 s41, 3506176
  buffer_load_dwordx4 v23, s[20:23], s41 offen nt lds
  v_xor_b32 v12, 64, v25
  v_add_u32 v12, 0, v12
  ds_read_b64_tr_b16 v[32:33], v12 offset:0
  ds_read_b64_tr_b16 v[34:35], v12 offset:256
  ds_read_b64_tr_b16 v[36:37], v12 offset:8192
  ds_read_b64_tr_b16 v[38:39], v12 offset:8448
  v_xor_b32 v12, 96, v25
  v_add_u32 v12, 0, v12
  ds_read_b64_tr_b16 v[64:65], v12 offset:0
  ds_read_b64_tr_b16 v[66:67], v12 offset:256
  ds_read_b64_tr_b16 v[68:69], v12 offset:8192
  ds_read_b64_tr_b16 v[70:71], v12 offset:8448
  v_xor_b32 v12, 224, v25
  v_add_u32 v12, 0, v12
  ds_read_b64_tr_b16 v[40:41], v12 offset:0
  ds_read_b64_tr_b16 v[42:43], v12 offset:256
  ds_read_b64_tr_b16 v[44:45], v12 offset:8192
  ds_read_b64_tr_b16 v[46:47], v12 offset:8448
  s_waitcnt lgkmcnt(0)
  ds_write_b128 v7, v[32:35] offset:0
  ds_write_b128 v7, v[36:39] offset:1024
  ds_write_b128 v7, v[40:43] offset:16384
  ds_write_b128 v7, v[44:47] offset:17408
  s_waitcnt vmcnt(8) lgkmcnt(0)
  s_barrier
  s_mov_b32 m0, 8192
  s_mov_b32 s41, 1572864
  buffer_load_dwordx4 v22, s[20:23], s41 offen nt lds
  s_mov_b32 m0, 9216
  s_mov_b32 s41, 1605632
  buffer_load_dwordx4 v23, s[20:23], s41 offen nt lds
  s_mov_b32 m0, 10240
  s_mov_b32 s41, 1638400
  buffer_load_dwordx4 v22, s[20:23], s41 offen nt lds
  s_mov_b32 m0, 11264
  s_mov_b32 s41, 1671168
  buffer_load_dwordx4 v23, s[20:23], s41 offen nt lds
  v_xor_b32 v12, 64, v25
  v_add_u32 v12, 65536, v12
  ds_read_b64_tr_b16 v[32:33], v12 offset:0
  ds_read_b64_tr_b16 v[34:35], v12 offset:256
  ds_read_b64_tr_b16 v[36:37], v12 offset:8192
  ds_read_b64_tr_b16 v[38:39], v12 offset:8448
  v_xor_b32 v12, 96, v25
  v_add_u32 v12, 65536, v12
  ds_read_b64_tr_b16 v[72:73], v12 offset:0
  ds_read_b64_tr_b16 v[74:75], v12 offset:256
  ds_read_b64_tr_b16 v[76:77], v12 offset:8192
  ds_read_b64_tr_b16 v[78:79], v12 offset:8448
  v_xor_b32 v12, 224, v25
  v_add_u32 v12, 65536, v12
  ds_read_b64_tr_b16 v[40:41], v12 offset:0
  ds_read_b64_tr_b16 v[42:43], v12 offset:256
  ds_read_b64_tr_b16 v[44:45], v12 offset:8192
  ds_read_b64_tr_b16 v[46:47], v12 offset:8448
  s_waitcnt lgkmcnt(0)
  ds_write_b128 v7, v[32:35] offset:2048
  ds_write_b128 v7, v[36:39] offset:3072
  ds_write_b128 v7, v[40:43] offset:18432
  ds_write_b128 v7, v[44:47] offset:19456
  s_waitcnt vmcnt(8) lgkmcnt(0)
  s_barrier
  s_mov_b32 m0, 73728
  s_mov_b32 s41, 3670016
  buffer_load_dwordx4 v22, s[20:23], s41 offen nt lds
  s_mov_b32 m0, 74752
  s_mov_b32 s41, 3702784
  buffer_load_dwordx4 v23, s[20:23], s41 offen nt lds
  s_mov_b32 m0, 75776
  s_mov_b32 s41, 3735552
  buffer_load_dwordx4 v22, s[20:23], s41 offen nt lds
  s_mov_b32 m0, 76800
  s_mov_b32 s41, 3768320
  buffer_load_dwordx4 v23, s[20:23], s41 offen nt lds
  v_xor_b32 v12, 64, v25
  v_add_u32 v12, 114688, v12
  ds_read_b64_tr_b16 v[32:33], v12 offset:0
  ds_read_b64_tr_b16 v[34:35], v12 offset:256
  ds_read_b64_tr_b16 v[36:37], v12 offset:8192
  ds_read_b64_tr_b16 v[38:39], v12 offset:8448
  v_xor_b32 v12, 96, v25
  v_add_u32 v12, 114688, v12
  ds_read_b64_tr_b16 v[80:81], v12 offset:0
  ds_read_b64_tr_b16 v[82:83], v12 offset:256
  ds_read_b64_tr_b16 v[84:85], v12 offset:8192
  ds_read_b64_tr_b16 v[86:87], v12 offset:8448
  v_xor_b32 v12, 224, v25
  v_add_u32 v12, 114688, v12
  ds_read_b64_tr_b16 v[40:41], v12 offset:0
  ds_read_b64_tr_b16 v[42:43], v12 offset:256
  ds_read_b64_tr_b16 v[44:45], v12 offset:8192
  ds_read_b64_tr_b16 v[46:47], v12 offset:8448
  s_waitcnt lgkmcnt(0)
  ds_write_b128 v7, v[32:35] offset:4096
  ds_write_b128 v7, v[36:39] offset:5120
  ds_write_b128 v7, v[40:43] offset:20480
  ds_write_b128 v7, v[44:47] offset:21504
  s_waitcnt vmcnt(8) lgkmcnt(0)
  s_barrier
  s_mov_b32 m0, 122880
  s_mov_b32 s41, 1835008
  buffer_load_dwordx4 v22, s[20:23], s41 offen nt lds
  s_mov_b32 m0, 123904
  s_mov_b32 s41, 1867776
  buffer_load_dwordx4 v23, s[20:23], s41 offen nt lds
  s_mov_b32 m0, 124928
  s_mov_b32 s41, 1900544
  buffer_load_dwordx4 v22, s[20:23], s41 offen nt lds
  s_mov_b32 m0, 125952
  s_mov_b32 s41, 1933312
  buffer_load_dwordx4 v23, s[20:23], s41 offen nt lds
  v_xor_b32 v12, 64, v25
  v_add_u32 v12, 147456, v12
  ds_read_b64_tr_b16 v[32:33], v12 offset:0
  ds_read_b64_tr_b16 v[34:35], v12 offset:256
  ds_read_b64_tr_b16 v[36:37], v12 offset:8192
  ds_read_b64_tr_b16 v[38:39], v12 offset:8448
  v_xor_b32 v12, 96, v25
  v_add_u32 v12, 147456, v12
  ds_read_b64_tr_b16 v[88:89], v12 offset:0
  ds_read_b64_tr_b16 v[90:91], v12 offset:256
  ds_read_b64_tr_b16 v[92:93], v12 offset:8192
  ds_read_b64_tr_b16 v[94:95], v12 offset:8448
  v_xor_b32 v12, 224, v25
  v_add_u32 v12, 147456, v12
  ds_read_b64_tr_b16 v[40:41], v12 offset:0
  ds_read_b64_tr_b16 v[42:43], v12 offset:256
  ds_read_b64_tr_b16 v[44:45], v12 offset:8192
  ds_read_b64_tr_b16 v[46:47], v12 offset:8448
  s_waitcnt lgkmcnt(0)
  ds_write_b128 v7, v[32:35] offset:6144
  ds_write_b128 v7, v[36:39] offset:7168
  ds_write_b128 v7, v[40:43] offset:22528
  ds_write_b128 v7, v[44:47] offset:23552
  s_waitcnt vmcnt(8) lgkmcnt(0)
  s_barrier
  s_mov_b32 m0, 155648
  s_mov_b32 s41, 3932160
  buffer_load_dwordx4 v22, s[20:23], s41 offen nt lds
  s_mov_b32 m0, 156672
  s_mov_b32 s41, 3964928
  buffer_load_dwordx4 v23, s[20:23], s41 offen nt lds
  s_mov_b32 m0, 157696
  s_mov_b32 s41, 3997696
  buffer_load_dwordx4 v22, s[20:23], s41 offen nt lds
  s_mov_b32 m0, 158720
  s_mov_b32 s41, 4030464
  buffer_load_dwordx4 v23, s[20:23], s41 offen nt lds
  v_xor_b32 v12, 64, v25
  v_add_u32 v12, 0, v12
  ds_read_b64_tr_b16 v[32:33], v12 offset:0
  ds_read_b64_tr_b16 v[34:35], v12 offset:256
  ds_read_b64_tr_b16 v[36:37], v12 offset:8192
  ds_read_b64_tr_b16 v[38:39], v12 offset:8448
  v_xor_b32 v12, 96, v25
  v_add_u32 v12, 0, v12
  ds_read_b64_tr_b16 v[96:97], v12 offset:0
  ds_read_b64_tr_b16 v[98:99], v12 offset:256
  ds_read_b64_tr_b16 v[100:101], v12 offset:8192
  ds_read_b64_tr_b16 v[102:103], v12 offset:8448
  v_xor_b32 v12, 224, v25
  v_add_u32 v12, 0, v12
  ds_read_b64_tr_b16 v[40:41], v12 offset:0
  ds_read_b64_tr_b16 v[42:43], v12 offset:256
  ds_read_b64_tr_b16 v[44:45], v12 offset:8192
  ds_read_b64_tr_b16 v[46:47], v12 offset:8448
  s_waitcnt lgkmcnt(0)
  ds_write_b128 v7, v[32:35] offset:8192
  ds_write_b128 v7, v[36:39] offset:9216
  ds_write_b128 v7, v[40:43] offset:24576
  ds_write_b128 v7, v[44:47] offset:25600
  s_waitcnt vmcnt(8) lgkmcnt(0)
  s_barrier
  v_lshrrev_b32 v55, 4, v0
  v_and_b32 v55, 1, v55
  v_lshlrev_b32 v55, 18, v55
  v_and_b32 v56, 15, v0
  v_lshl_add_u32 v55, v56, 7, v55
  s_lshl_b32 s41, s32, 13
  s_add_u32 s41, s41, 83890176
  v_and_b32 v56, 1, v0
  v_lshlrev_b32 v56, 7, v56
  s_lshl_b32 s42, s32, 8
  s_add_u32 s42, s42, 85000192
  buffer_load_dword v57, v55, s[4:7], s41 offen sc1
  buffer_load_dword v57, v56, s[4:7], s42 offen sc1
  v_xor_b32 v12, 64, v25
  v_add_u32 v12, 65536, v12
  ds_read_b64_tr_b16 v[32:33], v12 offset:0
  ds_read_b64_tr_b16 v[34:35], v12 offset:256
  ds_read_b64_tr_b16 v[36:37], v12 offset:8192
  ds_read_b64_tr_b16 v[38:39], v12 offset:8448
  v_xor_b32 v12, 96, v25
  v_add_u32 v12, 65536, v12
  ds_read_b64_tr_b16 v[104:105], v12 offset:0
  ds_read_b64_tr_b16 v[106:107], v12 offset:256
  ds_read_b64_tr_b16 v[108:109], v12 offset:8192
  ds_read_b64_tr_b16 v[110:111], v12 offset:8448
  v_xor_b32 v12, 224, v25
  v_add_u32 v12, 65536, v12
  ds_read_b64_tr_b16 v[40:41], v12 offset:0
  ds_read_b64_tr_b16 v[42:43], v12 offset:256
  ds_read_b64_tr_b16 v[44:45], v12 offset:8192
  ds_read_b64_tr_b16 v[46:47], v12 offset:8448
  s_waitcnt lgkmcnt(0)
  ds_write_b128 v7, v[32:35] offset:10240
  ds_write_b128 v7, v[36:39] offset:11264
  ds_write_b128 v7, v[40:43] offset:26624
  ds_write_b128 v7, v[44:47] offset:27648
  s_waitcnt vmcnt(6) lgkmcnt(0)
  s_barrier
  v_xor_b32 v12, 64, v25
  v_add_u32 v12, 114688, v12
  ds_read_b64_tr_b16 v[32:33], v12 offset:0
  ds_read_b64_tr_b16 v[34:35], v12 offset:256
  ds_read_b64_tr_b16 v[36:37], v12 offset:8192
  ds_read_b64_tr_b16 v[38:39], v12 offset:8448
  v_xor_b32 v12, 96, v25
  v_add_u32 v12, 114688, v12
  ds_read_b64_tr_b16 v[112:113], v12 offset:0
  ds_read_b64_tr_b16 v[114:115], v12 offset:256
  ds_read_b64_tr_b16 v[116:117], v12 offset:8192
  ds_read_b64_tr_b16 v[118:119], v12 offset:8448
  v_xor_b32 v12, 224, v25
  v_add_u32 v12, 114688, v12
  ds_read_b64_tr_b16 v[40:41], v12 offset:0
  ds_read_b64_tr_b16 v[42:43], v12 offset:256
  ds_read_b64_tr_b16 v[44:45], v12 offset:8192
  ds_read_b64_tr_b16 v[46:47], v12 offset:8448
  s_waitcnt lgkmcnt(0)
  ds_write_b128 v7, v[32:35] offset:12288
  ds_write_b128 v7, v[36:39] offset:13312
  ds_write_b128 v7, v[40:43] offset:28672
  ds_write_b128 v7, v[44:47] offset:29696
  s_waitcnt vmcnt(2) lgkmcnt(0)
  s_barrier
  v_xor_b32 v12, 64, v25
  v_add_u32 v12, 147456, v12
  ds_read_b64_tr_b16 v[32:33], v12 offset:0
  ds_read_b64_tr_b16 v[34:35], v12 offset:256
  ds_read_b64_tr_b16 v[36:37], v12 offset:8192
  ds_read_b64_tr_b16 v[38:39], v12 offset:8448
  v_xor_b32 v12, 96, v25
  v_add_u32 v12, 147456, v12
  ds_read_b64_tr_b16 v[120:121], v12 offset:0
  ds_read_b64_tr_b16 v[122:123], v12 offset:256
  ds_read_b64_tr_b16 v[124:125], v12 offset:8192
  ds_read_b64_tr_b16 v[126:127], v12 offset:8448
  v_xor_b32 v12, 224, v25
  v_add_u32 v12, 147456, v12
  ds_read_b64_tr_b16 v[40:41], v12 offset:0
  ds_read_b64_tr_b16 v[42:43], v12 offset:256
  ds_read_b64_tr_b16 v[44:45], v12 offset:8192
  ds_read_b64_tr_b16 v[46:47], v12 offset:8448
  s_waitcnt lgkmcnt(0)
  ds_write_b128 v7, v[32:35] offset:14336
  ds_write_b128 v7, v[36:39] offset:15360
  ds_write_b128 v7, v[40:43] offset:30720
  ds_write_b128 v7, v[44:47] offset:31744
  s_waitcnt lgkmcnt(0)
  s_barrier
  ds_write_b128 v7, v[192:195] offset:32768
  ds_write_b128 v7, v[196:199] offset:33792
  ds_write_b128 v7, v[200:203] offset:34816
  ds_write_b128 v7, v[204:207] offset:35840
  ds_write_b128 v7, v[208:211] offset:36864
  ds_write_b128 v7, v[212:215] offset:37888
  ds_write_b128 v7, v[216:219] offset:38912
  ds_write_b128 v7, v[220:223] offset:39936
  ds_write_b128 v7, v[224:227] offset:40960
  ds_write_b128 v7, v[228:231] offset:41984
  ds_write_b128 v7, v[232:235] offset:43008
  ds_write_b128 v7, v[236:239] offset:44032
  ds_write_b128 v7, v[240:243] offset:45056
  ds_write_b128 v7, v[244:247] offset:46080
  ds_write_b128 v7, v[248:251] offset:47104
  ds_write_b128 v7, v[252:255] offset:48128
  v_lshrrev_b32 v16, 4, v0
  v_and_b32 v17, 15, v0
  v_lshrrev_b32 v18, 3, v17
  v_and_b32 v19, 7, v0
  v_lshlrev_b32 v4, 9, v18
  v_lshl_add_u32 v4, v16, 7, v4
  v_lshl_add_u32 v4, v19, 4, v4
  s_lshl_b32 s45, s32, 11
  s_add_u32 s45, s45, 79626240
  s_lshl_b32 s47, s32, 13
  s_add_u32 s47, s47, 83889152
  s_lshl_b32 s36, s32, 6
  s_add_u32 s36, s36, 84279296
  s_mov_b32 s35, 84938752
  s_mov_b32 s67, 0
  s_mov_b32 s68, 0
  s_add_u32 s46, s46, 16777216
  s_add_u32 s70, s70, 16777216
  s_mov_b32 m0, 24576
  s_waitcnt vmcnt(0) lgkmcnt(0)
  ds_read_b128 v[192:195], v7 offset:0
  ds_read_b128 v[196:199], v7 offset:1024
  ds_read_b128 v[200:203], v7 offset:2048
  ds_read_b128 v[204:207], v7 offset:3072
  ds_read_b128 v[208:211], v7 offset:4096
  ds_read_b128 v[212:215], v7 offset:5120
  ds_read_b128 v[216:219], v7 offset:6144
  ds_read_b128 v[220:223], v7 offset:7168
  ds_read_b128 v[224:227], v7 offset:8192
  ds_read_b128 v[228:231], v7 offset:9216
  ds_read_b128 v[232:235], v7 offset:10240
  ds_read_b128 v[236:239], v7 offset:11264
  ds_read_b128 v[240:243], v7 offset:12288
  ds_read_b128 v[244:247], v7 offset:13312
  ds_read_b128 v[248:251], v7 offset:14336
  ds_read_b128 v[252:255], v7 offset:15360
  s_cmp_eq_u32 s96, 1
  s_cbranch_scc1 cf2_step
  s_branch cs2_step
c_cenw2:
  s_add_u32 s40, s40, 1
  s_cmp_gt_u32 s40, 131072
  s_cbranch_scc1 c_cend2
  buffer_load_dwordx2 v[52:53], off, s[8:11], 0 sc1
  buffer_load_dword v54, off, s[8:11], 0 offset:16 sc1
  s_waitcnt vmcnt(0)
  s_branch c_cen2
c_pro3:
  v_lshrrev_b32 v16, 4, v0
  v_bfe_u32 v17, v0, 1, 3
  v_and_b32 v18, 1, v0
  v_and_b32 v19, 1, v16
  v_lshlrev_b32 v19, 1, v19
  v_xor_b32 v19, v19, v17
  v_lshlrev_b32 v19, 5, v19
  v_lshl_add_u32 v19, v18, 4, v19
  v_lshl_add_u32 v20, v16, 10, v19
  s_lshl_b32 s41, s32, 17
  s_add_u32 s41, s41, 768
  v_xor_b32 v21, 128, v20
  v_add_u32 v20, s41, v20
  v_add_u32 v21, s41, v21
  s_mov_b32 m0, 12288
  s_mov_b32 s41, 0
  buffer_load_dwordx4 v20, s[24:27], s41 offen nt lds
  s_mov_b32 m0, 13312
  s_mov_b32 s41, 4096
  buffer_load_dwordx4 v20, s[24:27], s41 offen nt lds
  s_mov_b32 m0, 14336
  s_mov_b32 s41, 32768
  buffer_load_dwordx4 v21, s[24:27], s41 offen nt lds
  s_mov_b32 m0, 15360
  s_mov_b32 s41, 36864
  buffer_load_dwordx4 v21, s[24:27], s41 offen nt lds
  s_mov_b32 m0, 77824
  s_mov_b32 s41, 8192
  buffer_load_dwordx4 v20, s[24:27], s41 offen nt lds
  s_mov_b32 m0, 78848
  s_mov_b32 s41, 12288
  buffer_load_dwordx4 v20, s[24:27], s41 offen nt lds
  s_mov_b32 m0, 79872
  s_mov_b32 s41, 40960
  buffer_load_dwordx4 v21, s[24:27], s41 offen nt lds
  s_mov_b32 m0, 80896
  s_mov_b32 s41, 45056
  buffer_load_dwordx4 v21, s[24:27], s41 offen nt lds
  s_mov_b32 m0, 126976
  s_mov_b32 s41, 16384
  buffer_load_dwordx4 v20, s[24:27], s41 offen nt lds
  s_mov_b32 m0, 128000
  s_mov_b32 s41, 20480
  buffer_load_dwordx4 v20, s[24:27], s41 offen nt lds
  s_mov_b32 m0, 129024
  s_mov_b32 s41, 49152
  buffer_load_dwordx4 v21, s[24:27], s41 offen nt lds
  s_mov_b32 m0, 130048
  s_mov_b32 s41, 53248
  buffer_load_dwordx4 v21, s[24:27], s41 offen nt lds
  v_mov_b64 v[28:29], -1
  v_mov_b64 v[30:31], -1
  s_lshl_b32 s41, s32, 13
  s_add_u32 s41, s41, 83892224
  buffer_store_dwordx4 v[28:31], v3, s[4:7], s41 offen sc1
  buffer_store_dwordx4 v[28:31], v3, s[4:7], s41 offen offset:1024 sc1
  s_add_u32 s41, s41, 0x40000
  buffer_store_dwordx4 v[28:31], v3, s[4:7], s41 offen sc1
  buffer_store_dwordx4 v[28:31], v3, s[4:7], s41 offen offset:1024 sc1
  s_lshl_b32 s41, s32, 8
  s_add_u32 s41, s41, 85032960
  v_lshlrev_b32 v19, 2, v0
  buffer_store_dword v28, v19, s[4:7], s41 offen sc1
  s_bfe_u32 s41, s32, 0x20001
  s_lshl_b32 s38, s41, 6
  s_lshl_b32 s41, s41, 11
  s_lshr_b32 s42, s32, 3
  s_lshl_b32 s50, s42, 9
  s_add_u32 s38, s38, s50
  s_lshl_b32 s42, s42, 8
  s_add_u32 s41, s41, s42
  s_and_b32 s42, s32, 1
  s_lshl_b32 s50, s42, 8
  s_add_u32 s38, s38, s50
  s_lshl_b32 s42, s42, 4
  s_add_u32 s41, s41, s42
  v_lshrrev_b32 v19, 5, v0
  v_lshlrev_b32 v48, 10, v19
  v_and_b32 v19, 3, v0
  v_lshl_add_u32 v48, v19, 2, v48
  v_and_b32 v19, 1, v16
  v_lshl_add_u32 v48, v19, 1, v48
  buffer_load_ushort v49, v48, s[28:31], s41 offen offset:192
  buffer_load_ushort v50, v48, s[28:31], s41 offen offset:224
  s_lshl_b32 s37, s32, 13
  s_add_u32 s37, s37, 84154368
  s_add_u32 s39, s38, 85006336
  s_add_u32 s38, s38, 84940800
  s_lshl_b32 s46, s32, 13
  s_add_u32 s46, s46, 16777216
  s_add_u32 s70, s46, 16515072
  s_mov_b32 s34, 0
  s_lshl_b32 s71, s32, 7
  s_add_u32 s71, s71, 85200896
  v_lshrrev_b32 v19, 5, v0
  v_xor_b32 v19, 4, v19
  v_xor_b32 v19, v19, v17
  v_lshlrev_b32 v19, 5, v19
  v_lshl_add_u32 v19, v18, 4, v19
  v_lshl_add_u32 v22, v16, 13, v19
  s_lshl_b32 s41, s32, 8
  v_xor_b32 v23, 64, v22
  v_add_u32 v22, s41, v22
  v_add_u32 v23, s41, v23
  v_bfe_u32 v26, v0, 4, 1
  v_lshrrev_b32 v27, 5, v0
  v_bfe_u32 v12, v0, 2, 1
  v_bfe_u32 v13, v0, 3, 1
  v_and_b32 v14, 3, v0
  v_lshlrev_b32 v15, 3, v26
  v_lshl_add_u32 v15, v27, 2, v15
  v_add_u32 v15, v15, v13
  v_lshlrev_b32 v24, 8, v15
  v_lshl_add_u32 v24, v12, 5, v24
  v_lshl_add_u32 v24, v13, 6, v24
  v_lshl_add_u32 v24, v26, 7, v24
  v_lshl_add_u32 v24, v14, 3, v24
  v_lshlrev_b32 v15, 3, v27
  v_lshl_add_u32 v15, v26, 1, v15
  v_lshl_add_u32 v15, v12, 4, v15
  v_lshl_add_u32 v15, v13, 2, v15
  v_lshlrev_b32 v25, 8, v15
  v_lshl_add_u32 v25, v26, 5, v25
  v_lshl_add_u32 v25, v13, 6, v25
  v_lshl_add_u32 v25, v12, 7, v25
  v_lshl_add_u32 v25, v14, 3, v25
  v_lshrrev_b32 v16, 4, v0
  v_and_b32 v17, 15, v0
  v_bfe_u32 v18, v0, 1, 1
  v_mov_b32 v1, 0x88884444
  v_mov_b32 v19, 0xddddeeee
  v_cmp_eq_u32 vcc, 1, v18
  s_nop 1
  v_cndmask_b32 v1, v1, v19, vcc
  v_lshrrev_b32 v18, 2, v17
  v_bfe_u32 v19, v0, 1, 1
  v_lshlrev_b32 v2, 5, v19
  v_lshrrev_b32 v19, 1, v16
  v_lshl_add_u32 v2, v19, 4, v2
  v_and_b32 v19, 1, v0
  v_lshl_add_u32 v2, v19, 3, v2
  v_and_b32 v19, 1, v16
  v_lshl_add_u32 v2, v19, 2, v2
  v_lshlrev_b32 v5, 4, v17
  v_lshl_add_u32 v5, v16, 2, v5
  v_lshlrev_b32 v6, 1, v5
  v_and_b32 v19, 1, v0
  v_lshl_add_u32 v19, v18, 1, v19
  v_lshlrev_b32 v8, 4, v19
  v_lshl_add_u32 v8, v16, 7, v8
  v_and_b32 v19, 7, v0
  v_lshlrev_b32 v10, 3, v19
  v_lshrrev_b32 v19, 3, v0
  v_lshl_add_u32 v10, v19, 13, v10
  s_mov_b32 s43, 0x3e0293ee
  s_mov_b32 s44, 0x35800000
  s_mov_b32 s69, 0x14000000
  v_add_u32 v7, 131072, v3
  s_waitcnt vmcnt(15) lgkmcnt(0)
  s_barrier
  s_mov_b32 m0, 159744
  s_mov_b32 s41, 24576
  buffer_load_dwordx4 v20, s[24:27], s41 offen nt lds
  s_mov_b32 m0, 160768
  s_mov_b32 s41, 28672
  buffer_load_dwordx4 v20, s[24:27], s41 offen nt lds
  s_mov_b32 m0, 161792
  s_mov_b32 s41, 57344
  buffer_load_dwordx4 v21, s[24:27], s41 offen nt lds
  s_mov_b32 m0, 162816
  s_mov_b32 s41, 61440
  buffer_load_dwordx4 v21, s[24:27], s41 offen nt lds
  v_xor_b32 v12, 0, v24
  v_add_u32 v12, 12288, v12
  ds_read_b64_tr_b16 v[128:129], v12 offset:0
  ds_read_b64_tr_b16 v[130:131], v12 offset:512
  v_xor_b32 v12, 64, v24
  v_add_u32 v12, 12288, v12
  ds_read_b64_tr_b16 v[160:161], v12 offset:0
  ds_read_b64_tr_b16 v[162:163], v12 offset:512
  v_xor_b32 v12, 128, v24
  v_add_u32 v12, 12288, v12
  ds_read_b64_tr_b16 v[192:193], v12 offset:0
  ds_read_b64_tr_b16 v[194:195], v12 offset:512
  v_xor_b32 v12, 192, v24
  v_add_u32 v12, 12288, v12
  ds_read_b64_tr_b16 v[224:225], v12 offset:0
  ds_read_b64_tr_b16 v[226:227], v12 offset:512
  s_waitcnt vmcnt(15) lgkmcnt(0)
  s_barrier
  s_mov_b32 m0, 12288
  s_mov_b32 s41, 65536
  buffer_load_dwordx4 v20, s[24:27], s41 offen nt lds
  s_mov_b32 m0, 13312
  s_mov_b32 s41, 69632
  buffer_load_dwordx4 v20, s[24:27], s41 offen nt lds
  s_mov_b32 m0, 14336
  s_mov_b32 s41, 98304
  buffer_load_dwordx4 v21, s[24:27], s41 offen nt lds
  s_mov_b32 m0, 15360
  s_mov_b32 s41, 102400
  buffer_load_dwordx4 v21, s[24:27], s41 offen nt lds
  v_xor_b32 v12, 0, v24
  v_add_u32 v12, 77824, v12
  ds_read_b64_tr_b16 v[132:133], v12 offset:0
  ds_read_b64_tr_b16 v[134:135], v12 offset:512
  v_xor_b32 v12, 64, v24
  v_add_u32 v12, 77824, v12
  ds_read_b64_tr_b16 v[164:165], v12 offset:0
  ds_read_b64_tr_b16 v[166:167], v12 offset:512
  v_xor_b32 v12, 128, v24
  v_add_u32 v12, 77824, v12
  ds_read_b64_tr_b16 v[196:197], v12 offset:0
  ds_read_b64_tr_b16 v[198:199], v12 offset:512
  v_xor_b32 v12, 192, v24
  v_add_u32 v12, 77824, v12
  ds_read_b64_tr_b16 v[228:229], v12 offset:0
  ds_read_b64_tr_b16 v[230:231], v12 offset:512
  s_waitcnt vmcnt(15) lgkmcnt(0)
  s_barrier
  s_mov_b32 m0, 77824
  s_mov_b32 s41, 73728
  buffer_load_dwordx4 v20, s[24:27], s41 offen nt lds
  s_mov_b32 m0, 78848
  s_mov_b32 s41, 77824
  buffer_load_dwordx4 v20, s[24:27], s41 offen nt lds
  s_mov_b32 m0, 79872
  s_mov_b32 s41, 106496
  buffer_load_dwordx4 v21, s[24:27], s41 offen nt lds
  s_mov_b32 m0, 80896
  s_mov_b32 s41, 110592
  buffer_load_dwordx4 v21, s[24:27], s41 offen nt lds
  v_xor_b32 v12, 0, v24
  v_add_u32 v12, 126976, v12
  ds_read_b64_tr_b16 v[136:137], v12 offset:0
  ds_read_b64_tr_b16 v[138:139], v12 offset:512
  v_xor_b32 v12, 64, v24
  v_add_u32 v12, 126976, v12
  ds_read_b64_tr_b16 v[168:169], v12 offset:0
  ds_read_b64_tr_b16 v[170:171], v12 offset:512
  v_xor_b32 v12, 128, v24
  v_add_u32 v12, 126976, v12
  ds_read_b64_tr_b16 v[200:201], v12 offset:0
  ds_read_b64_tr_b16 v[202:203], v12 offset:512
  v_xor_b32 v12, 192, v24
  v_add_u32 v12, 126976, v12
  ds_read_b64_tr_b16 v[232:233], v12 offset:0
  ds_read_b64_tr_b16 v[234:235], v12 offset:512
  s_waitcnt vmcnt(8) lgkmcnt(0)
  s_barrier
  s_mov_b32 m0, 126976
  s_mov_b32 s41, 81920
  buffer_load_dwordx4 v20, s[24:27], s41 offen nt lds
  s_mov_b32 m0, 128000
  s_mov_b32 s41, 86016
  buffer_load_dwordx4 v20, s[24:27], s41 offen nt lds
  s_mov_b32 m0, 129024
  s_mov_b32 s41, 114688
  buffer_load_dwordx4 v21, s[24:27], s41 offen nt lds
  s_mov_b32 m0, 130048
  s_mov_b32 s41, 118784
  buffer_load_dwordx4 v21, s[24:27], s41 offen nt lds
  v_lshl_or_b32 v49, v50, 16, v49
  buffer_store_dword v49, v2, s[4:7], s38 offen sc1
  v_xor_b32 v12, 0, v24
  v_add_u32 v12, 159744, v12
  ds_read_b64_tr_b16 v[140:141], v12 offset:0
  ds_read_b64_tr_b16 v[142:143], v12 offset:512
  v_xor_b32 v12, 64, v24
  v_add_u32 v12, 159744, v12
  ds_read_b64_tr_b16 v[172:173], v12 offset:0
  ds_read_b64_tr_b16 v[174:175], v12 offset:512
  v_xor_b32 v12, 128, v24
  v_add_u32 v12, 159744, v12
  ds_read_b64_tr_b16 v[204:205], v12 offset:0
  ds_read_b64_tr_b16 v[206:207], v12 offset:512
  v_xor_b32 v12, 192, v24
  v_add_u32 v12, 159744, v12
  ds_read_b64_tr_b16 v[236:237], v12 offset:0
  ds_read_b64_tr_b16 v[238:239], v12 offset:512
  s_waitcnt vmcnt(9) lgkmcnt(0)
  s_barrier
  s_mov_b32 m0, 159744
  s_mov_b32 s41, 90112
  buffer_load_dwordx4 v20, s[24:27], s41 offen nt lds
  s_mov_b32 m0, 160768
  s_mov_b32 s41, 94208
  buffer_load_dwordx4 v20, s[24:27], s41 offen nt lds
  s_mov_b32 m0, 161792
  s_mov_b32 s41, 122880
  buffer_load_dwordx4 v21, s[24:27], s41 offen nt lds
  s_mov_b32 m0, 162816
  s_mov_b32 s41, 126976
  buffer_load_dwordx4 v21, s[24:27], s41 offen nt lds
  v_xor_b32 v12, 0, v24
  v_add_u32 v12, 12288, v12
  ds_read_b64_tr_b16 v[144:145], v12 offset:0
  ds_read_b64_tr_b16 v[146:147], v12 offset:512
  v_xor_b32 v12, 64, v24
  v_add_u32 v12, 12288, v12
  ds_read_b64_tr_b16 v[176:177], v12 offset:0
  ds_read_b64_tr_b16 v[178:179], v12 offset:512
  v_xor_b32 v12, 128, v24
  v_add_u32 v12, 12288, v12
  ds_read_b64_tr_b16 v[208:209], v12 offset:0
  ds_read_b64_tr_b16 v[210:211], v12 offset:512
  v_xor_b32 v12, 192, v24
  v_add_u32 v12, 12288, v12
  ds_read_b64_tr_b16 v[240:241], v12 offset:0
  ds_read_b64_tr_b16 v[242:243], v12 offset:512
  s_waitcnt vmcnt(9) lgkmcnt(0)
  s_barrier
  s_mov_b32 m0, 12288
  s_mov_b32 s41, 1179648
  buffer_load_dwordx4 v22, s[12:15], s41 offen nt lds
  s_mov_b32 m0, 13312
  s_mov_b32 s41, 1212416
  buffer_load_dwordx4 v23, s[12:15], s41 offen nt lds
  s_mov_b32 m0, 14336
  s_mov_b32 s41, 1245184
  buffer_load_dwordx4 v22, s[12:15], s41 offen nt lds
  s_mov_b32 m0, 15360
  s_mov_b32 s41, 1277952
  buffer_load_dwordx4 v23, s[12:15], s41 offen nt lds
  v_xor_b32 v12, 0, v24
  v_add_u32 v12, 77824, v12
  ds_read_b64_tr_b16 v[148:149], v12 offset:0
  ds_read_b64_tr_b16 v[150:151], v12 offset:512
  v_xor_b32 v12, 64, v24
  v_add_u32 v12, 77824, v12
  ds_read_b64_tr_b16 v[180:181], v12 offset:0
  ds_read_b64_tr_b16 v[182:183], v12 offset:512
  v_xor_b32 v12, 128, v24
  v_add_u32 v12, 77824, v12
  ds_read_b64_tr_b16 v[212:213], v12 offset:0
  ds_read_b64_tr_b16 v[214:215], v12 offset:512
  v_xor_b32 v12, 192, v24
  v_add_u32 v12, 77824, v12
  ds_read_b64_tr_b16 v[244:245], v12 offset:0
  ds_read_b64_tr_b16 v[246:247], v12 offset:512
  s_waitcnt vmcnt(9) lgkmcnt(0)
  s_barrier
  s_mov_b32 m0, 77824
  s_mov_b32 s41, 3276800
  buffer_load_dwordx4 v22, s[12:15], s41 offen nt lds
  s_mov_b32 m0, 78848
  s_mov_b32 s41, 3309568
  buffer_load_dwordx4 v23, s[12:15], s41 offen nt lds
  s_mov_b32 m0, 79872
  s_mov_b32 s41, 3342336
  buffer_load_dwordx4 v22, s[12:15], s41 offen nt lds
  s_mov_b32 m0, 80896
  s_mov_b32 s41, 3375104
  buffer_load_dwordx4 v23, s[12:15], s41 offen nt lds
  v_xor_b32 v12, 0, v24
  v_add_u32 v12, 126976, v12
  ds_read_b64_tr_b16 v[152:153], v12 offset:0
  ds_read_b64_tr_b16 v[154:155], v12 offset:512
  v_xor_b32 v12, 64, v24
  v_add_u32 v12, 126976, v12
  ds_read_b64_tr_b16 v[184:185], v12 offset:0
  ds_read_b64_tr_b16 v[186:187], v12 offset:512
  v_xor_b32 v12, 128, v24
  v_add_u32 v12, 126976, v12
  ds_read_b64_tr_b16 v[216:217], v12 offset:0
  ds_read_b64_tr_b16 v[218:219], v12 offset:512
  v_xor_b32 v12, 192, v24
  v_add_u32 v12, 126976, v12
  ds_read_b64_tr_b16 v[248:249], v12 offset:0
  ds_read_b64_tr_b16 v[250:251], v12 offset:512
  s_waitcnt vmcnt(8) lgkmcnt(0)
  s_barrier
  s_mov_b32 m0, 126976
  s_mov_b32 s41, 1441792
  buffer_load_dwordx4 v22, s[12:15], s41 offen nt lds
  s_mov_b32 m0, 128000
  s_mov_b32 s41, 1474560
  buffer_load_dwordx4 v23, s[12:15], s41 offen nt lds
  s_mov_b32 m0, 129024
  s_mov_b32 s41, 1507328
  buffer_load_dwordx4 v22, s[12:15], s41 offen nt lds
  s_mov_b32 m0, 130048
  s_mov_b32 s41, 1540096
  buffer_load_dwordx4 v23, s[12:15], s41 offen nt lds
  v_xor_b32 v12, 0, v24
  v_add_u32 v12, 159744, v12
  ds_read_b64_tr_b16 v[156:157], v12 offset:0
  ds_read_b64_tr_b16 v[158:159], v12 offset:512
  v_xor_b32 v12, 64, v24
  v_add_u32 v12, 159744, v12
  ds_read_b64_tr_b16 v[188:189], v12 offset:0
  ds_read_b64_tr_b16 v[190:191], v12 offset:512
  v_xor_b32 v12, 128, v24
  v_add_u32 v12, 159744, v12
  ds_read_b64_tr_b16 v[220:221], v12 offset:0
  ds_read_b64_tr_b16 v[222:223], v12 offset:512
  v_xor_b32 v12, 192, v24
  v_add_u32 v12, 159744, v12
  ds_read_b64_tr_b16 v[252:253], v12 offset:0
  ds_read_b64_tr_b16 v[254:255], v12 offset:512
  s_waitcnt vmcnt(8) lgkmcnt(0)
  s_barrier
  s_mov_b32 m0, 159744
  s_mov_b32 s41, 3538944
  buffer_load_dwordx4 v22, s[12:15], s41 offen nt lds
  s_mov_b32 m0, 160768
  s_mov_b32 s41, 3571712
  buffer_load_dwordx4 v23, s[12:15], s41 offen nt lds
  s_mov_b32 m0, 161792
  s_mov_b32 s41, 3604480
  buffer_load_dwordx4 v22, s[12:15], s41 offen nt lds
  s_mov_b32 m0, 162816
  s_mov_b32 s41, 3637248
  buffer_load_dwordx4 v23, s[12:15], s41 offen nt lds
  v_xor_b32 v12, 192, v25
  v_add_u32 v12, 0, v12
  ds_read_b64_tr_b16 a[0:1], v12 offset:0
  ds_read_b64_tr_b16 a[2:3], v12 offset:256
  ds_read_b64_tr_b16 a[4:5], v12 offset:8192
  ds_read_b64_tr_b16 a[6:7], v12 offset:8448
  v_xor_b32 v12, 224, v25
  v_add_u32 v12, 0, v12
  ds_read_b64_tr_b16 a[64:65], v12 offset:0
  ds_read_b64_tr_b16 a[66:67], v12 offset:256
  ds_read_b64_tr_b16 a[68:69], v12 offset:8192
  ds_read_b64_tr_b16 a[70:71], v12 offset:8448
  s_waitcnt vmcnt(8) lgkmcnt(0)
  s_barrier
  s_mov_b32 m0, 12288
  s_mov_b32 s41, 1703936
  buffer_load_dwordx4 v22, s[12:15], s41 offen nt lds
  s_mov_b32 m0, 13312
  s_mov_b32 s41, 1736704
  buffer_load_dwordx4 v23, s[12:15], s41 offen nt lds
  s_mov_b32 m0, 14336
  s_mov_b32 s41, 1769472
  buffer_load_dwordx4 v22, s[12:15], s41 offen nt lds
  s_mov_b32 m0, 15360
  s_mov_b32 s41, 1802240
  buffer_load_dwordx4 v23, s[12:15], s41 offen nt lds
  v_xor_b32 v12, 192, v25
  v_add_u32 v12, 65536, v12
  ds_read_b64_tr_b16 a[8:9], v12 offset:0
  ds_read_b64_tr_b16 a[10:11], v12 offset:256
  ds_read_b64_tr_b16 a[12:13], v12 offset:8192
  ds_read_b64_tr_b16 a[14:15], v12 offset:8448
  v_xor_b32 v12, 224, v25
  v_add_u32 v12, 65536, v12
  ds_read_b64_tr_b16 a[72:73], v12 offset:0
  ds_read_b64_tr_b16 a[74:75], v12 offset:256
  ds_read_b64_tr_b16 a[76:77], v12 offset:8192
  ds_read_b64_tr_b16 a[78:79], v12 offset:8448
  s_waitcnt vmcnt(8) lgkmcnt(0)
  s_barrier
  s_mov_b32 m0, 77824
  s_mov_b32 s41, 3801088
  buffer_load_dwordx4 v22, s[12:15], s41 offen nt lds
  s_mov_b32 m0, 78848
  s_mov_b32 s41, 3833856
  buffer_load_dwordx4 v23, s[12:15], s41 offen nt lds
  s_mov_b32 m0, 79872
  s_mov_b32 s41, 3866624
  buffer_load_dwordx4 v22, s[12:15], s41 offen nt lds
  s_mov_b32 m0, 80896
  s_mov_b32 s41, 3899392
  buffer_load_dwordx4 v23, s[12:15], s41 offen nt lds
  v_xor_b32 v12, 192, v25
  v_add_u32 v12, 114688, v12
  ds_read_b64_tr_b16 a[16:17], v12 offset:0
  ds_read_b64_tr_b16 a[18:19], v12 offset:256
  ds_read_b64_tr_b16 a[20:21], v12 offset:8192
  ds_read_b64_tr_b16 a[22:23], v12 offset:8448
  v_xor_b32 v12, 224, v25
  v_add_u32 v12, 114688, v12
  ds_read_b64_tr_b16 a[80:81], v12 offset:0
  ds_read_b64_tr_b16 a[82:83], v12 offset:256
  ds_read_b64_tr_b16 a[84:85], v12 offset:8192
  ds_read_b64_tr_b16 a[86:87], v12 offset:8448
  s_waitcnt vmcnt(8) lgkmcnt(0)
  s_barrier
  s_mov_b32 m0, 126976
  s_mov_b32 s41, 1966080
  buffer_load_dwordx4 v22, s[12:15], s41 offen nt lds
  s_mov_b32 m0, 128000
  s_mov_b32 s41, 1998848
  buffer_load_dwordx4 v23, s[12:15], s41 offen nt lds
  s_mov_b32 m0, 129024
  s_mov_b32 s41, 2031616
  buffer_load_dwordx4 v22, s[12:15], s41 offen nt lds
  s_mov_b32 m0, 130048
  s_mov_b32 s41, 2064384
  buffer_load_dwordx4 v23, s[12:15], s41 offen nt lds
  v_xor_b32 v12, 192, v25
  v_add_u32 v12, 147456, v12
  ds_read_b64_tr_b16 a[24:25], v12 offset:0
  ds_read_b64_tr_b16 a[26:27], v12 offset:256
  ds_read_b64_tr_b16 a[28:29], v12 offset:8192
  ds_read_b64_tr_b16 a[30:31], v12 offset:8448
  v_xor_b32 v12, 224, v25
  v_add_u32 v12, 147456, v12
  ds_read_b64_tr_b16 a[88:89], v12 offset:0
  ds_read_b64_tr_b16 a[90:91], v12 offset:256
  ds_read_b64_tr_b16 a[92:93], v12 offset:8192
  ds_read_b64_tr_b16 a[94:95], v12 offset:8448
  s_waitcnt vmcnt(8) lgkmcnt(0)
  s_barrier
  s_mov_b32 m0, 159744
  s_mov_b32 s41, 4063232
  buffer_load_dwordx4 v22, s[12:15], s41 offen nt lds
  s_mov_b32 m0, 160768
  s_mov_b32 s41, 4096000
  buffer_load_dwordx4 v23, s[12:15], s41 offen nt lds
  s_mov_b32 m0, 161792
  s_mov_b32 s41, 4128768
  buffer_load_dwordx4 v22, s[12:15], s41 offen nt lds
  s_mov_b32 m0, 162816
  s_mov_b32 s41, 4161536
  buffer_load_dwordx4 v23, s[12:15], s41 offen nt lds
  v_xor_b32 v12, 192, v25
  v_add_u32 v12, 0, v12
  ds_read_b64_tr_b16 a[32:33], v12 offset:0
  ds_read_b64_tr_b16 a[34:35], v12 offset:256
  ds_read_b64_tr_b16 a[36:37], v12 offset:8192
  ds_read_b64_tr_b16 a[38:39], v12 offset:8448
  v_xor_b32 v12, 224, v25
  v_add_u32 v12, 0, v12
  ds_read_b64_tr_b16 a[96:97], v12 offset:0
  ds_read_b64_tr_b16 a[98:99], v12 offset:256
  ds_read_b64_tr_b16 a[100:101], v12 offset:8192
  ds_read_b64_tr_b16 a[102:103], v12 offset:8448
  s_waitcnt vmcnt(8) lgkmcnt(0)
  s_barrier
  s_mov_b32 m0, 12288
  s_mov_b32 s41, 1179648
  buffer_load_dwordx4 v22, s[16:19], s41 offen nt lds
  s_mov_b32 m0, 13312
  s_mov_b32 s41, 1212416
  buffer_load_dwordx4 v23, s[16:19], s41 offen nt lds
  s_mov_b32 m0, 14336
  s_mov_b32 s41, 1245184
  buffer_load_dwordx4 v22, s[16:19], s41 offen nt lds
  s_mov_b32 m0, 15360
  s_mov_b32 s41, 1277952
  buffer_load_dwordx4 v23, s[16:19], s41 offen nt lds
  v_xor_b32 v12, 192, v25
  v_add_u32 v12, 65536, v12
  ds_read_b64_tr_b16 a[40:41], v12 offset:0
  ds_read_b64_tr_b16 a[42:43], v12 offset:256
  ds_read_b64_tr_b16 a[44:45], v12 offset:8192
  ds_read_b64_tr_b16 a[46:47], v12 offset:8448
  v_xor_b32 v12, 224, v25
  v_add_u32 v12, 65536, v12
  ds_read_b64_tr_b16 a[104:105], v12 offset:0
  ds_read_b64_tr_b16 a[106:107], v12 offset:256
  ds_read_b64_tr_b16 a[108:109], v12 offset:8192
  ds_read_b64_tr_b16 a[110:111], v12 offset:8448
  s_waitcnt vmcnt(8) lgkmcnt(0)
  s_barrier
  s_mov_b32 m0, 77824
  s_mov_b32 s41, 3276800
  buffer_load_dwordx4 v22, s[16:19], s41 offen nt lds
  s_mov_b32 m0, 78848
  s_mov_b32 s41, 3309568
  buffer_load_dwordx4 v23, s[16:19], s41 offen nt lds
  s_mov_b32 m0, 79872
  s_mov_b32 s41, 3342336
  buffer_load_dwordx4 v22, s[16:19], s41 offen nt lds
  s_mov_b32 m0, 80896
  s_mov_b32 s41, 3375104
  buffer_load_dwordx4 v23, s[16:19], s41 offen nt lds
  v_xor_b32 v12, 192, v25
  v_add_u32 v12, 114688, v12
  ds_read_b64_tr_b16 a[48:49], v12 offset:0
  ds_read_b64_tr_b16 a[50:51], v12 offset:256
  ds_read_b64_tr_b16 a[52:53], v12 offset:8192
  ds_read_b64_tr_b16 a[54:55], v12 offset:8448
  v_xor_b32 v12, 224, v25
  v_add_u32 v12, 114688, v12
  ds_read_b64_tr_b16 a[112:113], v12 offset:0
  ds_read_b64_tr_b16 a[114:115], v12 offset:256
  ds_read_b64_tr_b16 a[116:117], v12 offset:8192
  ds_read_b64_tr_b16 a[118:119], v12 offset:8448
  s_waitcnt vmcnt(8) lgkmcnt(0)
  s_barrier
  s_mov_b32 m0, 126976
  s_mov_b32 s41, 1441792
  buffer_load_dwordx4 v22, s[16:19], s41 offen nt lds
  s_mov_b32 m0, 128000
  s_mov_b32 s41, 1474560
  buffer_load_dwordx4 v23, s[16:19], s41 offen nt lds
  s_mov_b32 m0, 129024
  s_mov_b32 s41, 1507328
  buffer_load_dwordx4 v22, s[16:19], s41 offen nt lds
  s_mov_b32 m0, 130048
  s_mov_b32 s41, 1540096
  buffer_load_dwordx4 v23, s[16:19], s41 offen nt lds
  v_xor_b32 v12, 192, v25
  v_add_u32 v12, 147456, v12
  ds_read_b64_tr_b16 a[56:57], v12 offset:0
  ds_read_b64_tr_b16 a[58:59], v12 offset:256
  ds_read_b64_tr_b16 a[60:61], v12 offset:8192
  ds_read_b64_tr_b16 a[62:63], v12 offset:8448
  v_xor_b32 v12, 224, v25
  v_add_u32 v12, 147456, v12
  ds_read_b64_tr_b16 a[120:121], v12 offset:0
  ds_read_b64_tr_b16 a[122:123], v12 offset:256
  ds_read_b64_tr_b16 a[124:125], v12 offset:8192
  ds_read_b64_tr_b16 a[126:127], v12 offset:8448
  s_waitcnt vmcnt(8) lgkmcnt(0)
  s_barrier
  s_mov_b32 m0, 159744
  s_mov_b32 s41, 3538944
  buffer_load_dwordx4 v22, s[16:19], s41 offen nt lds
  s_mov_b32 m0, 160768
  s_mov_b32 s41, 3571712
  buffer_load_dwordx4 v23, s[16:19], s41 offen nt lds
  s_mov_b32 m0, 161792
  s_mov_b32 s41, 3604480
  buffer_load_dwordx4 v22, s[16:19], s41 offen nt lds
  s_mov_b32 m0, 162816
  s_mov_b32 s41, 3637248
  buffer_load_dwordx4 v23, s[16:19], s41 offen nt lds
  v_xor_b32 v12, 192, v25
  v_add_u32 v12, 0, v12
  ds_read_b64_tr_b16 a[128:129], v12 offset:0
  ds_read_b64_tr_b16 a[130:131], v12 offset:256
  ds_read_b64_tr_b16 a[132:133], v12 offset:8192
  ds_read_b64_tr_b16 a[134:135], v12 offset:8448
  v_xor_b32 v12, 224, v25
  v_add_u32 v12, 0, v12
  ds_read_b64_tr_b16 a[192:193], v12 offset:0
  ds_read_b64_tr_b16 a[194:195], v12 offset:256
  ds_read_b64_tr_b16 a[196:197], v12 offset:8192
  ds_read_b64_tr_b16 a[198:199], v12 offset:8448
  s_waitcnt vmcnt(8) lgkmcnt(0)
  s_barrier
  s_mov_b32 m0, 12288
  s_mov_b32 s41, 1703936
  buffer_load_dwordx4 v22, s[16:19], s41 offen nt lds
  s_mov_b32 m0, 13312
  s_mov_b32 s41, 1736704
  buffer_load_dwordx4 v23, s[16:19], s41 offen nt lds
  s_mov_b32 m0, 14336
  s_mov_b32 s41, 1769472
  buffer_load_dwordx4 v22, s[16:19], s41 offen nt lds
  s_mov_b32 m0, 15360
  s_mov_b32 s41, 1802240
  buffer_load_dwordx4 v23, s[16:19], s41 offen nt lds
  v_xor_b32 v12, 192, v25
  v_add_u32 v12, 65536, v12
  ds_read_b64_tr_b16 a[136:137], v12 offset:0
  ds_read_b64_tr_b16 a[138:139], v12 offset:256
  ds_read_b64_tr_b16 a[140:141], v12 offset:8192
  ds_read_b64_tr_b16 a[142:143], v12 offset:8448
  v_xor_b32 v12, 224, v25
  v_add_u32 v12, 65536, v12
  ds_read_b64_tr_b16 a[200:201], v12 offset:0
  ds_read_b64_tr_b16 a[202:203], v12 offset:256
  ds_read_b64_tr_b16 a[204:205], v12 offset:8192
  ds_read_b64_tr_b16 a[206:207], v12 offset:8448
  s_waitcnt vmcnt(8) lgkmcnt(0)
  s_barrier
  s_mov_b32 m0, 77824
  s_mov_b32 s41, 3801088
  buffer_load_dwordx4 v22, s[16:19], s41 offen nt lds
  s_mov_b32 m0, 78848
  s_mov_b32 s41, 3833856
  buffer_load_dwordx4 v23, s[16:19], s41 offen nt lds
  s_mov_b32 m0, 79872
  s_mov_b32 s41, 3866624
  buffer_load_dwordx4 v22, s[16:19], s41 offen nt lds
  s_mov_b32 m0, 80896
  s_mov_b32 s41, 3899392
  buffer_load_dwordx4 v23, s[16:19], s41 offen nt lds
  buffer_load_dwordx2 v[52:53], off, s[8:11], 0 sc1
  buffer_load_dword v54, off, s[8:11], 0 offset:16 sc1
  s_mov_b32 s40, 0
  v_xor_b32 v12, 192, v25
  v_add_u32 v12, 114688, v12
  ds_read_b64_tr_b16 a[144:145], v12 offset:0
  ds_read_b64_tr_b16 a[146:147], v12 offset:256
  ds_read_b64_tr_b16 a[148:149], v12 offset:8192
  ds_read_b64_tr_b16 a[150:151], v12 offset:8448
  v_xor_b32 v12, 224, v25
  v_add_u32 v12, 114688, v12
  ds_read_b64_tr_b16 a[208:209], v12 offset:0
  ds_read_b64_tr_b16 a[210:211], v12 offset:256
  ds_read_b64_tr_b16 a[212:213], v12 offset:8192
  ds_read_b64_tr_b16 a[214:215], v12 offset:8448
  s_waitcnt vmcnt(10) lgkmcnt(0)
  s_barrier
  s_mov_b32 m0, 126976
  s_mov_b32 s41, 1966080
  buffer_load_dwordx4 v22, s[16:19], s41 offen nt lds
  s_mov_b32 m0, 128000
  s_mov_b32 s41, 1998848
  buffer_load_dwordx4 v23, s[16:19], s41 offen nt lds
  s_mov_b32 m0, 129024
  s_mov_b32 s41, 2031616
  buffer_load_dwordx4 v22, s[16:19], s41 offen nt lds
  s_mov_b32 m0, 130048
  s_mov_b32 s41, 2064384
  buffer_load_dwordx4 v23, s[16:19], s41 offen nt lds
  v_xor_b32 v12, 192, v25
  v_add_u32 v12, 147456, v12
  ds_read_b64_tr_b16 a[152:153], v12 offset:0
  ds_read_b64_tr_b16 a[154:155], v12 offset:256
  ds_read_b64_tr_b16 a[156:157], v12 offset:8192
  ds_read_b64_tr_b16 a[158:159], v12 offset:8448
  v_xor_b32 v12, 224, v25
  v_add_u32 v12, 147456, v12
  ds_read_b64_tr_b16 a[216:217], v12 offset:0
  ds_read_b64_tr_b16 a[218:219], v12 offset:256
  ds_read_b64_tr_b16 a[220:221], v12 offset:8192
  ds_read_b64_tr_b16 a[222:223], v12 offset:8448
  s_waitcnt vmcnt(10) lgkmcnt(0)
  s_barrier
  s_mov_b32 m0, 159744
  s_mov_b32 s41, 4063232
  buffer_load_dwordx4 v22, s[16:19], s41 offen nt lds
  s_mov_b32 m0, 160768
  s_mov_b32 s41, 4096000
  buffer_load_dwordx4 v23, s[16:19], s41 offen nt lds
  s_mov_b32 m0, 161792
  s_mov_b32 s41, 4128768
  buffer_load_dwordx4 v22, s[16:19], s41 offen nt lds
  s_mov_b32 m0, 162816
  s_mov_b32 s41, 4161536
  buffer_load_dwordx4 v23, s[16:19], s41 offen nt lds
  v_xor_b32 v12, 192, v25
  v_add_u32 v12, 0, v12
  ds_read_b64_tr_b16 a[160:161], v12 offset:0
  ds_read_b64_tr_b16 a[162:163], v12 offset:256
  ds_read_b64_tr_b16 a[164:165], v12 offset:8192
  ds_read_b64_tr_b16 a[166:167], v12 offset:8448
  v_xor_b32 v12, 224, v25
  v_add_u32 v12, 0, v12
  ds_read_b64_tr_b16 a[224:225], v12 offset:0
  ds_read_b64_tr_b16 a[226:227], v12 offset:256
  ds_read_b64_tr_b16 a[228:229], v12 offset:8192
  ds_read_b64_tr_b16 a[230:231], v12 offset:8448
  s_waitcnt vmcnt(10) lgkmcnt(0)
  s_barrier
  s_mov_b32 m0, 12288
  s_mov_b32 s41, 1179648
  buffer_load_dwordx4 v22, s[20:23], s41 offen nt lds
  s_mov_b32 m0, 13312
  s_mov_b32 s41, 1212416
  buffer_load_dwordx4 v23, s[20:23], s41 offen nt lds
  s_mov_b32 m0, 14336
  s_mov_b32 s41, 1245184
  buffer_load_dwordx4 v22, s[20:23], s41 offen nt lds
  s_mov_b32 m0, 15360
  s_mov_b32 s41, 1277952
  buffer_load_dwordx4 v23, s[20:23], s41 offen nt lds
  v_xor_b32 v12, 192, v25
  v_add_u32 v12, 65536, v12
  ds_read_b64_tr_b16 a[168:169], v12 offset:0
  ds_read_b64_tr_b16 a[170:171], v12 offset:256
  ds_read_b64_tr_b16 a[172:173], v12 offset:8192
  ds_read_b64_tr_b16 a[174:175], v12 offset:8448
  v_xor_b32 v12, 224, v25
  v_add_u32 v12, 65536, v12
  ds_read_b64_tr_b16 a[232:233], v12 offset:0
  ds_read_b64_tr_b16 a[234:235], v12 offset:256
  ds_read_b64_tr_b16 a[236:237], v12 offset:8192
  ds_read_b64_tr_b16 a[238:239], v12 offset:8448
  s_waitcnt vmcnt(8) lgkmcnt(0)
  s_barrier
  s_mov_b32 m0, 77824
  s_mov_b32 s41, 3276800
  buffer_load_dwordx4 v22, s[20:23], s41 offen nt lds
  s_mov_b32 m0, 78848
  s_mov_b32 s41, 3309568
  buffer_load_dwordx4 v23, s[20:23], s41 offen nt lds
  s_mov_b32 m0, 79872
  s_mov_b32 s41, 3342336
  buffer_load_dwordx4 v22, s[20:23], s41 offen nt lds
  s_mov_b32 m0, 80896
  s_mov_b32 s41, 3375104
  buffer_load_dwordx4 v23, s[20:23], s41 offen nt lds
c_cen3:
  s_getreg_b32 s50, hwreg(HW_REG_XCC_ID, 0, 3)
  s_mul_i32 s50, s50, 6
  s_lshl_b64 s[56:57], 32, s50
  v_readfirstlane_b32 s58, v52
  v_readfirstlane_b32 s59, v53
  v_readfirstlane_b32 s50, v54
  s_cmp_eq_u64 s[56:57], s[58:59]
  s_cselect_b32 s96, 1, 0
  s_mov_b32 s41, 0
  s_and_b32 s42, s58, 63
  s_add_u32 s41, s41, s42
  s_lshr_b64 s[58:59], s[58:59], 6
  s_and_b32 s42, s58, 63
  s_add_u32 s41, s41, s42
  s_lshr_b64 s[58:59], s[58:59], 6
  s_and_b32 s42, s58, 63
  s_add_u32 s41, s41, s42
  s_lshr_b64 s[58:59], s[58:59], 6
  s_and_b32 s42, s58, 63
  s_add_u32 s41, s41, s42
  s_lshr_b64 s[58:59], s[58:59], 6
  s_and_b32 s42, s58, 63
  s_add_u32 s41, s41, s42
  s_lshr_b64 s[58:59], s[58:59], 6
  s_and_b32 s42, s58, 63
  s_add_u32 s41, s41, s42
  s_lshr_b64 s[58:59], s[58:59], 6
  s_and_b32 s42, s58, 63
  s_add_u32 s41, s41, s42
  s_lshr_b64 s[58:59], s[58:59], 6
  s_and_b32 s42, s58, 63
  s_add_u32 s41, s41, s42
  s_lshr_b64 s[58:59], s[58:59], 6
  s_mul_i32 s41, s41, s50
  s_cmp_lg_u32 s41, 32
  s_cbranch_scc1 c_cenw3
c_cend3:
  v_xor_b32 v12, 192, v25
  v_add_u32 v12, 114688, v12
  ds_read_b64_tr_b16 a[176:177], v12 offset:0
  ds_read_b64_tr_b16 a[178:179], v12 offset:256
  ds_read_b64_tr_b16 a[180:181], v12 offset:8192
  ds_read_b64_tr_b16 a[182:183], v12 offset:8448
  v_xor_b32 v12, 224, v25
  v_add_u32 v12, 114688, v12
  ds_read_b64_tr_b16 a[240:241], v12 offset:0
  ds_read_b64_tr_b16 a[242:243], v12 offset:256
  ds_read_b64_tr_b16 a[244:245], v12 offset:8192
  ds_read_b64_tr_b16 a[246:247], v12 offset:8448
  s_waitcnt vmcnt(8) lgkmcnt(0)
  s_barrier
  s_mov_b32 m0, 126976
  s_mov_b32 s41, 1441792
  buffer_load_dwordx4 v22, s[20:23], s41 offen nt lds
  s_mov_b32 m0, 128000
  s_mov_b32 s41, 1474560
  buffer_load_dwordx4 v23, s[20:23], s41 offen nt lds
  s_mov_b32 m0, 129024
  s_mov_b32 s41, 1507328
  buffer_load_dwordx4 v22, s[20:23], s41 offen nt lds
  s_mov_b32 m0, 130048
  s_mov_b32 s41, 1540096
  buffer_load_dwordx4 v23, s[20:23], s41 offen nt lds
  v_xor_b32 v12, 192, v25
  v_add_u32 v12, 147456, v12
  ds_read_b64_tr_b16 a[184:185], v12 offset:0
  ds_read_b64_tr_b16 a[186:187], v12 offset:256
  ds_read_b64_tr_b16 a[188:189], v12 offset:8192
  ds_read_b64_tr_b16 a[190:191], v12 offset:8448
  v_xor_b32 v12, 224, v25
  v_add_u32 v12, 147456, v12
  ds_read_b64_tr_b16 a[248:249], v12 offset:0
  ds_read_b64_tr_b16 a[250:251], v12 offset:256
  ds_read_b64_tr_b16 a[252:253], v12 offset:8192
  ds_read_b64_tr_b16 a[254:255], v12 offset:8448
  s_waitcnt vmcnt(8) lgkmcnt(0)
  s_barrier
  s_mov_b32 m0, 159744
  s_mov_b32 s41, 3538944
  buffer_load_dwordx4 v22, s[20:23], s41 offen nt lds
  s_mov_b32 m0, 160768
  s_mov_b32 s41, 3571712
  buffer_load_dwordx4 v23, s[20:23], s41 offen nt lds
  s_mov_b32 m0, 161792
  s_mov_b32 s41, 3604480
  buffer_load_dwordx4 v22, s[20:23], s41 offen nt lds
  s_mov_b32 m0, 162816
  s_mov_b32 s41, 3637248
  buffer_load_dwordx4 v23, s[20:23], s41 offen nt lds
  v_xor_b32 v12, 128, v25
  v_add_u32 v12, 0, v12
  ds_read_b64_tr_b16 v[32:33], v12 offset:0
  ds_read_b64_tr_b16 v[34:35], v12 offset:256
  ds_read_b64_tr_b16 v[36:37], v12 offset:8192
  ds_read_b64_tr_b16 v[38:39], v12 offset:8448
  v_xor_b32 v12, 160, v25
  v_add_u32 v12, 0, v12
  ds_read_b64_tr_b16 v[64:65], v12 offset:0
  ds_read_b64_tr_b16 v[66:67], v12 offset:256
  ds_read_b64_tr_b16 v[68:69], v12 offset:8192
  ds_read_b64_tr_b16 v[70:71], v12 offset:8448
  s_waitcnt lgkmcnt(0)
  ds_write_b128 v7, v[32:35] offset:0
  ds_write_b128 v7, v[36:39] offset:1024
  s_waitcnt vmcnt(8) lgkmcnt(0)
  s_barrier
  s_mov_b32 m0, 12288
  s_mov_b32 s41, 1703936
  buffer_load_dwordx4 v22, s[20:23], s41 offen nt lds
  s_mov_b32 m0, 13312
  s_mov_b32 s41, 1736704
  buffer_load_dwordx4 v23, s[20:23], s41 offen nt lds
  s_mov_b32 m0, 14336
  s_mov_b32 s41, 1769472
  buffer_load_dwordx4 v22, s[20:23], s41 offen nt lds
  s_mov_b32 m0, 15360
  s_mov_b32 s41, 1802240
  buffer_load_dwordx4 v23, s[20:23], s41 offen nt lds
  v_xor_b32 v12, 128, v25
  v_add_u32 v12, 65536, v12
  ds_read_b64_tr_b16 v[32:33], v12 offset:0
  ds_read_b64_tr_b16 v[34:35], v12 offset:256
  ds_read_b64_tr_b16 v[36:37], v12 offset:8192
  ds_read_b64_tr_b16 v[38:39], v12 offset:8448
  v_xor_b32 v12, 160, v25
  v_add_u32 v12, 65536, v12
  ds_read_b64_tr_b16 v[72:73], v12 offset:0
  ds_read_b64_tr_b16 v[74:75], v12 offset:256
  ds_read_b64_tr_b16 v[76:77], v12 offset:8192
  ds_read_b64_tr_b16 v[78:79], v12 offset:8448
  s_waitcnt lgkmcnt(0)
  ds_write_b128 v7, v[32:35] offset:2048
  ds_write_b128 v7, v[36:39] offset:3072
  s_waitcnt vmcnt(8) lgkmcnt(0)
  s_barrier
  s_mov_b32 m0, 77824
  s_mov_b32 s41, 3801088
  buffer_load_dwordx4 v22, s[20:23], s41 offen nt lds
  s_mov_b32 m0, 78848
  s_mov_b32 s41, 3833856
  buffer_load_dwordx4 v23, s[20:23], s41 offen nt lds
  s_mov_b32 m0, 79872
  s_mov_b32 s41, 3866624
  buffer_load_dwordx4 v22, s[20:23], s41 offen nt lds
  s_mov_b32 m0, 80896
  s_mov_b32 s41, 3899392
  buffer_load_dwordx4 v23, s[20:23], s41 offen nt lds
  v_xor_b32 v12, 128, v25
  v_add_u32 v12, 114688, v12
  ds_read_b64_tr_b16 v[32:33], v12 offset:0
  ds_read_b64_tr_b16 v[34:35], v12 offset:256
  ds_read_b64_tr_b16 v[36:37], v12 offset:8192
  ds_read_b64_tr_b16 v[38:39], v12 offset:8448
  v_xor_b32 v12, 160, v25
  v_add_u32 v12, 114688, v12
  ds_read_b64_tr_b16 v[80:81], v12 offset:0
  ds_read_b64_tr_b16 v[82:83], v12 offset:256
  ds_read_b64_tr_b16 v[84:85], v12 offset:8192
  ds_read_b64_tr_b16 v[86:87], v12 offset:8448
  s_waitcnt lgkmcnt(0)
  ds_write_b128 v7, v[32:35] offset:4096
  ds_write_b128 v7, v[36:39] offset:5120
  s_waitcnt vmcnt(8) lgkmcnt(0)
  s_barrier
  s_mov_b32 m0, 126976
  s_mov_b32 s41, 1966080
  buffer_load_dwordx4 v22, s[20:23], s41 offen nt lds
  s_mov_b32 m0, 128000
  s_mov_b32 s41, 1998848
  buffer_load_dwordx4 v23, s[20:23], s41 offen nt lds
  s_mov_b32 m0, 129024
  s_mov_b32 s41, 2031616
  buffer_load_dwordx4 v22, s[20:23], s41 offen nt lds
  s_mov_b32 m0, 130048
  s_mov_b32 s41, 2064384
  buffer_load_dwordx4 v23, s[20:23], s41 offen nt lds
  v_xor_b32 v12, 128, v25
  v_add_u32 v12, 147456, v12
  ds_read_b64_tr_b16 v[32:33], v12 offset:0
  ds_read_b64_tr_b16 v[34:35], v12 offset:256
  ds_read_b64_tr_b16 v[36:37], v12 offset:8192
  ds_read_b64_tr_b16 v[38:39], v12 offset:8448
  v_xor_b32 v12, 160, v25
  v_add_u32 v12, 147456, v12
  ds_read_b64_tr_b16 v[88:89], v12 offset:0
  ds_read_b64_tr_b16 v[90:91], v12 offset:256
  ds_read_b64_tr_b16 v[92:93], v12 offset:8192
  ds_read_b64_tr_b16 v[94:95], v12 offset:8448
  s_waitcnt lgkmcnt(0)
  ds_write_b128 v7, v[32:35] offset:6144
  ds_write_b128 v7, v[36:39] offset:7168
  s_waitcnt vmcnt(8) lgkmcnt(0)
  s_barrier
  s_mov_b32 m0, 159744
  s_mov_b32 s41, 4063232
  buffer_load_dwordx4 v22, s[20:23], s41 offen nt lds
  s_mov_b32 m0, 160768
  s_mov_b32 s41, 4096000
  buffer_load_dwordx4 v23, s[20:23], s41 offen nt lds
  s_mov_b32 m0, 161792
  s_mov_b32 s41, 4128768
  buffer_load_dwordx4 v22, s[20:23], s41 offen nt lds
  s_mov_b32 m0, 162816
  s_mov_b32 s41, 4161536
  buffer_load_dwordx4 v23, s[20:23], s41 offen nt lds
  v_xor_b32 v12, 128, v25
  v_add_u32 v12, 0, v12
  ds_read_b64_tr_b16 v[32:33], v12 offset:0
  ds_read_b64_tr_b16 v[34:35], v12 offset:256
  ds_read_b64_tr_b16 v[36:37], v12 offset:8192
  ds_read_b64_tr_b16 v[38:39], v12 offset:8448
  v_xor_b32 v12, 160, v25
  v_add_u32 v12, 0, v12
  ds_read_b64_tr_b16 v[96:97], v12 offset:0
  ds_read_b64_tr_b16 v[98:99], v12 offset:256
  ds_read_b64_tr_b16 v[100:101], v12 offset:8192
  ds_read_b64_tr_b16 v[102:103], v12 offset:8448
  s_waitcnt lgkmcnt(0)
  ds_write_b128 v7, v[32:35] offset:8192
  ds_write_b128 v7, v[36:39] offset:9216
  s_waitcnt vmcnt(8) lgkmcnt(0)
  s_barrier
  v_lshrrev_b32 v55, 4, v0
  v_and_b32 v55, 1, v55
  v_lshlrev_b32 v55, 18, v55
  v_and_b32 v56, 15, v0
  v_lshl_add_u32 v55, v56, 7, v55
  s_lshl_b32 s41, s32, 13
  s_add_u32 s41, s41, 83892224
  v_and_b32 v56, 1, v0
  v_lshlrev_b32 v56, 7, v56
  s_lshl_b32 s42, s32, 8
  s_add_u32 s42, s42, 85032960
  buffer_load_dword v57, v55, s[4:7], s41 offen sc1
  buffer_load_dword v57, v56, s[4:7], s42 offen sc1
  v_xor_b32 v12, 128, v25
  v_add_u32 v12, 65536, v12
  ds_read_b64_tr_b16 v[32:33], v12 offset:0
  ds_read_b64_tr_b16 v[34:35], v12 offset:256
  ds_read_b64_tr_b16 v[36:37], v12 offset:8192
  ds_read_b64_tr_b16 v[38:39], v12 offset:8448
  v_xor_b32 v12, 160, v25
  v_add_u32 v12, 65536, v12
  ds_read_b64_tr_b16 v[104:105], v12 offset:0
  ds_read_b64_tr_b16 v[106:107], v12 offset:256
  ds_read_b64_tr_b16 v[108:109], v12 offset:8192
  ds_read_b64_tr_b16 v[110:111], v12 offset:8448
  s_waitcnt lgkmcnt(0)
  ds_write_b128 v7, v[32:35] offset:10240
  ds_write_b128 v7, v[36:39] offset:11264
  s_waitcnt vmcnt(6) lgkmcnt(0)
  s_barrier
  v_xor_b32 v12, 128, v25
  v_add_u32 v12, 114688, v12
  ds_read_b64_tr_b16 v[32:33], v12 offset:0
  ds_read_b64_tr_b16 v[34:35], v12 offset:256
  ds_read_b64_tr_b16 v[36:37], v12 offset:8192
  ds_read_b64_tr_b16 v[38:39], v12 offset:8448
  v_xor_b32 v12, 160, v25
  v_add_u32 v12, 114688, v12
  ds_read_b64_tr_b16 v[112:113], v12 offset:0
  ds_read_b64_tr_b16 v[114:115], v12 offset:256
  ds_read_b64_tr_b16 v[116:117], v12 offset:8192
  ds_read_b64_tr_b16 v[118:119], v12 offset:8448
  s_waitcnt lgkmcnt(0)
  ds_write_b128 v7, v[32:35] offset:12288
  ds_write_b128 v7, v[36:39] offset:13312
  s_waitcnt vmcnt(2) lgkmcnt(0)
  s_barrier
  v_xor_b32 v12, 128, v25
  v_add_u32 v12, 147456, v12
  ds_read_b64_tr_b16 v[32:33], v12 offset:0
  ds_read_b64_tr_b16 v[34:35], v12 offset:256
  ds_read_b64_tr_b16 v[36:37], v12 offset:8192
  ds_read_b64_tr_b16 v[38:39], v12 offset:8448
  v_xor_b32 v12, 160, v25
  v_add_u32 v12, 147456, v12
  ds_read_b64_tr_b16 v[120:121], v12 offset:0
  ds_read_b64_tr_b16 v[122:123], v12 offset:256
  ds_read_b64_tr_b16 v[124:125], v12 offset:8192
  ds_read_b64_tr_b16 v[126:127], v12 offset:8448
  s_waitcnt lgkmcnt(0)
  ds_write_b128 v7, v[32:35] offset:14336
  ds_write_b128 v7, v[36:39] offset:15360
  s_waitcnt lgkmcnt(0)
  s_barrier
  ds_write_b128 v7, v[192:195] offset:16384
  ds_write_b128 v7, v[196:199] offset:17408
  ds_write_b128 v7, v[200:203] offset:18432
  ds_write_b128 v7, v[204:207] offset:19456
  ds_write_b128 v7, v[208:211] offset:20480
  ds_write_b128 v7, v[212:215] offset:21504
  ds_write_b128 v7, v[216:219] offset:22528
  ds_write_b128 v7, v[220:223] offset:23552
  ds_write_b128 v7, v[224:227] offset:24576
  ds_write_b128 v7, v[228:231] offset:25600
  ds_write_b128 v7, v[232:235] offset:26624
  ds_write_b128 v7, v[236:239] offset:27648
  ds_write_b128 v7, v[240:243] offset:28672
  ds_write_b128 v7, v[244:247] offset:29696
  ds_write_b128 v7, v[248:251] offset:30720
  ds_write_b128 v7, v[252:255] offset:31744
  v_lshrrev_b32 v16, 4, v0
  v_and_b32 v17, 15, v0
  v_lshrrev_b32 v18, 2, v17
  v_lshlrev_b32 v9, 3, v16
  v_lshl_add_u32 v9, v18, 1, v9
  v_and_b32 v18, 1, v17
  v_add_u32 v9, v9, v18
  v_lshlrev_b32 v9, 4, v9
  s_lshl_b32 s45, s32, 11
  s_add_u32 s45, s45, 75431936
  s_lshl_b32 s49, s32, 7
  s_add_u32 s49, s49, 85196800
  s_lshl_b32 s47, s32, 13
  s_add_u32 s47, s47, 83892224
  s_lshl_b32 s36, s32, 6
  s_add_u32 s36, s36, 84344832
  s_mov_b32 s35, 84940800
  s_mov_b32 s67, 0
  s_mov_b32 s68, 0
  s_add_u32 s46, s46, 16781312
  s_add_u32 s70, s70, 16781312
  s_mov_b32 m0, 28672
  s_waitcnt vmcnt(0) lgkmcnt(0)
  ds_read_b128 v[192:195], v7 offset:0
  ds_read_b128 v[196:199], v7 offset:1024
  ds_read_b128 v[200:203], v7 offset:2048
  ds_read_b128 v[204:207], v7 offset:3072
  ds_read_b128 v[208:211], v7 offset:4096
  ds_read_b128 v[212:215], v7 offset:5120
  ds_read_b128 v[216:219], v7 offset:6144
  ds_read_b128 v[220:223], v7 offset:7168
  ds_read_b128 v[224:227], v7 offset:8192
  ds_read_b128 v[228:231], v7 offset:9216
  ds_read_b128 v[232:235], v7 offset:10240
  ds_read_b128 v[236:239], v7 offset:11264
  ds_read_b128 v[240:243], v7 offset:12288
  ds_read_b128 v[244:247], v7 offset:13312
  ds_read_b128 v[248:251], v7 offset:14336
  ds_read_b128 v[252:255], v7 offset:15360
  s_cmp_eq_u32 s96, 1
  s_cbranch_scc1 cf3_step
  s_branch cs3_step
c_cenw3:
  s_add_u32 s40, s40, 1
  s_cmp_gt_u32 s40, 131072
  s_cbranch_scc1 c_cend3
  buffer_load_dwordx2 v[52:53], off, s[8:11], 0 sc1
  buffer_load_dword v54, off, s[8:11], 0 offset:16 sc1
  s_waitcnt vmcnt(0)
  s_branch c_cen3
cf0_step:
  v_mov_b64 v[16:17], 0
  v_mov_b64 v[18:19], 0
  v_mov_b64 v[20:21], 0
  v_mov_b64 v[22:23], 0
  v_mov_b64 v[26:27], 0
  v_mov_b64 v[28:29], 0
  v_mov_b64 v[30:31], 0
  s_xor_b32 s37, s37, 0x40000
  s_xor_b32 s36, s36, 0x40000
  s_mov_b32 s40, 0
  v_mov_b64 v[24:25], 0
  s_add_u32 s46, s46, 262144
  s_min_u32 s46, s46, s70
  s_nop 7
  s_nop 7
  s_nop 7
  buffer_load_dwordx4 v[32:35], v3, s[4:7], s35 offen offset:0 sc1
  buffer_load_dwordx4 v[36:39], v3, s[4:7], s35 offen offset:1024 sc1
  s_nop 7
  s_nop 7
  s_nop 7
  buffer_load_dwordx4 v[32:35], v3, s[4:7], s35 offen offset:0 sc1
  buffer_load_dwordx4 v[36:39], v3, s[4:7], s35 offen offset:1024 sc1
  s_barrier
  ds_read_b128 v[64:67], v3 offset:16384
  ds_read_b128 v[68:71], v3 offset:17408
  ds_read_b128 v[72:75], v3 offset:18432
  ds_read_b128 v[76:79], v3 offset:19456
  ds_read_b128 v[80:83], v3 offset:20480
  ds_read_b128 v[84:87], v3 offset:21504
  ds_read_b128 v[88:91], v3 offset:22528
  ds_read_b128 v[92:95], v3 offset:23552
  ds_read_b128 v[96:99], v3 offset:24576
  ds_read_b128 v[100:103], v3 offset:25600
  ds_read_b128 v[104:107], v3 offset:26624
  ds_read_b128 v[108:111], v3 offset:27648
  ds_read_b128 v[112:115], v3 offset:28672
  ds_read_b128 v[116:119], v3 offset:29696
  ds_read_b128 v[120:123], v3 offset:30720
  ds_read_b128 v[124:127], v3 offset:31744
  s_branch cf0_chkB1
cf0_chkB:
  buffer_load_dwordx4 v[32:35], v3, s[4:7], s35 offen offset:0 sc1
  buffer_load_dwordx4 v[36:39], v3, s[4:7], s35 offen offset:1024 sc1
cf0_chkB1:
  s_add_u32 s40, s40, 1
  s_add_u32 s68, s68, 1
  s_cmp_gt_u32 s40, 1048576
  s_cselect_b32 s51, -1, -2
  s_waitcnt vmcnt(2)
  v_max3_u32 v0, v32, v33, v34
  v_max3_u32 v0, v0, v35, v36
  v_max3_u32 v0, v0, v37, v38
  v_max_u32 v0, v0, v39
  v_cmp_lt_u32 vcc, s51, v0
  ds_write_b128 v3, v[32:35] offset:0
  ds_write_b128 v3, v[36:39] offset:1024
  s_cbranch_vccnz cf0_chkB
cf0_okB:
  v_smfmac_f32_16x16x64_bf16 v[16:19], v[32:35], a[0:7], v1
  v_mov_b32 v0, -1
  v_smfmac_f32_16x16x64_bf16 v[20:23], v[32:35], a[64:71], v1
  buffer_store_dword v0, v2, s[4:7], s39 offen
  v_smfmac_f32_16x16x64_bf16 v[16:19], v[36:39], a[8:15], v1
  s_mov_b32 s39, s38
  s_add_u32 s38, s38, 0x8000
  v_smfmac_f32_16x16x64_bf16 v[20:23], v[36:39], a[72:79], v1
  s_waitcnt lgkmcnt(0)
  s_barrier
  ds_read_b128 v[40:43], v3 offset:2048
  ds_read_b128 v[44:47], v3 offset:3072
  s_and_b32 s38, s38, 0xfffdffff
  s_sub_u32 s39, s39, 0x8000
  v_smfmac_f32_16x16x64_bf16 v[24:27], v[32:35], a[128:135], v1
  ds_read_b128 v[48:51], v3 offset:4096
  ds_read_b128 v[52:55], v3 offset:5120
  v_smfmac_f32_16x16x64_bf16 v[28:31], v[32:35], a[192:199], v1
  ds_read_b128 v[56:59], v3 offset:6144
  ds_read_b128 v[60:63], v3 offset:7168
  v_smfmac_f32_16x16x64_bf16 v[24:27], v[36:39], a[136:143], v1
  v_smfmac_f32_16x16x64_bf16 v[28:31], v[36:39], a[200:207], v1
  s_waitcnt lgkmcnt(5)
  v_smfmac_f32_16x16x64_bf16 v[16:19], v[40:43], a[16:23], v1
  buffer_load_dwordx4 v3, s[4:7], s46 offen offset:0 sc1 lds
  s_waitcnt lgkmcnt(4)
  v_smfmac_f32_16x16x64_bf16 v[16:19], v[44:47], a[24:31], v1
  s_waitcnt lgkmcnt(3)
  v_smfmac_f32_16x16x64_bf16 v[16:19], v[48:51], a[32:39], v1
  s_waitcnt lgkmcnt(2)
  v_smfmac_f32_16x16x64_bf16 v[16:19], v[52:55], a[40:47], v1
  s_waitcnt lgkmcnt(1)
  v_smfmac_f32_16x16x64_bf16 v[16:19], v[56:59], a[48:55], v1
  buffer_load_dwordx4 v3, s[4:7], s46 offen offset:1024 sc1 lds
  s_waitcnt lgkmcnt(0)
  v_smfmac_f32_16x16x64_bf16 v[16:19], v[60:63], a[56:63], v1
  s_nop 1
  v_smfmac_f32_16x16x64_bf16 v[20:23], v[40:43], a[80:87], v1
  s_nop 2
  v_smfmac_f32_16x16x64_bf16 v[20:23], v[44:47], a[88:95], v1
  s_nop 0
  v_add_f32 v16, v16, v18
  v_add_f32 v17, v17, v19
  v_smfmac_f32_16x16x64_bf16 v[20:23], v[48:51], a[96:103], v1
  buffer_load_dwordx4 v3, s[4:7], s46 offen offset:2048 sc1 lds
  v_mul_f32 v16, s43, v16
  v_mul_f32 v17, s43, v17
  v_smfmac_f32_16x16x64_bf16 v[20:23], v[52:55], a[104:111], v1
  v_cvt_pk_bf16_f32 v16, v16, v17
  v_smfmac_f32_16x16x64_bf16 v[20:23], v[56:59], a[112:119], v1
  ds_write_b32 v5, v16 offset:12288
  v_smfmac_f32_16x16x64_bf16 v[20:23], v[60:63], a[120:127], v1
  s_nop 1
  v_smfmac_f32_16x16x64_bf16 v[24:27], v[40:43], a[144:151], v1
  buffer_load_dwordx4 v3, s[4:7], s46 offen offset:3072 sc1 lds
  s_nop 1
  v_smfmac_f32_16x16x64_bf16 v[24:27], v[44:47], a[152:159], v1
  s_nop 0
  v_add_f32 v20, v20, v22
  v_add_f32 v21, v21, v23
  v_mul_f32 v20, s43, v20
  v_mul_f32 v21, s43, v21
  v_cvt_pk_bf16_f32 v20, v20, v21
  v_smfmac_f32_16x16x64_bf16 v[24:27], v[48:51], a[160:167], v1
  ds_write_b32 v5, v20 offset:12544
  v_smfmac_f32_16x16x64_bf16 v[24:27], v[52:55], a[168:175], v1
  s_and_b32 s39, s39, 0x1ffff
  s_add_u32 s39, s39, 84934656
  v_smfmac_f32_16x16x64_bf16 v[24:27], v[56:59], a[176:183], v1
  s_add_u32 s51, s36, 4096
  v_smfmac_f32_16x16x64_bf16 v[24:27], v[60:63], a[184:191], v1
  s_waitcnt lgkmcnt(0)
  s_barrier
  s_waitcnt vmcnt(5)
  v_smfmac_f32_16x16x64_bf16 v[28:31], v[40:43], a[208:215], v1
  ds_read_b64_tr_b16 v[32:33], v7 offset:12288
  ds_read_b64_tr_b16 v[34:35], v7 offset:12544
  ds_read_b64_tr_b16 v[36:37], v7 offset:12800
  v_smfmac_f32_16x16x64_bf16 v[28:31], v[44:47], a[216:223], v1
  ds_read_b64_tr_b16 v[38:39], v7 offset:13056
  v_add_f32 v24, v24, v26
  v_smfmac_f32_16x16x64_bf16 v[28:31], v[48:51], a[224:231], v1
  ds_read_b64_tr_b16 v[16:17], v7 offset:13312
  v_add_f32 v25, v25, v27
  v_smfmac_f32_16x16x64_bf16 v[28:31], v[52:55], a[232:239], v1
  ds_read_b64_tr_b16 v[18:19], v7 offset:13568
  v_cvt_pk_bf16_f32 v24, v24, v25
  v_smfmac_f32_16x16x64_bf16 v[28:31], v[56:59], a[240:247], v1
  ds_write_b32 v6, v24 offset:8192
  ds_read_b64_tr_b16 v[20:21], v7 offset:13824
  v_smfmac_f32_16x16x64_bf16 v[28:31], v[60:63], a[248:255], v1
  ds_read_b64_tr_b16 v[22:23], v7 offset:14080
  s_waitcnt lgkmcnt(7)
  v_mfma_f32_16x16x32_bf16 v[56:59], v[64:67], v[32:35], 0
  s_nop 1
  s_waitcnt lgkmcnt(5)
  v_mfma_f32_16x16x32_bf16 v[56:59], v[68:71], v[36:39], v[56:59]
  s_nop 0
  v_add_f32 v28, v28, v30
  v_add_f32 v29, v29, v31
  s_waitcnt lgkmcnt(3)
  v_mfma_f32_16x16x32_bf16 v[56:59], v[72:75], v[16:19], v[56:59]
  v_cvt_pk_bf16_f32 v28, v28, v29
  s_waitcnt lgkmcnt(0)
  v_mfma_f32_16x16x32_bf16 v[56:59], v[76:79], v[20:23], v[56:59]
  ds_write_b32 v6, v28 offset:8704
  v_lshrrev_b32 v0, 7, v8
  v_lshlrev_b32 v0, 5, v0
  v_mfma_f32_16x16x32_bf16 v[60:63], v[80:83], v[32:35], 0
  s_nop 1
  v_add_u32 v0, 8204, v0
  v_mfma_f32_16x16x32_bf16 v[60:63], v[84:87], v[36:39], v[60:63]
  v_exp_f32 v64, v56
  v_mfma_f32_16x16x32_bf16 v[60:63], v[88:91], v[16:19], v[60:63]
  s_waitcnt lgkmcnt(0)
  v_exp_f32 v65, v57
  v_mfma_f32_16x16x32_bf16 v[60:63], v[92:95], v[20:23], v[60:63]
  s_barrier
  ds_read_b64_tr_b16 v[40:41], v4 offset:8192
  ds_read_b64_tr_b16 v[42:43], v4 offset:8704
  ds_read_b64_tr_b16 v[44:45], v4 offset:9216
  ds_read_b64_tr_b16 v[46:47], v4 offset:9728
  ds_read_b64_tr_b16 v[48:49], v4 offset:10240
  ds_read_b64_tr_b16 v[50:51], v4 offset:10752
  ds_read_b64_tr_b16 v[52:53], v4 offset:11264
  ds_read_b64_tr_b16 v[54:55], v4 offset:11776
  v_exp_f32 v66, v58
  v_exp_f32 v67, v59
  v_cvt_pk_bf16_f32 v72, v64, v65
  v_and_b32 v76, v11, v72
  v_cvt_pk_bf16_f32 v73, v66, v67
  v_and_b32 v77, v11, v73
  s_waitcnt lgkmcnt(6)
  v_mfma_f32_16x16x32_bf16 v[24:27], v[40:43], v[32:35], 0
  s_waitcnt lgkmcnt(4)
  v_exp_f32 v68, v60
  v_mfma_f32_16x16x32_bf16 v[24:27], v[44:47], v[36:39], v[24:27]
  s_waitcnt lgkmcnt(2)
  v_exp_f32 v69, v61
  v_mfma_f32_16x16x32_bf16 v[24:27], v[48:51], v[16:19], v[24:27]
  s_waitcnt lgkmcnt(0)
  v_exp_f32 v70, v62
  v_mfma_f32_16x16x32_bf16 v[24:27], v[52:55], v[20:23], v[24:27]
  v_exp_f32 v71, v63
  v_cvt_pk_bf16_f32 v74, v68, v69
  v_and_b32 v78, v11, v74
  v_cvt_pk_bf16_f32 v75, v70, v71
  v_and_b32 v79, v11, v75
  v_xor_b32 v64, v72, v76
  v_xor_b32 v65, v73, v77
  v_mfma_f32_16x16x32_bf16 v[92:95], v[120:123], v[76:79], 0
  v_xor_b32 v66, v74, v78
  v_xor_b32 v67, v75, v79
  v_mfma_f32_16x16x32_bf16 v[68:71], v[12:15], v[72:75], 0
  v_exp_f32 v28, v24
  v_mfma_f32_16x16x32_bf16 v[92:95], v[124:127], v[64:67], v[92:95]
  v_exp_f32 v29, v25
  v_mfma_f32_16x16x32_bf16 v[80:83], v[96:99], v[76:79], 0
  v_cvt_pk_bf16_f32 v28, v28, v29
  v_and_b32 v26, v11, v28
  v_mfma_f32_16x16x32_bf16 v[84:87], v[104:107], v[76:79], 0
  ds_write_b32 v3, v28 offset:1024
  v_xor_b32 v27, v28, v26
  v_mfma_f32_16x16x32_bf16 v[88:91], v[112:115], v[76:79], 0
  ds_write_b128 v3, v[92:95] offset:0
  v_mfma_f32_16x16x16_bf16 v[68:71], v[12:13], v[26:27], v[68:71]
  v_mov_b64 v[48:49], 0
  v_mov_b64 v[50:51], 0
  v_mfma_f32_16x16x32_bf16 v[80:83], v[100:103], v[64:67], v[80:83]
  s_waitcnt lgkmcnt(0)
  s_barrier
  ds_read_b128 v[32:35], v3 offset:14336
  ds_read_b64 v[36:37], v3 offset:15360
  v_mov_b64 v[52:53], 0
  v_mov_b64 v[54:55], 0
  v_mfma_f32_16x16x32_bf16 v[84:87], v[108:111], v[64:67], v[84:87]
  s_cmp_eq_u32 s34, 63
  v_mfma_f32_16x16x32_bf16 v[88:91], v[116:119], v[64:67], v[88:91]
  v_subrev_u32 v30, s44, v68
  v_cmp_lt_u32 vcc, s69, v30
  s_cbranch_scc1 cf0_exit
  s_waitcnt lgkmcnt(1)
  v_mfma_f32_16x16x16_bf16 v[80:83], v[32:33], v[26:27], v[80:83]
  s_cbranch_vccnz cf0_fb
  v_rcp_f32 v30, v68
  v_mfma_f32_16x16x16_bf16 v[84:87], v[34:35], v[26:27], v[84:87]
  s_waitcnt lgkmcnt(0)
  v_mov_b64 v[56:57], 0
  v_mov_b64 v[58:59], 0
  v_mfma_f32_16x16x16_bf16 v[88:91], v[36:37], v[26:27], v[88:91]
  ds_write_b32 v9, v30 offset:8204
  v_cvt_pk_bf16_f32 v40, v80, v81
  v_cvt_pk_bf16_f32 v41, v82, v83
  v_mov_b64 v[60:61], 0
  v_cvt_pk_bf16_f32 v42, v84, v85
  v_cvt_pk_bf16_f32 v43, v86, v87
  ds_write_b64 v9, v[40:41] offset:12288
  ds_write_b64 v9, v[42:43] offset:12296
  v_cvt_pk_bf16_f32 v44, v88, v89
  v_cvt_pk_bf16_f32 v45, v90, v91
  ds_write_b64 v9, v[44:45] offset:13312
  v_mov_b64 v[62:63], 0
  s_waitcnt lgkmcnt(0)
  s_barrier
cf0_wo:
  ds_read_b128 v[32:35], v8 offset:12288
  ds_read_b128 v[36:39], v8 offset:12800
  ds_read_b128 v[40:43], v8 offset:13312
  ds_read_b128 v[44:47], v8 offset:13824
  s_waitcnt lgkmcnt(3)
  v_smfmac_f32_16x16x64_bf16 v[48:51], v[32:35], v[128:135], v1 abid:1
  ds_read2_b32 v[28:29], v0 offset0:0 offset1:4
  s_waitcnt lgkmcnt(3)
  v_smfmac_f32_16x16x64_bf16 v[48:51], v[36:39], v[136:143], v1 abid:1
  s_waitcnt lgkmcnt(2)
  v_smfmac_f32_16x16x64_bf16 v[48:51], v[40:43], v[144:151], v1 abid:1
  s_waitcnt lgkmcnt(1)
  v_smfmac_f32_16x16x64_bf16 v[48:51], v[44:47], v[152:159], v1 abid:1
  s_nop 1
  v_smfmac_f32_16x16x64_bf16 v[52:55], v[32:35], v[160:167], v1 abid:1
  s_nop 2
  v_smfmac_f32_16x16x64_bf16 v[52:55], v[36:39], v[168:175], v1 abid:1
  s_waitcnt lgkmcnt(0)
  v_mul_f32 v48, v28, v48
  v_mul_f32 v49, v29, v49
  v_mul_f32 v50, v28, v50
  v_mul_f32 v51, v29, v51
  v_cvt_pk_bf16_f32 v48, v48, v49
  v_cvt_pk_bf16_f32 v49, v50, v51
  v_smfmac_f32_16x16x64_bf16 v[52:55], v[40:43], v[176:183], v1 abid:1
  buffer_store_dwordx2 v[48:49], v10, s[4:7], s36 offen offset:0
  v_smfmac_f32_16x16x64_bf16 v[52:55], v[44:47], v[184:191], v1 abid:1
  ds_read_b32 v16, v3 offset:10244
  ds_read_b32 v17, v3 offset:10252
  v_smfmac_f32_16x16x64_bf16 v[56:59], v[32:35], v[192:199], v1 abid:1
  ds_read_b32 v18, v3 offset:11268
  ds_read_b32 v19, v3 offset:11276
  s_nop 0
  v_smfmac_f32_16x16x64_bf16 v[56:59], v[36:39], v[200:207], v1 abid:1
  s_nop 0
  v_mul_f32 v52, v28, v52
  v_mul_f32 v53, v29, v53
  v_mul_f32 v54, v28, v54
  v_mul_f32 v55, v29, v55
  v_cvt_pk_bf16_f32 v52, v52, v53
  v_cvt_pk_bf16_f32 v53, v54, v55
  v_smfmac_f32_16x16x64_bf16 v[56:59], v[40:43], v[208:215], v1 abid:1
  buffer_store_dwordx2 v[52:53], v10, s[4:7], s36 offen offset:2048
  v_smfmac_f32_16x16x64_bf16 v[56:59], v[44:47], v[216:223], v1 abid:1
  s_nop 1
  v_smfmac_f32_16x16x64_bf16 v[60:63], v[32:35], v[224:231], v1 abid:1
  s_nop 2
  v_smfmac_f32_16x16x64_bf16 v[60:63], v[36:39], v[232:239], v1 abid:1
  s_nop 0
  v_mul_f32 v56, v28, v56
  v_mul_f32 v57, v29, v57
  v_mul_f32 v58, v28, v58
  v_mul_f32 v59, v29, v59
  v_cvt_pk_bf16_f32 v56, v56, v57
  v_cvt_pk_bf16_f32 v57, v58, v59
  v_smfmac_f32_16x16x64_bf16 v[60:63], v[40:43], v[240:247], v1 abid:1
  buffer_store_dwordx2 v[56:57], v10, s[4:7], s51 offen offset:0
  v_smfmac_f32_16x16x64_bf16 v[60:63], v[44:47], v[248:255], v1 abid:1
  s_add_u32 s34, s34, 1
  s_and_b32 s41, s34, 3
  s_lshl_b32 s41, s41, 15
  s_add_u32 s35, s41, 84934656
  s_mov_b32 s40, 0
  s_nop 2
  v_mul_f32 v60, v28, v60
  v_mul_f32 v61, v29, v61
  v_mul_f32 v62, v28, v62
  v_mul_f32 v63, v29, v63
  v_cvt_pk_bf16_f32 v60, v60, v61
  v_cvt_pk_bf16_f32 v61, v62, v63
  buffer_store_dwordx2 v[60:61], v10, s[4:7], s51 offen offset:2048
  s_nop 7
  s_nop 7
  s_nop 7
  buffer_load_dwordx4 v[40:43], v3, s[4:7], s37 offen offset:0 sc1
  buffer_load_dwordx4 v[44:47], v3, s[4:7], s37 offen offset:1024 sc1
  s_nop 7
  s_nop 7
  s_nop 7
  s_nop 7
  s_nop 7
  buffer_load_dwordx4 v[40:43], v3, s[4:7], s37 offen offset:0 sc1
  buffer_load_dwordx4 v[44:47], v3, s[4:7], s37 offen offset:1024 sc1
  s_branch cf0_pollA1
cf0_pollA:
  buffer_load_dwordx4 v[40:43], v3, s[4:7], s37 offen offset:0 sc1
  buffer_load_dwordx4 v[44:47], v3, s[4:7], s37 offen offset:1024 sc1
cf0_pollA1:
  s_add_u32 s40, s40, 1
  s_add_u32 s67, s67, 1
  s_mov_b32 s24, 3
  s_cmp_gt_u32 s40, 63
  s_cbranch_scc1 cf0_nanA
cf0_pollA2:
  s_waitcnt vmcnt(3) lgkmcnt(0)
  v_mfma_f32_16x16x32_bf16 v[20:23], v[16:19], v[40:43], 0
  s_waitcnt vmcnt(2) lgkmcnt(0)
  v_mfma_f32_16x16x32_bf16 v[20:23], v[16:19], v[44:47], v[20:23]
  s_nop 7
  v_cmp_class_f32 vcc, v22, s24
  v_add_f32_dpp v20, v20, v20 row_ror:4 row_mask:0xf bank_mask:0xf
  v_add_f32_dpp v21, v21, v21 row_ror:4 row_mask:0xf bank_mask:0xf
  s_nop 0
  v_add_f32_dpp v20, v20, v20 row_ror:8 row_mask:0xf bank_mask:0xf
  v_add_f32_dpp v21, v21, v21 row_ror:8 row_mask:0xf bank_mask:0xf
  v_cvt_pk_bf16_f32 v24, v20, v21
  s_cbranch_vccnz cf0_pollA
cf0_pub:
  buffer_store_dword v24, v2, s[4:7], s38 offen
  s_branch cf0_step
cf0_retryB:
cf0_nanA:
  s_waitcnt vmcnt(0)
  v_max3_u32 v0, v40, v41, v42
  v_max3_u32 v0, v0, v43, v44
  v_max3_u32 v0, v0, v45, v46
  v_max_u32 v0, v0, v47
  v_cmp_eq_u32 vcc, -1, v0
  s_nop 4
  s_cmp_eq_u64 vcc, 0
  s_cselect_b32 s24, 0, 3
  s_cmp_gt_u32 s40, 1048576
  s_cselect_b32 s24, 0, s24
  s_branch cf0_pollA2
cf0_fb:
  s_nop 7
  v_mov_b32 v30, -1.0
  ds_write_b32 v9, v30 offset:8204
  s_waitcnt lgkmcnt(0)
  s_barrier
  ds_read_b64 v[38:39], v3 offset:15368
  v_max3_f32 v28, v56, v57, v58
  v_max3_f32 v28, v28, v59, v60
  v_max3_f32 v28, v28, v61, v62
  v_max3_f32 v28, v28, v63, v24
  v_max_f32 v28, v28, v25
  v_mov_b32 v29, v28
  s_nop 1
  v_permlane32_swap_b32 v28, v29
  v_max_f32 v28, v28, v29
  v_mov_b32 v29, v28
  s_nop 1
  v_permlane16_swap_b32 v28, v29
  v_max_f32 v31, v28, v29
  v_sub_f32 v64, v56, v31
  v_exp_f32 v64, v64
  v_sub_f32 v65, v57, v31
  v_exp_f32 v65, v65
  v_sub_f32 v66, v58, v31
  v_exp_f32 v66, v66
  v_sub_f32 v67, v59, v31
  v_exp_f32 v67, v67
  v_sub_f32 v68, v60, v31
  v_exp_f32 v68, v68
  v_sub_f32 v69, v61, v31
  v_exp_f32 v69, v69
  v_sub_f32 v70, v62, v31
  v_exp_f32 v70, v70
  v_sub_f32 v71, v63, v31
  v_exp_f32 v71, v71
  v_sub_f32 v28, v24, v31
  v_sub_f32 v29, v25, v31
  v_exp_f32 v28, v28
  v_exp_f32 v29, v29
  v_cvt_pk_bf16_f32 v72, v64, v65
  v_cvt_pk_bf16_f32 v73, v66, v67
  v_cvt_pk_bf16_f32 v74, v68, v69
  v_cvt_pk_bf16_f32 v75, v70, v71
  v_and_b32 v76, v11, v72
  v_and_b32 v77, v11, v73
  v_and_b32 v78, v11, v74
  v_and_b32 v79, v11, v75
  v_xor_b32 v64, v72, v76
  v_xor_b32 v65, v73, v77
  v_xor_b32 v66, v74, v78
  v_xor_b32 v67, v75, v79
  v_cvt_pk_bf16_f32 v28, v28, v29
  v_and_b32 v26, v11, v28
  v_xor_b32 v27, v28, v26
  s_nop 1
  v_mfma_f32_16x16x32_bf16 v[92:95], v[120:123], v[76:79], 0
  v_mfma_f32_16x16x32_bf16 v[68:71], v[12:15], v[72:75], 0
  v_mfma_f32_16x16x32_bf16 v[92:95], v[124:127], v[64:67], v[92:95]
  v_mfma_f32_16x16x32_bf16 v[80:83], v[96:99], v[76:79], 0
  v_mfma_f32_16x16x32_bf16 v[84:87], v[104:107], v[76:79], 0
  v_mfma_f32_16x16x32_bf16 v[88:91], v[112:115], v[76:79], 0
  s_nop 3
  v_mfma_f32_16x16x16_bf16 v[68:71], v[12:13], v[26:27], v[68:71]
  v_mfma_f32_16x16x32_bf16 v[80:83], v[100:103], v[64:67], v[80:83]
  v_mfma_f32_16x16x32_bf16 v[84:87], v[108:111], v[64:67], v[84:87]
  v_mfma_f32_16x16x32_bf16 v[88:91], v[116:119], v[64:67], v[88:91]
  s_nop 7
  s_waitcnt lgkmcnt(0)
  v_mfma_f32_16x16x16_bf16 v[80:83], v[32:33], v[26:27], v[80:83]
  v_mfma_f32_16x16x16_bf16 v[84:87], v[34:35], v[26:27], v[84:87]
  v_mfma_f32_16x16x16_bf16 v[88:91], v[36:37], v[26:27], v[88:91]
  v_mfma_f32_16x16x16_bf16 v[92:95], v[38:39], v[26:27], v[92:95]
  s_nop 7
  v_rcp_f32 v30, v68
  v_cvt_pk_bf16_f32 v40, v80, v81
  v_cvt_pk_bf16_f32 v41, v82, v83
  v_cvt_pk_bf16_f32 v42, v84, v85
  v_cvt_pk_bf16_f32 v43, v86, v87
  v_cvt_pk_bf16_f32 v44, v88, v89
  v_cvt_pk_bf16_f32 v45, v90, v91
  v_cvt_pk_bf16_f32 v46, v92, v93
  v_cvt_pk_bf16_f32 v47, v94, v95
  v_mov_b64 v[48:49], 0
  v_mov_b64 v[50:51], 0
  v_mov_b64 v[52:53], 0
  v_mov_b64 v[54:55], 0
  v_mov_b64 v[56:57], 0
  v_mov_b64 v[58:59], 0
  v_mov_b64 v[60:61], 0
  v_mov_b64 v[62:63], 0
  s_barrier
  ds_write_b32 v9, v30 offset:8204
  ds_write_b128 v9, v[40:43] offset:12288
  ds_write_b128 v9, v[44:47] offset:13312
  s_waitcnt lgkmcnt(0)
  s_barrier
  s_branch cf0_wo
cf0_exit:
  s_waitcnt vmcnt(0)
  s_barrier
  s_endpgm
cf1_step:
  s_cmp_lg_u32 s48, 64
  s_cbranch_scc1 cf1_p1w
cf1_p1d:
  v_mov_b64 v[12:13], -1
  v_mov_b64 v[14:15], -1
  v_mov_b64 v[16:17], 0
  v_mov_b64 v[18:19], 0
  v_mov_b64 v[20:21], 0
  v_mov_b64 v[22:23], 0
  v_mov_b64 v[26:27], 0
  v_mov_b64 v[28:29], 0
  v_mov_b64 v[30:31], 0
  s_xor_b32 s37, s37, 0x40000
  s_xor_b32 s36, s36, 0x40000
  s_mov_b32 s40, 0
  v_mov_b64 v[24:25], 0
  s_add_u32 s46, s46, 262144
  s_min_u32 s46, s46, s70
  s_add_u32 s45, s45, 65536
  s_xor_b32 s47, s47, 0x40000
  s_waitcnt vmcnt(0)
  buffer_load_dwordx4 v[40:43], v3, s[4:7], s35 offen offset:0 sc1
  buffer_load_dwordx4 v[44:47], v3, s[4:7], s35 offen offset:1024 sc1
  s_barrier
  s_nop 7
  s_nop 7
  s_nop 7
  buffer_load_dwordx4 v[40:43], v3, s[4:7], s35 offen offset:0 sc1
  buffer_load_dwordx4 v[44:47], v3, s[4:7], s35 offen offset:1024 sc1
  s_branch cf1_chkB1
cf1_chkB:
  buffer_load_dwordx4 v[40:43], v3, s[4:7], s35 offen offset:0 sc1
  buffer_load_dwordx4 v[44:47], v3, s[4:7], s35 offen offset:1024 sc1
cf1_chkB1:
  s_add_u32 s40, s40, 1
  s_add_u32 s68, s68, 1
  s_cmp_gt_u32 s40, 1048576
  s_cselect_b32 s51, -1, -2
  s_waitcnt vmcnt(2)
  v_max3_u32 v0, v40, v41, v42
  v_max3_u32 v0, v0, v43, v44
  v_max3_u32 v0, v0, v45, v46
  v_max_u32 v0, v0, v47
  v_cmp_lt_u32 vcc, s51, v0
  ds_write_b128 v3, v[40:43] offset:2048
  ds_write_b128 v3, v[44:47] offset:3072
  s_cbranch_vccnz cf1_chkB
cf1_okB:
  v_smfmac_f32_16x16x64_bf16 v[16:19], v[40:43], a[16:23], v1
  v_mov_b32 v0, -1
  v_smfmac_f32_16x16x64_bf16 v[20:23], v[40:43], a[80:87], v1
  buffer_store_dword v0, v2, s[4:7], s39 offen
  v_smfmac_f32_16x16x64_bf16 v[16:19], v[44:47], a[24:31], v1
  s_mov_b32 s39, s38
  s_add_u32 s38, s38, 0x8000
  v_smfmac_f32_16x16x64_bf16 v[20:23], v[44:47], a[88:95], v1
  s_waitcnt lgkmcnt(0)
  s_barrier
  ds_read_b128 v[48:51], v3 offset:4096
  ds_read_b128 v[52:55], v3 offset:5120
  s_and_b32 s38, s38, 0xfffdffff
  s_sub_u32 s39, s39, 0x8000
  v_smfmac_f32_16x16x64_bf16 v[24:27], v[40:43], a[144:151], v1
  ds_read_b128 v[56:59], v3 offset:6144
  ds_read_b128 v[60:63], v3 offset:7168
  v_smfmac_f32_16x16x64_bf16 v[28:31], v[40:43], a[208:215], v1
  ds_read_b128 v[32:35], v3 offset:0
  ds_read_b128 v[36:39], v3 offset:1024
  v_smfmac_f32_16x16x64_bf16 v[24:27], v[44:47], a[152:159], v1
  v_smfmac_f32_16x16x64_bf16 v[28:31], v[44:47], a[216:223], v1
  buffer_load_dword v11, v9, s[4:7], s71 offen sc1
  s_waitcnt lgkmcnt(5)
  v_smfmac_f32_16x16x64_bf16 v[16:19], v[48:51], a[32:39], v1
  s_waitcnt lgkmcnt(4)
  v_smfmac_f32_16x16x64_bf16 v[16:19], v[52:55], a[40:47], v1
  buffer_load_dwordx4 v3, s[4:7], s46 offen offset:0 sc1 lds
  s_waitcnt lgkmcnt(3)
  v_smfmac_f32_16x16x64_bf16 v[16:19], v[56:59], a[48:55], v1
  buffer_store_dwordx4 v[12:15], v3, s[4:7], s47 offen offset:0
  s_waitcnt lgkmcnt(2)
  v_smfmac_f32_16x16x64_bf16 v[16:19], v[60:63], a[56:63], v1
  s_waitcnt lgkmcnt(1)
  v_smfmac_f32_16x16x64_bf16 v[16:19], v[32:35], a[0:7], v1
  s_waitcnt lgkmcnt(0)
  v_smfmac_f32_16x16x64_bf16 v[16:19], v[36:39], a[8:15], v1
  buffer_store_dwordx4 v[12:15], v3, s[4:7], s47 offen offset:1024
  buffer_load_dwordx4 v3, s[4:7], s46 offen offset:1024 sc1 lds
  v_smfmac_f32_16x16x64_bf16 v[20:23], v[48:51], a[96:103], v1
  s_nop 2
  v_smfmac_f32_16x16x64_bf16 v[20:23], v[52:55], a[104:111], v1
  s_nop 0
  v_add_f32 v16, v16, v18
  v_add_f32 v17, v17, v19
  v_smfmac_f32_16x16x64_bf16 v[20:23], v[56:59], a[112:119], v1
  buffer_store_dwordx4 v[12:15], v3, s[4:7], s47 offen offset:2048
  v_mul_f32 v16, s43, v16
  v_mul_f32 v17, s43, v17
  v_smfmac_f32_16x16x64_bf16 v[20:23], v[60:63], a[120:127], v1
  buffer_load_dwordx4 v3, s[4:7], s46 offen offset:2048 sc1 lds
  v_cvt_pk_bf16_f32 v16, v16, v17
  v_smfmac_f32_16x16x64_bf16 v[20:23], v[32:35], a[64:71], v1
  ds_write_b32 v5, v16 offset:12800
  v_smfmac_f32_16x16x64_bf16 v[20:23], v[36:39], a[72:79], v1
  s_nop 1
  v_smfmac_f32_16x16x64_bf16 v[24:27], v[48:51], a[160:167], v1
  s_nop 2
  v_smfmac_f32_16x16x64_bf16 v[24:27], v[52:55], a[168:175], v1
  buffer_load_dwordx4 v3, s[4:7], s46 offen offset:3072 sc1 lds
  v_add_f32 v20, v20, v22
  v_add_f32 v21, v21, v23
  v_mul_f32 v20, s43, v20
  v_mul_f32 v21, s43, v21
  v_cvt_pk_bf16_f32 v20, v20, v21
  v_smfmac_f32_16x16x64_bf16 v[24:27], v[56:59], a[176:183], v1
  ds_write_b32 v5, v20 offset:13056
  v_smfmac_f32_16x16x64_bf16 v[24:27], v[60:63], a[184:191], v1
  s_and_b32 s39, s39, 0x1ffff
  s_add_u32 s39, s39, 84934656
  v_mov_b64 v[12:13], 0
  v_smfmac_f32_16x16x64_bf16 v[24:27], v[32:35], a[128:135], v1
  s_add_u32 s51, s36, 4096
  v_mov_b64 v[14:15], 0
  v_smfmac_f32_16x16x64_bf16 v[24:27], v[36:39], a[136:143], v1
  s_waitcnt lgkmcnt(0)
  s_barrier
  v_smfmac_f32_16x16x64_bf16 v[28:31], v[48:51], a[224:231], v1
  s_nop 2
  v_smfmac_f32_16x16x64_bf16 v[28:31], v[52:55], a[232:239], v1
  s_nop 0
  v_add_f32 v24, v24, v26
  v_smfmac_f32_16x16x64_bf16 v[28:31], v[56:59], a[240:247], v1
  v_add_f32 v25, v25, v27
  v_smfmac_f32_16x16x64_bf16 v[28:31], v[60:63], a[248:255], v1
  v_cvt_pk_bf16_f32 v24, v24, v25
  v_smfmac_f32_16x16x64_bf16 v[28:31], v[32:35], a[192:199], v1
  ds_write_b32 v6, v24 offset:9216
  v_mov_b64 v[16:17], 0
  v_smfmac_f32_16x16x64_bf16 v[28:31], v[36:39], a[200:207], v1
  v_mov_b64 v[18:19], 0
  s_nop 0
  v_smfmac_f32_16x16x64_bf16 v[12:15], v[32:35], v[192:199], v1
  s_nop 2
  v_smfmac_f32_16x16x64_bf16 v[12:15], v[36:39], v[200:207], v1
  s_nop 0
  v_add_f32 v28, v28, v30
  v_add_f32 v29, v29, v31
  v_cvt_pk_bf16_f32 v28, v28, v29
  v_smfmac_f32_16x16x64_bf16 v[12:15], v[40:43], v[208:215], v1
  ds_write_b32 v6, v28 offset:9728
  v_smfmac_f32_16x16x64_bf16 v[12:15], v[44:47], v[216:223], v1
  ds_read_b128 v[192:195], v7 offset:16384
  v_smfmac_f32_16x16x64_bf16 v[12:15], v[48:51], v[224:231], v1
  ds_read_b128 v[196:199], v7 offset:17408
  v_mov_b64 v[20:21], 0
  v_smfmac_f32_16x16x64_bf16 v[12:15], v[52:55], v[232:239], v1
  ds_read_b128 v[200:203], v7 offset:18432
  v_mov_b64 v[22:23], 0
  v_smfmac_f32_16x16x64_bf16 v[12:15], v[56:59], v[240:247], v1
  ds_read_b128 v[204:207], v7 offset:19456
  v_smfmac_f32_16x16x64_bf16 v[12:15], v[60:63], v[248:255], v1
  ds_read_b128 v[208:211], v7 offset:20480
  ds_read_b128 v[212:215], v7 offset:21504
  v_smfmac_f32_16x16x64_bf16 v[16:19], v[32:35], v[64:71], v1
  ds_read_b128 v[216:219], v7 offset:22528
  ds_read_b128 v[220:223], v7 offset:23552
  s_nop 0
  v_smfmac_f32_16x16x64_bf16 v[16:19], v[36:39], v[72:79], v1
  s_waitcnt lgkmcnt(8)
  s_barrier
  ds_read_b128 v[224:227], v7 offset:24576
  v_add_f32 v12, v12, v14
  v_smfmac_f32_16x16x64_bf16 v[16:19], v[40:43], v[80:87], v1
  ds_read_b128 v[228:231], v7 offset:25600
  v_add_f32 v13, v13, v15
  v_smfmac_f32_16x16x64_bf16 v[16:19], v[44:47], v[88:95], v1
  ds_read_b128 v[232:235], v7 offset:26624
  v_cvt_pk_bf16_f32 v12, v12, v13
  v_smfmac_f32_16x16x64_bf16 v[16:19], v[48:51], v[96:103], v1
  ds_write_b32 v3, v12 offset:14336
  v_mov_b32 v29, 0
  v_smfmac_f32_16x16x64_bf16 v[16:19], v[52:55], v[104:111], v1
  ds_read_b128 v[236:239], v7 offset:27648
  v_mov_b32 v31, 0
  v_smfmac_f32_16x16x64_bf16 v[16:19], v[56:59], v[112:119], v1
  ds_read_b128 v[240:243], v7 offset:28672
  v_lshrrev_b32 v0, 7, v8
  v_smfmac_f32_16x16x64_bf16 v[16:19], v[60:63], v[120:127], v1
  ds_read_b128 v[244:247], v7 offset:29696
  ds_read_b128 v[248:251], v7 offset:30720
  s_waitcnt lgkmcnt(6)
  v_smfmac_f32_16x16x64_bf16 v[20:23], v[32:35], v[192:199], v1
  ds_read_b128 v[252:255], v7 offset:31744
  s_nop 1
  v_smfmac_f32_16x16x64_bf16 v[20:23], v[36:39], v[200:207], v1
  s_nop 0
  v_add_f32 v16, v16, v18
  v_add_f32 v17, v17, v19
  v_cvt_pk_bf16_f32 v16, v16, v17
  v_smfmac_f32_16x16x64_bf16 v[20:23], v[40:43], v[208:215], v1
  ds_write_b32 v3, v16 offset:14340
  v_lshlrev_b32 v0, 5, v0
  v_smfmac_f32_16x16x64_bf16 v[20:23], v[44:47], v[216:223], v1
  s_waitcnt vmcnt(9)
  v_add_u32 v0, 8204, v0
  v_smfmac_f32_16x16x64_bf16 v[20:23], v[48:51], v[224:231], v1
  s_cmp_eq_u32 s34, 63
  v_lshrrev_b32 v12, 2, v3
  s_waitcnt lgkmcnt(1)
  v_smfmac_f32_16x16x64_bf16 v[20:23], v[52:55], v[232:239], v1
  v_smfmac_f32_16x16x64_bf16 v[20:23], v[56:59], v[240:247], v1
  v_smfmac_f32_16x16x64_bf16 v[20:23], v[60:63], v[248:255], v1
  s_waitcnt lgkmcnt(0)
  s_barrier
  ds_read_b128 v[24:27], v3 offset:0
  ds_read_b32 v28, v3 offset:1024
  ds_read_b128 v[192:195], v7 offset:32768
  ds_read_b128 v[196:199], v7 offset:33792
  ds_read_b128 v[200:203], v7 offset:34816
  ds_read_b128 v[204:207], v7 offset:35840
  ds_read_b128 v[208:211], v7 offset:36864
  ds_read_b128 v[212:215], v7 offset:37888
  ds_read_b128 v[216:219], v7 offset:38912
  ds_read_b128 v[220:223], v7 offset:39936
  v_add_f32 v20, v20, v22
  v_add_f32 v21, v21, v23
  v_cvt_pk_bf16_f32 v30, v20, v21
  s_waitcnt lgkmcnt(8)
  s_mov_b32 s24, 0xff00ff
  v_mfma_f32_16x16x16_bf16 v[24:27], v[30:31], v[28:29], v[24:27]
  buffer_store_dword v30, v12, s[4:7], s45 offen offset:1536 sc1
  s_cbranch_scc1 cf1_exit
  s_mov_b32 s25, s24
  v_mov_b64 v[48:49], 0
  v_mov_b64 v[50:51], 0
  v_mov_b64 v[52:53], 0
  v_mov_b64 v[54:55], 0
  v_mov_b64 v[56:57], 0
  v_cvt_pk_bf16_f32 v24, v24, v25
  v_cvt_pk_bf16_f32 v25, v26, v27
  s_mov_b64 exec, s[24:25]
  ds_write_b64 v4, v[24:25] offset:13320
  s_mov_b64 exec, -1
  ds_write_b32 v3, v30 offset:15368
  v_mov_b64 v[58:59], 0
  v_mov_b64 v[60:61], 0
  v_mov_b64 v[62:63], 0
  s_waitcnt lgkmcnt(0)
  s_barrier
cf1_wo:
  ds_read_b128 v[32:35], v8 offset:12288
  ds_read_b128 v[36:39], v8 offset:12800
  ds_read_b128 v[40:43], v8 offset:13312
  ds_read_b128 v[44:47], v8 offset:13824
  s_waitcnt lgkmcnt(3)
  v_smfmac_f32_16x16x64_bf16 v[48:51], v[32:35], v[128:135], v1 abid:1
  ds_read2_b32 v[28:29], v0 offset0:0 offset1:4
  s_waitcnt lgkmcnt(3)
  v_smfmac_f32_16x16x64_bf16 v[48:51], v[36:39], v[136:143], v1 abid:1
  ds_read_b128 v[224:227], v7 offset:40960
  ds_read_b128 v[228:231], v7 offset:41984
  s_waitcnt lgkmcnt(4)
  v_smfmac_f32_16x16x64_bf16 v[48:51], v[40:43], v[144:151], v1 abid:1
  ds_read_b128 v[232:235], v7 offset:43008
  ds_read_b128 v[236:239], v7 offset:44032
  s_waitcnt lgkmcnt(5)
  v_smfmac_f32_16x16x64_bf16 v[48:51], v[44:47], v[152:159], v1 abid:1
  ds_read_b128 v[240:243], v7 offset:45056
  ds_read_b128 v[244:247], v7 offset:46080
  v_smfmac_f32_16x16x64_bf16 v[52:55], v[32:35], v[160:167], v1 abid:1
  ds_read_b128 v[248:251], v7 offset:47104
  ds_read_b128 v[252:255], v7 offset:48128
  s_nop 0
  v_smfmac_f32_16x16x64_bf16 v[52:55], v[36:39], v[168:175], v1 abid:1
  s_waitcnt lgkmcnt(8)
  v_cmp_gt_f32 vcc, 0, v28
  v_mul_f32 v48, v28, v48
  v_mul_f32 v49, v29, v49
  v_mul_f32 v50, v28, v50
  v_mul_f32 v51, v29, v51
  v_cvt_pk_bf16_f32 v48, v48, v49
  v_cvt_pk_bf16_f32 v49, v50, v51
  v_smfmac_f32_16x16x64_bf16 v[52:55], v[40:43], v[176:183], v1 abid:1
  s_cbranch_vccnz cf1_redo
  buffer_store_dwordx2 v[48:49], v10, s[4:7], s36 offen offset:0
  v_smfmac_f32_16x16x64_bf16 v[52:55], v[44:47], v[184:191], v1 abid:1
  ds_read_b32 v16, v3 offset:10244
  ds_read_b32 v17, v3 offset:10252
  v_smfmac_f32_16x16x64_bf16 v[56:59], v[32:35], v[192:199], v1 abid:1
  ds_read_b32 v18, v3 offset:11268
  ds_read_b32 v19, v3 offset:11276
  s_nop 0
  v_smfmac_f32_16x16x64_bf16 v[56:59], v[36:39], v[200:207], v1 abid:1
  s_nop 0
  v_mul_f32 v52, v28, v52
  v_mul_f32 v53, v29, v53
  v_mul_f32 v54, v28, v54
  v_mul_f32 v55, v29, v55
  v_cvt_pk_bf16_f32 v52, v52, v53
  v_cvt_pk_bf16_f32 v53, v54, v55
  v_smfmac_f32_16x16x64_bf16 v[56:59], v[40:43], v[208:215], v1 abid:1
  buffer_store_dwordx2 v[52:53], v10, s[4:7], s36 offen offset:2048
  v_smfmac_f32_16x16x64_bf16 v[56:59], v[44:47], v[216:223], v1 abid:1
  s_nop 1
  s_waitcnt lgkmcnt(4)
  v_smfmac_f32_16x16x64_bf16 v[60:63], v[32:35], v[224:231], v1 abid:1
  s_nop 2
  v_smfmac_f32_16x16x64_bf16 v[60:63], v[36:39], v[232:239], v1 abid:1
  s_nop 0
  v_mul_f32 v56, v28, v56
  v_mul_f32 v57, v29, v57
  v_mul_f32 v58, v28, v58
  v_mul_f32 v59, v29, v59
  v_cvt_pk_bf16_f32 v56, v56, v57
  v_cvt_pk_bf16_f32 v57, v58, v59
  v_smfmac_f32_16x16x64_bf16 v[60:63], v[40:43], v[240:247], v1 abid:1
  buffer_store_dwordx2 v[56:57], v10, s[4:7], s51 offen offset:0
  v_smfmac_f32_16x16x64_bf16 v[60:63], v[44:47], v[248:255], v1 abid:1
  s_add_u32 s34, s34, 1
  s_and_b32 s41, s34, 3
  s_lshl_b32 s41, s41, 15
  s_add_u32 s35, s41, 84936704
  s_mov_b32 s40, 0
  s_nop 2
  v_mul_f32 v60, v28, v60
  v_mul_f32 v61, v29, v61
  v_mul_f32 v62, v28, v62
  v_mul_f32 v63, v29, v63
  v_cvt_pk_bf16_f32 v60, v60, v61
  v_cvt_pk_bf16_f32 v61, v62, v63
  buffer_store_dwordx2 v[60:61], v10, s[4:7], s51 offen offset:2048
  ds_read_b128 v[192:195], v7 offset:0
  ds_read_b128 v[196:199], v7 offset:1024
  ds_read_b128 v[200:203], v7 offset:2048
  ds_read_b128 v[204:207], v7 offset:3072
  ds_read_b128 v[208:211], v7 offset:4096
  ds_read_b128 v[212:215], v7 offset:5120
  ds_read_b128 v[216:219], v7 offset:6144
  ds_read_b128 v[220:223], v7 offset:7168
  ds_read_b128 v[224:227], v7 offset:8192
  ds_read_b128 v[228:231], v7 offset:9216
  ds_read_b128 v[232:235], v7 offset:10240
  ds_read_b128 v[236:239], v7 offset:11264
  buffer_load_dwordx4 v[32:35], v3, s[4:7], s37 offen offset:0 sc1
  buffer_load_dwordx4 v[36:39], v3, s[4:7], s37 offen offset:1024 sc1
  ds_read_b128 v[240:243], v7 offset:12288
  ds_read_b128 v[244:247], v7 offset:13312
  ds_read_b128 v[248:251], v7 offset:14336
  ds_read_b128 v[252:255], v7 offset:15360
  s_nop 7
  s_nop 7
  s_nop 7
  buffer_load_dwordx4 v[32:35], v3, s[4:7], s37 offen offset:0 sc1
  buffer_load_dwordx4 v[36:39], v3, s[4:7], s37 offen offset:1024 sc1
  s_branch cf1_pollA1
cf1_pollA:
  buffer_load_dwordx4 v[32:35], v3, s[4:7], s37 offen offset:0 sc1
  buffer_load_dwordx4 v[36:39], v3, s[4:7], s37 offen offset:1024 sc1
cf1_pollA1:
  s_add_u32 s40, s40, 1
  s_add_u32 s67, s67, 1
  s_mov_b32 s24, 3
  s_cmp_gt_u32 s40, 63
  s_cbranch_scc1 cf1_nanA
cf1_pollA2:
  s_waitcnt vmcnt(3) lgkmcnt(0)
  v_mfma_f32_16x16x32_bf16 v[20:23], v[16:19], v[32:35], 0
  s_waitcnt vmcnt(2) lgkmcnt(0)
  v_mfma_f32_16x16x32_bf16 v[20:23], v[16:19], v[36:39], v[20:23]
  s_nop 7
  v_cmp_class_f32 vcc, v22, s24
  v_add_f32_dpp v20, v20, v20 row_ror:4 row_mask:0xf bank_mask:0xf
  v_add_f32_dpp v21, v21, v21 row_ror:4 row_mask:0xf bank_mask:0xf
  s_nop 0
  v_add_f32_dpp v20, v20, v20 row_ror:8 row_mask:0xf bank_mask:0xf
  v_add_f32_dpp v21, v21, v21 row_ror:8 row_mask:0xf bank_mask:0xf
  v_cvt_pk_bf16_f32 v24, v20, v21
  s_cbranch_vccnz cf1_pollA
cf1_pub:
  buffer_store_dword v24, v2, s[4:7], s38 offen
  s_branch cf1_step
cf1_p1w:
  s_mov_b32 s51, 0
L_p1w_2:
  v_readlane_b32 s41, v11, 0
  v_readlane_b32 s42, v11, 1
  v_readlane_b32 s50, v11, 2
  v_readlane_b32 s48, v11, 3
  s_min_u32 s41, s41, s50
  s_min_u32 s42, s42, s48
  s_lshl_b32 s41, s41, 2
  s_lshl_b32 s42, s42, 2
  s_add_u32 s42, s42, 2
  s_min_u32 s48, s41, s42
  s_max_u32 s48, s48, 1
  s_sub_u32 s48, s48, 1
  s_cmp_eq_u32 s48, 63
  s_cselect_b32 s48, 64, s48
  s_cmp_lt_u32 s34, s48
  s_cbranch_scc1 cf1_p1d
  s_cmp_gt_u32 s51, 131072
  s_cbranch_scc1 cf1_p1d
  s_add_u32 s51, s51, 1
  buffer_load_dword v11, v9, s[4:7], s71 offen sc1
  s_waitcnt vmcnt(0)
  s_branch L_p1w_2
cf1_retryB:
cf1_nanA:
  s_waitcnt vmcnt(0)
  v_max3_u32 v0, v32, v33, v34
  v_max3_u32 v0, v0, v35, v36
  v_max3_u32 v0, v0, v37, v38
  v_max_u32 v0, v0, v39
  v_cmp_eq_u32 vcc, -1, v0
  s_nop 4
  s_cmp_eq_u64 vcc, 0
  s_cselect_b32 s24, 0, 3
  s_cmp_gt_u32 s40, 1048576
  s_cselect_b32 s24, 0, s24
  s_branch cf1_pollA2
cf1_redo:
  s_nop 7
  v_mov_b64 v[48:49], 0
  v_mov_b64 v[50:51], 0
  v_mov_b64 v[52:53], 0
  v_mov_b64 v[54:55], 0
  v_mov_b64 v[56:57], 0
  v_mov_b64 v[58:59], 0
  v_mov_b64 v[60:61], 0
  v_mov_b64 v[62:63], 0
  s_waitcnt lgkmcnt(0)
  s_barrier
  s_barrier
  s_branch cf1_wo
cf1_exit:
  s_waitcnt vmcnt(0)
  s_barrier
  s_endpgm
cf2_step:
  v_mov_b64 v[12:13], -1
  v_mov_b64 v[14:15], -1
  v_mov_b64 v[16:17], 0
  v_mov_b64 v[18:19], 0
  v_mov_b64 v[20:21], 0
  v_mov_b64 v[22:23], 0
  v_mov_b64 v[26:27], 0
  v_mov_b64 v[28:29], 0
  v_mov_b64 v[30:31], 0
  s_xor_b32 s37, s37, 0x40000
  s_xor_b32 s36, s36, 0x40000
  s_mov_b32 s40, 0
  v_mov_b64 v[24:25], 0
  s_add_u32 s46, s46, 262144
  s_min_u32 s46, s46, s70
  s_add_u32 s45, s45, 65536
  s_xor_b32 s47, s47, 0x40000
  s_waitcnt vmcnt(0)
  buffer_load_dwordx4 v[48:51], v3, s[4:7], s35 offen offset:0 sc1
  buffer_load_dwordx4 v[52:55], v3, s[4:7], s35 offen offset:1024 sc1
  s_barrier
  s_nop 7
  s_nop 7
  s_nop 7
  buffer_load_dwordx4 v[48:51], v3, s[4:7], s35 offen offset:0 sc1
  buffer_load_dwordx4 v[52:55], v3, s[4:7], s35 offen offset:1024 sc1
  s_branch cf2_chkB1
cf2_chkB:
  buffer_load_dwordx4 v[48:51], v3, s[4:7], s35 offen offset:0 sc1
  buffer_load_dwordx4 v[52:55], v3, s[4:7], s35 offen offset:1024 sc1
cf2_chkB1:
  s_add_u32 s40, s40, 1
  s_add_u32 s68, s68, 1
  s_cmp_gt_u32 s40, 1048576
  s_cselect_b32 s51, -1, -2
  s_waitcnt vmcnt(2)
  v_max3_u32 v0, v48, v49, v50
  v_max3_u32 v0, v0, v51, v52
  v_max3_u32 v0, v0, v53, v54
  v_max_u32 v0, v0, v55
  v_cmp_lt_u32 vcc, s51, v0
  ds_write_b128 v3, v[48:51] offset:4096
  ds_write_b128 v3, v[52:55] offset:5120
  s_cbranch_vccnz cf2_chkB
cf2_okB:
  v_smfmac_f32_16x16x64_bf16 v[16:19], v[48:51], a[32:39], v1
  v_mov_b32 v0, -1
  v_smfmac_f32_16x16x64_bf16 v[20:23], v[48:51], a[96:103], v1
  buffer_store_dword v0, v2, s[4:7], s39 offen
  v_smfmac_f32_16x16x64_bf16 v[16:19], v[52:55], a[40:47], v1
  s_mov_b32 s39, s38
  s_add_u32 s38, s38, 0x8000
  v_smfmac_f32_16x16x64_bf16 v[20:23], v[52:55], a[104:111], v1
  s_waitcnt lgkmcnt(0)
  s_barrier
  ds_read_b128 v[56:59], v3 offset:6144
  ds_read_b128 v[60:63], v3 offset:7168
  s_and_b32 s38, s38, 0xfffdffff
  s_sub_u32 s39, s39, 0x8000
  v_smfmac_f32_16x16x64_bf16 v[24:27], v[48:51], a[160:167], v1
  ds_read_b128 v[32:35], v3 offset:0
  ds_read_b128 v[36:39], v3 offset:1024
  v_smfmac_f32_16x16x64_bf16 v[28:31], v[48:51], a[224:231], v1
  ds_read_b128 v[40:43], v3 offset:2048
  ds_read_b128 v[44:47], v3 offset:3072
  v_smfmac_f32_16x16x64_bf16 v[24:27], v[52:55], a[168:175], v1
  v_smfmac_f32_16x16x64_bf16 v[28:31], v[52:55], a[232:239], v1
  s_waitcnt lgkmcnt(5)
  v_smfmac_f32_16x16x64_bf16 v[16:19], v[56:59], a[48:55], v1
  s_waitcnt lgkmcnt(4)
  v_smfmac_f32_16x16x64_bf16 v[16:19], v[60:63], a[56:63], v1
  s_waitcnt lgkmcnt(3)
  v_smfmac_f32_16x16x64_bf16 v[16:19], v[32:35], a[0:7], v1
  buffer_load_dwordx4 v3, s[4:7], s46 offen offset:0 sc1 lds
  s_waitcnt lgkmcnt(2)
  v_smfmac_f32_16x16x64_bf16 v[16:19], v[36:39], a[8:15], v1
  buffer_store_dwordx4 v[12:15], v3, s[4:7], s47 offen offset:0
  s_waitcnt lgkmcnt(1)
  v_smfmac_f32_16x16x64_bf16 v[16:19], v[40:43], a[16:23], v1
  s_waitcnt lgkmcnt(0)
  v_smfmac_f32_16x16x64_bf16 v[16:19], v[44:47], a[24:31], v1
  s_nop 1
  v_smfmac_f32_16x16x64_bf16 v[20:23], v[56:59], a[112:119], v1
  buffer_store_dwordx4 v[12:15], v3, s[4:7], s47 offen offset:1024
  buffer_load_dwordx4 v3, s[4:7], s46 offen offset:1024 sc1 lds
  s_nop 0
  v_smfmac_f32_16x16x64_bf16 v[20:23], v[60:63], a[120:127], v1
  s_nop 0
  v_add_f32 v16, v16, v18
  v_add_f32 v17, v17, v19
  v_smfmac_f32_16x16x64_bf16 v[20:23], v[32:35], a[64:71], v1
  v_mul_f32 v16, s43, v16
  v_mul_f32 v17, s43, v17
  v_smfmac_f32_16x16x64_bf16 v[20:23], v[36:39], a[72:79], v1
  buffer_store_dwordx4 v[12:15], v3, s[4:7], s47 offen offset:2048
  v_cvt_pk_bf16_f32 v16, v16, v17
  v_smfmac_f32_16x16x64_bf16 v[20:23], v[40:43], a[80:87], v1
  ds_write_b32 v5, v16 offset:13312
  buffer_load_dwordx4 v3, s[4:7], s46 offen offset:2048 sc1 lds
  v_smfmac_f32_16x16x64_bf16 v[20:23], v[44:47], a[88:95], v1
  s_nop 1
  v_smfmac_f32_16x16x64_bf16 v[24:27], v[56:59], a[176:183], v1
  s_nop 2
  v_smfmac_f32_16x16x64_bf16 v[24:27], v[60:63], a[184:191], v1
  s_nop 0
  v_add_f32 v20, v20, v22
  v_add_f32 v21, v21, v23
  v_mul_f32 v20, s43, v20
  v_mul_f32 v21, s43, v21
  v_cvt_pk_bf16_f32 v20, v20, v21
  v_smfmac_f32_16x16x64_bf16 v[24:27], v[32:35], a[128:135], v1
  ds_write_b32 v5, v20 offset:13568
  buffer_load_dwordx4 v3, s[4:7], s46 offen offset:3072 sc1 lds
  v_smfmac_f32_16x16x64_bf16 v[24:27], v[36:39], a[136:143], v1
  s_and_b32 s39, s39, 0x1ffff
  s_add_u32 s39, s39, 84934656
  v_mov_b64 v[12:13], 0
  v_smfmac_f32_16x16x64_bf16 v[24:27], v[40:43], a[144:151], v1
  s_add_u32 s51, s36, 4096
  v_mov_b64 v[14:15], 0
  v_smfmac_f32_16x16x64_bf16 v[24:27], v[44:47], a[152:159], v1
  s_waitcnt lgkmcnt(0)
  s_barrier
  v_smfmac_f32_16x16x64_bf16 v[28:31], v[56:59], a[240:247], v1
  s_nop 2
  v_smfmac_f32_16x16x64_bf16 v[28:31], v[60:63], a[248:255], v1
  s_nop 0
  v_add_f32 v24, v24, v26
  v_smfmac_f32_16x16x64_bf16 v[28:31], v[32:35], a[192:199], v1
  v_add_f32 v25, v25, v27
  v_smfmac_f32_16x16x64_bf16 v[28:31], v[36:39], a[200:207], v1
  v_cvt_pk_bf16_f32 v24, v24, v25
  v_smfmac_f32_16x16x64_bf16 v[28:31], v[40:43], a[208:215], v1
  ds_write_b32 v6, v24 offset:10240
  v_mov_b64 v[16:17], 0
  v_smfmac_f32_16x16x64_bf16 v[28:31], v[44:47], a[216:223], v1
  v_mov_b64 v[18:19], 0
  s_nop 0
  v_smfmac_f32_16x16x64_bf16 v[12:15], v[32:35], v[192:199], v1
  s_nop 2
  v_smfmac_f32_16x16x64_bf16 v[12:15], v[36:39], v[200:207], v1
  s_nop 0
  v_add_f32 v28, v28, v30
  v_add_f32 v29, v29, v31
  v_cvt_pk_bf16_f32 v28, v28, v29
  v_smfmac_f32_16x16x64_bf16 v[12:15], v[40:43], v[208:215], v1
  ds_write_b32 v6, v28 offset:10752
  v_smfmac_f32_16x16x64_bf16 v[12:15], v[44:47], v[216:223], v1
  ds_read_b128 v[192:195], v7 offset:16384
  v_smfmac_f32_16x16x64_bf16 v[12:15], v[48:51], v[224:231], v1
  ds_read_b128 v[196:199], v7 offset:17408
  v_mov_b64 v[20:21], 0
  v_smfmac_f32_16x16x64_bf16 v[12:15], v[52:55], v[232:239], v1
  ds_read_b128 v[200:203], v7 offset:18432
  v_mov_b64 v[22:23], 0
  v_smfmac_f32_16x16x64_bf16 v[12:15], v[56:59], v[240:247], v1
  ds_read_b128 v[204:207], v7 offset:19456
  v_smfmac_f32_16x16x64_bf16 v[12:15], v[60:63], v[248:255], v1
  ds_read_b128 v[208:211], v7 offset:20480
  ds_read_b128 v[212:215], v7 offset:21504
  v_smfmac_f32_16x16x64_bf16 v[16:19], v[32:35], v[64:71], v1
  ds_read_b128 v[216:219], v7 offset:22528
  ds_read_b128 v[220:223], v7 offset:23552
  s_nop 0
  v_smfmac_f32_16x16x64_bf16 v[16:19], v[36:39], v[72:79], v1
  s_waitcnt lgkmcnt(8)
  s_barrier
  ds_read_b128 v[224:227], v7 offset:24576
  v_add_f32 v12, v12, v14
  v_smfmac_f32_16x16x64_bf16 v[16:19], v[40:43], v[80:87], v1
  ds_read_b128 v[228:231], v7 offset:25600
  v_add_f32 v13, v13, v15
  v_smfmac_f32_16x16x64_bf16 v[16:19], v[44:47], v[88:95], v1
  ds_read_b128 v[232:235], v7 offset:26624
  v_cvt_pk_bf16_f32 v12, v12, v13
  v_smfmac_f32_16x16x64_bf16 v[16:19], v[48:51], v[96:103], v1
  ds_write_b32 v3, v12 offset:14344
  v_mov_b32 v29, 0
  v_smfmac_f32_16x16x64_bf16 v[16:19], v[52:55], v[104:111], v1
  ds_read_b128 v[236:239], v7 offset:27648
  v_mov_b32 v31, 0
  v_smfmac_f32_16x16x64_bf16 v[16:19], v[56:59], v[112:119], v1
  ds_read_b128 v[240:243], v7 offset:28672
  v_lshrrev_b32 v0, 7, v8
  v_smfmac_f32_16x16x64_bf16 v[16:19], v[60:63], v[120:127], v1
  ds_read_b128 v[244:247], v7 offset:29696
  ds_read_b128 v[248:251], v7 offset:30720
  s_waitcnt lgkmcnt(6)
  v_smfmac_f32_16x16x64_bf16 v[20:23], v[32:35], v[192:199], v1
  ds_read_b128 v[252:255], v7 offset:31744
  s_nop 1
  v_smfmac_f32_16x16x64_bf16 v[20:23], v[36:39], v[200:207], v1
  s_nop 0
  v_add_f32 v16, v16, v18
  v_add_f32 v17, v17, v19
  v_cvt_pk_bf16_f32 v16, v16, v17
  v_smfmac_f32_16x16x64_bf16 v[20:23], v[40:43], v[208:215], v1
  ds_write_b32 v3, v16 offset:14348
  v_lshlrev_b32 v0, 5, v0
  v_smfmac_f32_16x16x64_bf16 v[20:23], v[44:47], v[216:223], v1
  s_waitcnt vmcnt(8)
  v_add_u32 v0, 8204, v0
  v_smfmac_f32_16x16x64_bf16 v[20:23], v[48:51], v[224:231], v1
  s_cmp_eq_u32 s34, 63
  v_lshrrev_b32 v12, 2, v3
  s_waitcnt lgkmcnt(1)
  v_smfmac_f32_16x16x64_bf16 v[20:23], v[52:55], v[232:239], v1
  v_smfmac_f32_16x16x64_bf16 v[20:23], v[56:59], v[240:247], v1
  v_smfmac_f32_16x16x64_bf16 v[20:23], v[60:63], v[248:255], v1
  s_waitcnt lgkmcnt(0)
  s_barrier
  ds_read_b128 v[24:27], v3 offset:0
  ds_read_b32 v28, v3 offset:1024
  ds_read_b128 v[192:195], v7 offset:32768
  ds_read_b128 v[196:199], v7 offset:33792
  ds_read_b128 v[200:203], v7 offset:34816
  ds_read_b128 v[204:207], v7 offset:35840
  ds_read_b128 v[208:211], v7 offset:36864
  ds_read_b128 v[212:215], v7 offset:37888
  ds_read_b128 v[216:219], v7 offset:38912
  ds_read_b128 v[220:223], v7 offset:39936
  v_add_f32 v20, v20, v22
  v_add_f32 v21, v21, v23
  v_cvt_pk_bf16_f32 v30, v20, v21
  s_waitcnt lgkmcnt(8)
  s_mov_b32 s24, 0xff00ff00
  v_mfma_f32_16x16x16_bf16 v[24:27], v[30:31], v[28:29], v[24:27]
  buffer_store_dword v30, v12, s[4:7], s45 offen offset:1792 sc1
  s_cbranch_scc1 cf2_exit
  s_mov_b32 s25, s24
  v_mov_b64 v[48:49], 0
  v_mov_b64 v[50:51], 0
  v_mov_b64 v[52:53], 0
  v_mov_b64 v[54:55], 0
  v_mov_b64 v[56:57], 0
  v_cvt_pk_bf16_f32 v24, v24, v25
  v_cvt_pk_bf16_f32 v25, v26, v27
  s_mov_b64 exec, s[24:25]
  ds_write_b64 v4, v[24:25] offset:13320
  s_mov_b64 exec, -1
  ds_write_b32 v3, v30 offset:15372
  v_mov_b64 v[58:59], 0
  v_mov_b64 v[60:61], 0
  v_mov_b64 v[62:63], 0
  s_waitcnt lgkmcnt(0)
  s_barrier
cf2_wo:
  ds_read_b128 v[32:35], v8 offset:12288
  ds_read_b128 v[36:39], v8 offset:12800
  ds_read_b128 v[40:43], v8 offset:13312
  ds_read_b128 v[44:47], v8 offset:13824
  s_waitcnt lgkmcnt(3)
  v_smfmac_f32_16x16x64_bf16 v[48:51], v[32:35], v[128:135], v1 abid:1
  ds_read2_b32 v[28:29], v0 offset0:0 offset1:4
  s_waitcnt lgkmcnt(3)
  v_smfmac_f32_16x16x64_bf16 v[48:51], v[36:39], v[136:143], v1 abid:1
  ds_read_b128 v[224:227], v7 offset:40960
  ds_read_b128 v[228:231], v7 offset:41984
  s_waitcnt lgkmcnt(4)
  v_smfmac_f32_16x16x64_bf16 v[48:51], v[40:43], v[144:151], v1 abid:1
  ds_read_b128 v[232:235], v7 offset:43008
  ds_read_b128 v[236:239], v7 offset:44032
  s_waitcnt lgkmcnt(5)
  v_smfmac_f32_16x16x64_bf16 v[48:51], v[44:47], v[152:159], v1 abid:1
  ds_read_b128 v[240:243], v7 offset:45056
  ds_read_b128 v[244:247], v7 offset:46080
  v_smfmac_f32_16x16x64_bf16 v[52:55], v[32:35], v[160:167], v1 abid:1
  ds_read_b128 v[248:251], v7 offset:47104
  ds_read_b128 v[252:255], v7 offset:48128
  s_nop 0
  v_smfmac_f32_16x16x64_bf16 v[52:55], v[36:39], v[168:175], v1 abid:1
  s_waitcnt lgkmcnt(8)
  v_cmp_gt_f32 vcc, 0, v28
  v_mul_f32 v48, v28, v48
  v_mul_f32 v49, v29, v49
  v_mul_f32 v50, v28, v50
  v_mul_f32 v51, v29, v51
  v_cvt_pk_bf16_f32 v48, v48, v49
  v_cvt_pk_bf16_f32 v49, v50, v51
  v_smfmac_f32_16x16x64_bf16 v[52:55], v[40:43], v[176:183], v1 abid:1
  s_cbranch_vccnz cf2_redo
  buffer_store_dwordx2 v[48:49], v10, s[4:7], s36 offen offset:0
  v_smfmac_f32_16x16x64_bf16 v[52:55], v[44:47], v[184:191], v1 abid:1
  ds_read_b32 v16, v3 offset:10244
  ds_read_b32 v17, v3 offset:10252
  v_smfmac_f32_16x16x64_bf16 v[56:59], v[32:35], v[192:199], v1 abid:1
  ds_read_b32 v18, v3 offset:11268
  ds_read_b32 v19, v3 offset:11276
  s_nop 0
  v_smfmac_f32_16x16x64_bf16 v[56:59], v[36:39], v[200:207], v1 abid:1
  s_nop 0
  v_mul_f32 v52, v28, v52
  v_mul_f32 v53, v29, v53
  v_mul_f32 v54, v28, v54
  v_mul_f32 v55, v29, v55
  v_cvt_pk_bf16_f32 v52, v52, v53
  v_cvt_pk_bf16_f32 v53, v54, v55
  v_smfmac_f32_16x16x64_bf16 v[56:59], v[40:43], v[208:215], v1 abid:1
  buffer_store_dwordx2 v[52:53], v10, s[4:7], s36 offen offset:2048
  v_smfmac_f32_16x16x64_bf16 v[56:59], v[44:47], v[216:223], v1 abid:1
  s_nop 1
  s_waitcnt lgkmcnt(4)
  v_smfmac_f32_16x16x64_bf16 v[60:63], v[32:35], v[224:231], v1 abid:1
  s_nop 2
  v_smfmac_f32_16x16x64_bf16 v[60:63], v[36:39], v[232:239], v1 abid:1
  s_nop 0
  v_mul_f32 v56, v28, v56
  v_mul_f32 v57, v29, v57
  v_mul_f32 v58, v28, v58
  v_mul_f32 v59, v29, v59
  v_cvt_pk_bf16_f32 v56, v56, v57
  v_cvt_pk_bf16_f32 v57, v58, v59
  v_smfmac_f32_16x16x64_bf16 v[60:63], v[40:43], v[240:247], v1 abid:1
  buffer_store_dwordx2 v[56:57], v10, s[4:7], s51 offen offset:0
  v_smfmac_f32_16x16x64_bf16 v[60:63], v[44:47], v[248:255], v1 abid:1
  s_add_u32 s34, s34, 1
  s_and_b32 s41, s34, 3
  s_lshl_b32 s41, s41, 15
  s_add_u32 s35, s41, 84938752
  s_mov_b32 s40, 0
  s_nop 2
  v_mul_f32 v60, v28, v60
  v_mul_f32 v61, v29, v61
  v_mul_f32 v62, v28, v62
  v_mul_f32 v63, v29, v63
  v_cvt_pk_bf16_f32 v60, v60, v61
  v_cvt_pk_bf16_f32 v61, v62, v63
  buffer_store_dwordx2 v[60:61], v10, s[4:7], s51 offen offset:2048
  ds_read_b128 v[192:195], v7 offset:0
  ds_read_b128 v[196:199], v7 offset:1024
  ds_read_b128 v[200:203], v7 offset:2048
  ds_read_b128 v[204:207], v7 offset:3072
  s_waitcnt vmcnt(1)
  buffer_load_dwordx4 v[32:35], v3, s[4:7], s37 offen offset:0 sc1
  buffer_load_dwordx4 v[36:39], v3, s[4:7], s37 offen offset:1024 sc1
  ds_read_b128 v[208:211], v7 offset:4096
  ds_read_b128 v[212:215], v7 offset:5120
  ds_read_b128 v[216:219], v7 offset:6144
  ds_read_b128 v[220:223], v7 offset:7168
  ds_read_b128 v[224:227], v7 offset:8192
  ds_read_b128 v[228:231], v7 offset:9216
  ds_read_b128 v[232:235], v7 offset:10240
  ds_read_b128 v[236:239], v7 offset:11264
  ds_read_b128 v[240:243], v7 offset:12288
  ds_read_b128 v[244:247], v7 offset:13312
  ds_read_b128 v[248:251], v7 offset:14336
  ds_read_b128 v[252:255], v7 offset:15360
  s_nop 7
  s_nop 7
  buffer_load_dwordx4 v[32:35], v3, s[4:7], s37 offen offset:0 sc1
  buffer_load_dwordx4 v[36:39], v3, s[4:7], s37 offen offset:1024 sc1
  s_branch cf2_pollA1
cf2_pollA:
  buffer_load_dwordx4 v[32:35], v3, s[4:7], s37 offen offset:0 sc1
  buffer_load_dwordx4 v[36:39], v3, s[4:7], s37 offen offset:1024 sc1
cf2_pollA1:
  s_add_u32 s40, s40, 1
  s_add_u32 s67, s67, 1
  s_mov_b32 s24, 3
  s_cmp_gt_u32 s40, 63
  s_cbranch_scc1 cf2_nanA
cf2_pollA2:
  s_waitcnt vmcnt(3) lgkmcnt(0)
  v_mfma_f32_16x16x32_bf16 v[20:23], v[16:19], v[32:35], 0
  s_waitcnt vmcnt(2) lgkmcnt(0)
  v_mfma_f32_16x16x32_bf16 v[20:23], v[16:19], v[36:39], v[20:23]
  s_nop 7
  v_cmp_class_f32 vcc, v22, s24
  v_add_f32_dpp v20, v20, v20 row_ror:4 row_mask:0xf bank_mask:0xf
  v_add_f32_dpp v21, v21, v21 row_ror:4 row_mask:0xf bank_mask:0xf
  s_nop 0
  v_add_f32_dpp v20, v20, v20 row_ror:8 row_mask:0xf bank_mask:0xf
  v_add_f32_dpp v21, v21, v21 row_ror:8 row_mask:0xf bank_mask:0xf
  v_cvt_pk_bf16_f32 v24, v20, v21
  s_cbranch_vccnz cf2_pollA
cf2_pub:
  buffer_store_dword v24, v2, s[4:7], s38 offen
  s_branch cf2_step
cf2_retryB:
cf2_nanA:
  s_waitcnt vmcnt(0)
  v_max3_u32 v0, v32, v33, v34
  v_max3_u32 v0, v0, v35, v36
  v_max3_u32 v0, v0, v37, v38
  v_max_u32 v0, v0, v39
  v_cmp_eq_u32 vcc, -1, v0
  s_nop 4
  s_cmp_eq_u64 vcc, 0
  s_cselect_b32 s24, 0, 3
  s_cmp_gt_u32 s40, 1048576
  s_cselect_b32 s24, 0, s24
  s_branch cf2_pollA2
cf2_redo:
  s_nop 7
  v_mov_b64 v[48:49], 0
  v_mov_b64 v[50:51], 0
  v_mov_b64 v[52:53], 0
  v_mov_b64 v[54:55], 0
  v_mov_b64 v[56:57], 0
  v_mov_b64 v[58:59], 0
  v_mov_b64 v[60:61], 0
  v_mov_b64 v[62:63], 0
  s_waitcnt lgkmcnt(0)
  s_barrier
  s_barrier
  s_branch cf2_wo
cf2_exit:
  s_waitcnt vmcnt(0)
  s_barrier
  s_endpgm
cf3_step:
  v_mov_b64 v[12:13], -1
  v_mov_b64 v[14:15], -1
  v_mov_b64 v[16:17], 0
  v_mov_b64 v[18:19], 0
  v_mov_b64 v[20:21], 0
  v_mov_b64 v[22:23], 0
  v_mov_b64 v[26:27], 0
  v_mov_b64 v[28:29], 0
  v_mov_b64 v[30:31], 0
  s_xor_b32 s37, s37, 0x40000
  s_xor_b32 s36, s36, 0x40000
  s_mov_b32 s40, 0
  v_mov_b64 v[24:25], 0
  s_add_u32 s46, s46, 262144
  s_min_u32 s46, s46, s70
  s_add_u32 s45, s45, 65536
  s_xor_b32 s47, s47, 0x40000
  s_nop 7
  s_nop 7
  s_nop 3
  buffer_load_dwordx4 v[56:59], v3, s[4:7], s35 offen offset:0 sc1
  buffer_load_dwordx4 v[60:63], v3, s[4:7], s35 offen offset:1024 sc1
  s_barrier
  s_nop 7
  s_nop 7
  s_nop 7
  buffer_load_dwordx4 v[56:59], v3, s[4:7], s35 offen offset:0 sc1
  buffer_load_dwordx4 v[60:63], v3, s[4:7], s35 offen offset:1024 sc1
  s_branch cf3_chkB1
cf3_chkB:
  buffer_load_dwordx4 v[56:59], v3, s[4:7], s35 offen offset:0 sc1
  buffer_load_dwordx4 v[60:63], v3, s[4:7], s35 offen offset:1024 sc1
cf3_chkB1:
  s_add_u32 s40, s40, 1
  s_add_u32 s68, s68, 1
  s_cmp_gt_u32 s40, 1048576
  s_cselect_b32 s51, -1, -2
  s_waitcnt vmcnt(2)
  v_max3_u32 v0, v56, v57, v58
  v_max3_u32 v0, v0, v59, v60
  v_max3_u32 v0, v0, v61, v62
  v_max_u32 v0, v0, v63
  v_cmp_lt_u32 vcc, s51, v0
  ds_write_b128 v3, v[56:59] offset:6144
  ds_write_b128 v3, v[60:63] offset:7168
  s_cbranch_vccnz cf3_chkB
cf3_okB:
  v_smfmac_f32_16x16x64_bf16 v[16:19], v[56:59], a[48:55], v1
  v_mov_b32 v0, -1
  v_smfmac_f32_16x16x64_bf16 v[20:23], v[56:59], a[112:119], v1
  buffer_store_dword v0, v2, s[4:7], s39 offen
  v_smfmac_f32_16x16x64_bf16 v[16:19], v[60:63], a[56:63], v1
  s_mov_b32 s39, s38
  s_add_u32 s38, s38, 0x8000
  v_smfmac_f32_16x16x64_bf16 v[20:23], v[60:63], a[120:127], v1
  s_waitcnt lgkmcnt(0)
  s_barrier
  ds_read_b128 v[32:35], v3 offset:0
  ds_read_b128 v[36:39], v3 offset:1024
  s_and_b32 s38, s38, 0xfffdffff
  s_sub_u32 s39, s39, 0x8000
  v_smfmac_f32_16x16x64_bf16 v[24:27], v[56:59], a[176:183], v1
  ds_read_b128 v[40:43], v3 offset:2048
  ds_read_b128 v[44:47], v3 offset:3072
  v_smfmac_f32_16x16x64_bf16 v[28:31], v[56:59], a[240:247], v1
  ds_read_b128 v[48:51], v3 offset:4096
  ds_read_b128 v[52:55], v3 offset:5120
  v_smfmac_f32_16x16x64_bf16 v[24:27], v[60:63], a[184:191], v1
  v_smfmac_f32_16x16x64_bf16 v[28:31], v[60:63], a[248:255], v1
  s_waitcnt lgkmcnt(5)
  v_smfmac_f32_16x16x64_bf16 v[16:19], v[32:35], a[0:7], v1
  s_waitcnt lgkmcnt(4)
  v_smfmac_f32_16x16x64_bf16 v[16:19], v[36:39], a[8:15], v1
  s_waitcnt lgkmcnt(3)
  v_smfmac_f32_16x16x64_bf16 v[16:19], v[40:43], a[16:23], v1
  s_waitcnt lgkmcnt(2)
  v_smfmac_f32_16x16x64_bf16 v[16:19], v[44:47], a[24:31], v1
  buffer_load_dwordx4 v3, s[4:7], s46 offen offset:0 sc1 lds
  s_waitcnt lgkmcnt(1)
  v_smfmac_f32_16x16x64_bf16 v[16:19], v[48:51], a[32:39], v1
  buffer_store_dwordx4 v[12:15], v3, s[4:7], s47 offen offset:0
  s_waitcnt lgkmcnt(0)
  v_smfmac_f32_16x16x64_bf16 v[16:19], v[52:55], a[40:47], v1
  s_nop 1
  v_smfmac_f32_16x16x64_bf16 v[20:23], v[32:35], a[64:71], v1
  s_nop 2
  v_smfmac_f32_16x16x64_bf16 v[20:23], v[36:39], a[72:79], v1
  buffer_store_dwordx4 v[12:15], v3, s[4:7], s47 offen offset:1024
  buffer_load_dwordx4 v3, s[4:7], s46 offen offset:1024 sc1 lds
  v_add_f32 v16, v16, v18
  v_add_f32 v17, v17, v19
  v_smfmac_f32_16x16x64_bf16 v[20:23], v[40:43], a[80:87], v1
  v_mul_f32 v16, s43, v16
  v_mul_f32 v17, s43, v17
  v_smfmac_f32_16x16x64_bf16 v[20:23], v[44:47], a[88:95], v1
  v_cvt_pk_bf16_f32 v16, v16, v17
  v_smfmac_f32_16x16x64_bf16 v[20:23], v[48:51], a[96:103], v1
  ds_write_b32 v5, v16 offset:13824
  v_smfmac_f32_16x16x64_bf16 v[20:23], v[52:55], a[104:111], v1
  buffer_load_dwordx4 v3, s[4:7], s46 offen offset:2048 sc1 lds
  s_nop 0
  v_smfmac_f32_16x16x64_bf16 v[24:27], v[32:35], a[128:135], v1
  s_nop 2
  v_smfmac_f32_16x16x64_bf16 v[24:27], v[36:39], a[136:143], v1
  s_nop 0
  v_add_f32 v20, v20, v22
  v_add_f32 v21, v21, v23
  v_mul_f32 v20, s43, v20
  v_mul_f32 v21, s43, v21
  v_cvt_pk_bf16_f32 v20, v20, v21
  v_smfmac_f32_16x16x64_bf16 v[24:27], v[40:43], a[144:151], v1
  ds_write_b32 v5, v20 offset:14080
  v_smfmac_f32_16x16x64_bf16 v[24:27], v[44:47], a[152:159], v1
  s_and_b32 s39, s39, 0x1ffff
  s_add_u32 s39, s39, 84934656
  v_mov_b64 v[12:13], 0
  buffer_load_dwordx4 v3, s[4:7], s46 offen offset:3072 sc1 lds
  v_smfmac_f32_16x16x64_bf16 v[24:27], v[48:51], a[160:167], v1
  s_add_u32 s51, s36, 4096
  v_mov_b64 v[14:15], 0
  v_smfmac_f32_16x16x64_bf16 v[24:27], v[52:55], a[168:175], v1
  s_waitcnt lgkmcnt(0)
  s_barrier
  v_smfmac_f32_16x16x64_bf16 v[28:31], v[32:35], a[192:199], v1
  s_nop 2
  v_smfmac_f32_16x16x64_bf16 v[28:31], v[36:39], a[200:207], v1
  s_nop 0
  v_add_f32 v24, v24, v26
  v_smfmac_f32_16x16x64_bf16 v[28:31], v[40:43], a[208:215], v1
  v_add_f32 v25, v25, v27
  v_smfmac_f32_16x16x64_bf16 v[28:31], v[44:47], a[216:223], v1
  v_cvt_pk_bf16_f32 v24, v24, v25
  v_smfmac_f32_16x16x64_bf16 v[28:31], v[48:51], a[224:231], v1
  ds_write_b32 v6, v24 offset:11264
  v_mov_b64 v[16:17], 0
  v_smfmac_f32_16x16x64_bf16 v[28:31], v[52:55], a[232:239], v1
  v_mov_b64 v[18:19], 0
  s_nop 0
  v_smfmac_f32_16x16x64_bf16 v[12:15], v[32:35], v[192:199], v1
  s_nop 2
  v_smfmac_f32_16x16x64_bf16 v[12:15], v[36:39], v[200:207], v1
  s_nop 0
  v_add_f32 v28, v28, v30
  v_add_f32 v29, v29, v31
  v_cvt_pk_bf16_f32 v28, v28, v29
  v_smfmac_f32_16x16x64_bf16 v[12:15], v[40:43], v[208:215], v1
  ds_write_b32 v6, v28 offset:11776
  v_smfmac_f32_16x16x64_bf16 v[12:15], v[44:47], v[216:223], v1
  v_smfmac_f32_16x16x64_bf16 v[12:15], v[48:51], v[224:231], v1
  v_smfmac_f32_16x16x64_bf16 v[12:15], v[52:55], v[232:239], v1
  v_smfmac_f32_16x16x64_bf16 v[12:15], v[56:59], v[240:247], v1
  v_smfmac_f32_16x16x64_bf16 v[12:15], v[60:63], v[248:255], v1
  s_nop 1
  v_smfmac_f32_16x16x64_bf16 v[16:19], v[32:35], v[64:71], v1
  v_mov_b32 v11, s34
  s_nop 1
  v_smfmac_f32_16x16x64_bf16 v[16:19], v[36:39], v[72:79], v1
  s_waitcnt lgkmcnt(0)
  s_barrier
  v_add_f32 v12, v12, v14
  v_smfmac_f32_16x16x64_bf16 v[16:19], v[40:43], v[80:87], v1
  v_add_f32 v13, v13, v15
  v_smfmac_f32_16x16x64_bf16 v[16:19], v[44:47], v[88:95], v1
  v_cvt_pk_bf16_f32 v12, v12, v13
  v_smfmac_f32_16x16x64_bf16 v[16:19], v[48:51], v[96:103], v1
  ds_write_b32 v3, v12 offset:15360
  v_smfmac_f32_16x16x64_bf16 v[16:19], v[52:55], v[104:111], v1
  s_mov_b64 exec, 1
  buffer_store_dword v11, off, s[4:7], s49 sc1
  s_mov_b64 exec, -1
  v_smfmac_f32_16x16x64_bf16 v[16:19], v[56:59], v[112:119], v1
  v_smfmac_f32_16x16x64_bf16 v[16:19], v[60:63], v[120:127], v1
  s_waitcnt vmcnt(8)
  ds_read_b64_tr_b16 v[32:33], v4 offset:8192
  ds_read_b64_tr_b16 v[34:35], v4 offset:8704
  ds_read_b64_tr_b16 v[36:37], v4 offset:9216
  ds_read_b64_tr_b16 v[38:39], v4 offset:9728
  ds_read_b64_tr_b16 v[40:41], v4 offset:10240
  ds_read_b64_tr_b16 v[42:43], v4 offset:10752
  ds_read_b64_tr_b16 v[44:45], v4 offset:11264
  v_add_f32 v16, v16, v18
  v_add_f32 v17, v17, v19
  v_cvt_pk_bf16_f32 v16, v16, v17
  ds_write_b32 v3, v16 offset:15364
  ds_read_b64_tr_b16 v[46:47], v4 offset:11776
  s_add_u32 s42, s45, 4194304
  s_cmp_eq_u32 s34, 63
  s_waitcnt lgkmcnt(0)
  s_barrier
  ds_read_b128 v[16:19], v3 offset:14336
  ds_read_b64 v[20:21], v3 offset:15360
  s_mov_b32 exec_lo, 0x33333333
  s_mov_b32 exec_hi, 0x33333333
  buffer_store_dwordx4 v[32:35], v9, s[4:7], s45 offen offset:0 sc1
  buffer_store_dwordx4 v[36:39], v9, s[4:7], s45 offen offset:512 sc1
  buffer_store_dwordx4 v[40:43], v9, s[4:7], s45 offen offset:1024 sc1
  buffer_store_dwordx4 v[44:47], v9, s[4:7], s45 offen offset:1536 sc1
  s_mov_b64 exec, -1
  s_waitcnt lgkmcnt(0)
  buffer_store_dwordx4 v[16:19], v3, s[4:7], s42 offen sc1
  buffer_store_dwordx2 v[20:21], v4, s[4:7], s42 offen offset:1024 sc1
  s_cbranch_scc1 cf3_exit
  ds_read_b128 v[192:195], v7 offset:16384
  ds_read_b128 v[196:199], v7 offset:17408
  ds_read_b128 v[200:203], v7 offset:18432
  ds_read_b128 v[204:207], v7 offset:19456
  ds_read_b128 v[208:211], v7 offset:20480
  ds_read_b128 v[212:215], v7 offset:21504
  ds_read_b128 v[216:219], v7 offset:22528
  ds_read_b128 v[220:223], v7 offset:23552
  v_lshrrev_b32 v0, 7, v8
  v_lshlrev_b32 v0, 5, v0
  v_add_u32 v0, 8204, v0
  v_mov_b64 v[48:49], 0
  v_mov_b64 v[50:51], 0
  v_mov_b64 v[52:53], 0
  v_mov_b64 v[54:55], 0
  v_mov_b64 v[56:57], 0
  v_mov_b64 v[58:59], 0
  v_mov_b64 v[60:61], 0
  v_mov_b64 v[62:63], 0
  s_barrier
cf3_wo:
  ds_read_b128 v[32:35], v8 offset:12288
  ds_read_b128 v[36:39], v8 offset:12800
  ds_read_b128 v[40:43], v8 offset:13312
  ds_read_b128 v[44:47], v8 offset:13824
  s_waitcnt lgkmcnt(3)
  v_smfmac_f32_16x16x64_bf16 v[48:51], v[32:35], v[128:135], v1 abid:1
  ds_read2_b32 v[28:29], v0 offset0:0 offset1:4
  s_waitcnt lgkmcnt(3)
  v_smfmac_f32_16x16x64_bf16 v[48:51], v[36:39], v[136:143], v1 abid:1
  ds_read_b128 v[224:227], v7 offset:24576
  ds_read_b128 v[228:231], v7 offset:25600
  s_waitcnt lgkmcnt(4)
  v_smfmac_f32_16x16x64_bf16 v[48:51], v[40:43], v[144:151], v1 abid:1
  ds_read_b128 v[232:235], v7 offset:26624
  ds_read_b128 v[236:239], v7 offset:27648
  s_waitcnt lgkmcnt(5)
  v_smfmac_f32_16x16x64_bf16 v[48:51], v[44:47], v[152:159], v1 abid:1
  ds_read_b128 v[240:243], v7 offset:28672
  ds_read_b128 v[244:247], v7 offset:29696
  v_smfmac_f32_16x16x64_bf16 v[52:55], v[32:35], v[160:167], v1 abid:1
  ds_read_b128 v[248:251], v7 offset:30720
  ds_read_b128 v[252:255], v7 offset:31744
  s_nop 0
  v_smfmac_f32_16x16x64_bf16 v[52:55], v[36:39], v[168:175], v1 abid:1
  s_waitcnt lgkmcnt(8)
  v_cmp_gt_f32 vcc, 0, v28
  v_mul_f32 v48, v28, v48
  v_mul_f32 v49, v29, v49
  v_mul_f32 v50, v28, v50
  v_mul_f32 v51, v29, v51
  v_cvt_pk_bf16_f32 v48, v48, v49
  v_cvt_pk_bf16_f32 v49, v50, v51
  v_smfmac_f32_16x16x64_bf16 v[52:55], v[40:43], v[176:183], v1 abid:1
  s_cbranch_vccnz cf3_redo
  buffer_store_dwordx2 v[48:49], v10, s[4:7], s36 offen offset:0
  v_smfmac_f32_16x16x64_bf16 v[52:55], v[44:47], v[184:191], v1 abid:1
  ds_read_b32 v16, v3 offset:10244
  ds_read_b32 v17, v3 offset:10252
  v_smfmac_f32_16x16x64_bf16 v[56:59], v[32:35], v[192:199], v1 abid:1
  ds_read_b32 v18, v3 offset:11268
  ds_read_b32 v19, v3 offset:11276
  s_nop 0
  v_smfmac_f32_16x16x64_bf16 v[56:59], v[36:39], v[200:207], v1 abid:1
  s_nop 0
  v_mul_f32 v52, v28, v52
  v_mul_f32 v53, v29, v53
  v_mul_f32 v54, v28, v54
  v_mul_f32 v55, v29, v55
  v_cvt_pk_bf16_f32 v52, v52, v53
  v_cvt_pk_bf16_f32 v53, v54, v55
  v_smfmac_f32_16x16x64_bf16 v[56:59], v[40:43], v[208:215], v1 abid:1
  buffer_store_dwordx2 v[52:53], v10, s[4:7], s36 offen offset:2048
  v_smfmac_f32_16x16x64_bf16 v[56:59], v[44:47], v[216:223], v1 abid:1
  s_nop 1
  s_waitcnt lgkmcnt(4)
  v_smfmac_f32_16x16x64_bf16 v[60:63], v[32:35], v[224:231], v1 abid:1
  s_nop 2
  v_smfmac_f32_16x16x64_bf16 v[60:63], v[36:39], v[232:239], v1 abid:1
  s_nop 0
  v_mul_f32 v56, v28, v56
  v_mul_f32 v57, v29, v57
  v_mul_f32 v58, v28, v58
  v_mul_f32 v59, v29, v59
  v_cvt_pk_bf16_f32 v56, v56, v57
  v_cvt_pk_bf16_f32 v57, v58, v59
  v_smfmac_f32_16x16x64_bf16 v[60:63], v[40:43], v[240:247], v1 abid:1
  buffer_store_dwordx2 v[56:57], v10, s[4:7], s51 offen offset:0
  v_smfmac_f32_16x16x64_bf16 v[60:63], v[44:47], v[248:255], v1 abid:1
  s_add_u32 s34, s34, 1
  s_and_b32 s41, s34, 3
  s_lshl_b32 s41, s41, 15
  s_add_u32 s35, s41, 84940800
  s_mov_b32 s40, 0
  s_nop 2
  v_mul_f32 v60, v28, v60
  v_mul_f32 v61, v29, v61
  v_mul_f32 v62, v28, v62
  v_mul_f32 v63, v29, v63
  v_cvt_pk_bf16_f32 v60, v60, v61
  v_cvt_pk_bf16_f32 v61, v62, v63
  buffer_store_dwordx2 v[60:61], v10, s[4:7], s51 offen offset:2048
  ds_read_b128 v[192:195], v7 offset:0
  ds_read_b128 v[196:199], v7 offset:1024
  ds_read_b128 v[200:203], v7 offset:2048
  ds_read_b128 v[204:207], v7 offset:3072
  ds_read_b128 v[208:211], v7 offset:4096
  ds_read_b128 v[212:215], v7 offset:5120
  ds_read_b128 v[216:219], v7 offset:6144
  ds_read_b128 v[220:223], v7 offset:7168
  ds_read_b128 v[224:227], v7 offset:8192
  ds_read_b128 v[228:231], v7 offset:9216
  ds_read_b128 v[232:235], v7 offset:10240
  ds_read_b128 v[236:239], v7 offset:11264
  ds_read_b128 v[240:243], v7 offset:12288
  ds_read_b128 v[244:247], v7 offset:13312
  ds_read_b128 v[248:251], v7 offset:14336
  ds_read_b128 v[252:255], v7 offset:15360
  s_waitcnt vmcnt(0)
  buffer_load_dwordx4 v[32:35], v3, s[4:7], s37 offen offset:0 sc1
  buffer_load_dwordx4 v[36:39], v3, s[4:7], s37 offen offset:1024 sc1
  s_nop 7
  s_nop 7
  s_nop 7
  s_nop 7
  buffer_load_dwordx4 v[32:35], v3, s[4:7], s37 offen offset:0 sc1
  buffer_load_dwordx4 v[36:39], v3, s[4:7], s37 offen offset:1024 sc1
  s_branch cf3_pollA1
cf3_pollA:
  buffer_load_dwordx4 v[32:35], v3, s[4:7], s37 offen offset:0 sc1
  buffer_load_dwordx4 v[36:39], v3, s[4:7], s37 offen offset:1024 sc1
cf3_pollA1:
  s_add_u32 s40, s40, 1
  s_add_u32 s67, s67, 1
  s_mov_b32 s24, 3
  s_cmp_gt_u32 s40, 63
  s_cbranch_scc1 cf3_nanA
cf3_pollA2:
  s_waitcnt vmcnt(3) lgkmcnt(0)
  v_mfma_f32_16x16x32_bf16 v[20:23], v[16:19], v[32:35], 0
  s_waitcnt vmcnt(2) lgkmcnt(0)
  v_mfma_f32_16x16x32_bf16 v[20:23], v[16:19], v[36:39], v[20:23]
  s_nop 7
  v_cmp_class_f32 vcc, v22, s24
  v_add_f32_dpp v20, v20, v20 row_ror:4 row_mask:0xf bank_mask:0xf
  v_add_f32_dpp v21, v21, v21 row_ror:4 row_mask:0xf bank_mask:0xf
  s_nop 0
  v_add_f32_dpp v20, v20, v20 row_ror:8 row_mask:0xf bank_mask:0xf
  v_add_f32_dpp v21, v21, v21 row_ror:8 row_mask:0xf bank_mask:0xf
  v_cvt_pk_bf16_f32 v24, v20, v21
  s_cbranch_vccnz cf3_pollA
cf3_pub:
  buffer_store_dword v24, v2, s[4:7], s38 offen
  s_branch cf3_step
cf3_retryB:
cf3_nanA:
  s_waitcnt vmcnt(0)
  v_max3_u32 v0, v32, v33, v34
  v_max3_u32 v0, v0, v35, v36
  v_max3_u32 v0, v0, v37, v38
  v_max_u32 v0, v0, v39
  v_cmp_eq_u32 vcc, -1, v0
  s_nop 4
  s_cmp_eq_u64 vcc, 0
  s_cselect_b32 s24, 0, 3
  s_cmp_gt_u32 s40, 1048576
  s_cselect_b32 s24, 0, s24
  s_branch cf3_pollA2
cf3_redo:
  s_nop 7
  v_mov_b64 v[48:49], 0
  v_mov_b64 v[50:51], 0
  v_mov_b64 v[52:53], 0
  v_mov_b64 v[54:55], 0
  v_mov_b64 v[56:57], 0
  v_mov_b64 v[58:59], 0
  v_mov_b64 v[60:61], 0
  v_mov_b64 v[62:63], 0
  s_waitcnt lgkmcnt(0)
  s_barrier
  s_barrier
  s_branch cf3_wo
cf3_exit:
  s_waitcnt vmcnt(0)
  s_barrier
  v_mov_b32 v11, 64
  s_mov_b64 exec, 1
  buffer_store_dword v11, off, s[4:7], s49 sc1
  s_endpgm
cs0_step:
  v_mov_b64 v[16:17], 0
  v_mov_b64 v[18:19], 0
  v_mov_b64 v[20:21], 0
  v_mov_b64 v[22:23], 0
  v_mov_b64 v[26:27], 0
  v_mov_b64 v[28:29], 0
  v_mov_b64 v[30:31], 0
  s_xor_b32 s37, s37, 0x40000
  s_xor_b32 s36, s36, 0x40000
  s_mov_b32 s40, 0
  v_mov_b64 v[24:25], 0
  s_add_u32 s46, s46, 262144
  s_min_u32 s46, s46, s70
  s_nop 7
  s_nop 7
  s_nop 7
  buffer_load_dwordx4 v[32:35], v3, s[4:7], s35 offen offset:0 sc1
  buffer_load_dwordx4 v[36:39], v3, s[4:7], s35 offen offset:1024 sc1
  s_nop 7
  s_nop 7
  s_nop 7
  buffer_load_dwordx4 v[32:35], v3, s[4:7], s35 offen offset:0 sc1
  buffer_load_dwordx4 v[36:39], v3, s[4:7], s35 offen offset:1024 sc1
  s_barrier
  ds_read_b128 v[64:67], v3 offset:16384
  ds_read_b128 v[68:71], v3 offset:17408
  ds_read_b128 v[72:75], v3 offset:18432
  ds_read_b128 v[76:79], v3 offset:19456
  ds_read_b128 v[80:83], v3 offset:20480
  ds_read_b128 v[84:87], v3 offset:21504
  ds_read_b128 v[88:91], v3 offset:22528
  ds_read_b128 v[92:95], v3 offset:23552
  ds_read_b128 v[96:99], v3 offset:24576
  ds_read_b128 v[100:103], v3 offset:25600
  ds_read_b128 v[104:107], v3 offset:26624
  ds_read_b128 v[108:111], v3 offset:27648
  ds_read_b128 v[112:115], v3 offset:28672
  ds_read_b128 v[116:119], v3 offset:29696
  ds_read_b128 v[120:123], v3 offset:30720
  ds_read_b128 v[124:127], v3 offset:31744
  s_branch cs0_chkB1
cs0_chkB:
  buffer_load_dwordx4 v[32:35], v3, s[4:7], s35 offen offset:0 sc1
  buffer_load_dwordx4 v[36:39], v3, s[4:7], s35 offen offset:1024 sc1
cs0_chkB1:
  s_add_u32 s40, s40, 1
  s_add_u32 s68, s68, 1
  s_cmp_gt_u32 s40, 1048576
  s_cselect_b32 s51, -1, -2
  s_waitcnt vmcnt(2)
  v_max3_u32 v0, v32, v33, v34
  v_max3_u32 v0, v0, v35, v36
  v_max3_u32 v0, v0, v37, v38
  v_max_u32 v0, v0, v39
  v_cmp_lt_u32 vcc, s51, v0
  ds_write_b128 v3, v[32:35] offset:0
  ds_write_b128 v3, v[36:39] offset:1024
  s_cbranch_vccnz cs0_chkB
cs0_okB:
  v_smfmac_f32_16x16x64_bf16 v[16:19], v[32:35], a[0:7], v1
  v_mov_b32 v0, -1
  v_smfmac_f32_16x16x64_bf16 v[20:23], v[32:35], a[64:71], v1
  buffer_store_dword v0, v2, s[4:7], s39 offen sc1
  v_smfmac_f32_16x16x64_bf16 v[16:19], v[36:39], a[8:15], v1
  s_mov_b32 s39, s38
  s_add_u32 s38, s38, 0x8000
  v_smfmac_f32_16x16x64_bf16 v[20:23], v[36:39], a[72:79], v1
  s_waitcnt lgkmcnt(0)
  s_barrier
  ds_read_b128 v[40:43], v3 offset:2048
  ds_read_b128 v[44:47], v3 offset:3072
  s_and_b32 s38, s38, 0xfffdffff
  s_sub_u32 s39, s39, 0x8000
  v_smfmac_f32_16x16x64_bf16 v[24:27], v[32:35], a[128:135], v1
  ds_read_b128 v[48:51], v3 offset:4096
  ds_read_b128 v[52:55], v3 offset:5120
  v_smfmac_f32_16x16x64_bf16 v[28:31], v[32:35], a[192:199], v1
  ds_read_b128 v[56:59], v3 offset:6144
  ds_read_b128 v[60:63], v3 offset:7168
  v_smfmac_f32_16x16x64_bf16 v[24:27], v[36:39], a[136:143], v1
  v_smfmac_f32_16x16x64_bf16 v[28:31], v[36:39], a[200:207], v1
  s_waitcnt lgkmcnt(5)
  v_smfmac_f32_16x16x64_bf16 v[16:19], v[40:43], a[16:23], v1
  buffer_load_dwordx4 v3, s[4:7], s46 offen offset:0 sc1 lds
  s_waitcnt lgkmcnt(4)
  v_smfmac_f32_16x16x64_bf16 v[16:19], v[44:47], a[24:31], v1
  s_waitcnt lgkmcnt(3)
  v_smfmac_f32_16x16x64_bf16 v[16:19], v[48:51], a[32:39], v1
  s_waitcnt lgkmcnt(2)
  v_smfmac_f32_16x16x64_bf16 v[16:19], v[52:55], a[40:47], v1
  s_waitcnt lgkmcnt(1)
  v_smfmac_f32_16x16x64_bf16 v[16:19], v[56:59], a[48:55], v1
  buffer_load_dwordx4 v3, s[4:7], s46 offen offset:1024 sc1 lds
  s_waitcnt lgkmcnt(0)
  v_smfmac_f32_16x16x64_bf16 v[16:19], v[60:63], a[56:63], v1
  s_nop 1
  v_smfmac_f32_16x16x64_bf16 v[20:23], v[40:43], a[80:87], v1
  s_nop 2
  v_smfmac_f32_16x16x64_bf16 v[20:23], v[44:47], a[88:95], v1
  s_nop 0
  v_add_f32 v16, v16, v18
  v_add_f32 v17, v17, v19
  v_smfmac_f32_16x16x64_bf16 v[20:23], v[48:51], a[96:103], v1
  buffer_load_dwordx4 v3, s[4:7], s46 offen offset:2048 sc1 lds
  v_mul_f32 v16, s43, v16
  v_mul_f32 v17, s43, v17
  v_smfmac_f32_16x16x64_bf16 v[20:23], v[52:55], a[104:111], v1
  v_cvt_pk_bf16_f32 v16, v16, v17
  v_smfmac_f32_16x16x64_bf16 v[20:23], v[56:59], a[112:119], v1
  ds_write_b32 v5, v16 offset:12288
  v_smfmac_f32_16x16x64_bf16 v[20:23], v[60:63], a[120:127], v1
  s_nop 1
  v_smfmac_f32_16x16x64_bf16 v[24:27], v[40:43], a[144:151], v1
  buffer_load_dwordx4 v3, s[4:7], s46 offen offset:3072 sc1 lds
  s_nop 1
  v_smfmac_f32_16x16x64_bf16 v[24:27], v[44:47], a[152:159], v1
  s_nop 0
  v_add_f32 v20, v20, v22
  v_add_f32 v21, v21, v23
  v_mul_f32 v20, s43, v20
  v_mul_f32 v21, s43, v21
  v_cvt_pk_bf16_f32 v20, v20, v21
  v_smfmac_f32_16x16x64_bf16 v[24:27], v[48:51], a[160:167], v1
  ds_write_b32 v5, v20 offset:12544
  v_smfmac_f32_16x16x64_bf16 v[24:27], v[52:55], a[168:175], v1
  s_and_b32 s39, s39, 0x1ffff
  s_add_u32 s39, s39, 84934656
  v_smfmac_f32_16x16x64_bf16 v[24:27], v[56:59], a[176:183], v1
  s_add_u32 s51, s36, 4096
  v_smfmac_f32_16x16x64_bf16 v[24:27], v[60:63], a[184:191], v1
  s_waitcnt lgkmcnt(0)
  s_barrier
  s_waitcnt vmcnt(5)
  v_smfmac_f32_16x16x64_bf16 v[28:31], v[40:43], a[208:215], v1
  ds_read_b64_tr_b16 v[32:33], v7 offset:12288
  ds_read_b64_tr_b16 v[34:35], v7 offset:12544
  ds_read_b64_tr_b16 v[36:37], v7 offset:12800
  v_smfmac_f32_16x16x64_bf16 v[28:31], v[44:47], a[216:223], v1
  ds_read_b64_tr_b16 v[38:39], v7 offset:13056
  v_add_f32 v24, v24, v26
  v_smfmac_f32_16x16x64_bf16 v[28:31], v[48:51], a[224:231], v1
  ds_read_b64_tr_b16 v[16:17], v7 offset:13312
  v_add_f32 v25, v25, v27
  v_smfmac_f32_16x16x64_bf16 v[28:31], v[52:55], a[232:239], v1
  ds_read_b64_tr_b16 v[18:19], v7 offset:13568
  v_cvt_pk_bf16_f32 v24, v24, v25
  v_smfmac_f32_16x16x64_bf16 v[28:31], v[56:59], a[240:247], v1
  ds_write_b32 v6, v24 offset:8192
  ds_read_b64_tr_b16 v[20:21], v7 offset:13824
  v_smfmac_f32_16x16x64_bf16 v[28:31], v[60:63], a[248:255], v1
  ds_read_b64_tr_b16 v[22:23], v7 offset:14080
  s_waitcnt lgkmcnt(7)
  v_mfma_f32_16x16x32_bf16 v[56:59], v[64:67], v[32:35], 0
  s_nop 1
  s_waitcnt lgkmcnt(5)
  v_mfma_f32_16x16x32_bf16 v[56:59], v[68:71], v[36:39], v[56:59]
  s_nop 0
  v_add_f32 v28, v28, v30
  v_add_f32 v29, v29, v31
  s_waitcnt lgkmcnt(3)
  v_mfma_f32_16x16x32_bf16 v[56:59], v[72:75], v[16:19], v[56:59]
  v_cvt_pk_bf16_f32 v28, v28, v29
  s_waitcnt lgkmcnt(0)
  v_mfma_f32_16x16x32_bf16 v[56:59], v[76:79], v[20:23], v[56:59]
  ds_write_b32 v6, v28 offset:8704
  v_lshrrev_b32 v0, 7, v8
  v_lshlrev_b32 v0, 5, v0
  v_mfma_f32_16x16x32_bf16 v[60:63], v[80:83], v[32:35], 0
  s_nop 1
  v_add_u32 v0, 8204, v0
  v_mfma_f32_16x16x32_bf16 v[60:63], v[84:87], v[36:39], v[60:63]
  v_exp_f32 v64, v56
  v_mfma_f32_16x16x32_bf16 v[60:63], v[88:91], v[16:19], v[60:63]
  s_waitcnt lgkmcnt(0)
  v_exp_f32 v65, v57
  v_mfma_f32_16x16x32_bf16 v[60:63], v[92:95], v[20:23], v[60:63]
  s_barrier
  ds_read_b64_tr_b16 v[40:41], v4 offset:8192
  ds_read_b64_tr_b16 v[42:43], v4 offset:8704
  ds_read_b64_tr_b16 v[44:45], v4 offset:9216
  ds_read_b64_tr_b16 v[46:47], v4 offset:9728
  ds_read_b64_tr_b16 v[48:49], v4 offset:10240
  ds_read_b64_tr_b16 v[50:51], v4 offset:10752
  ds_read_b64_tr_b16 v[52:53], v4 offset:11264
  ds_read_b64_tr_b16 v[54:55], v4 offset:11776
  v_exp_f32 v66, v58
  v_exp_f32 v67, v59
  v_cvt_pk_bf16_f32 v72, v64, v65
  v_and_b32 v76, v11, v72
  v_cvt_pk_bf16_f32 v73, v66, v67
  v_and_b32 v77, v11, v73
  s_waitcnt lgkmcnt(6)
  v_mfma_f32_16x16x32_bf16 v[24:27], v[40:43], v[32:35], 0
  s_waitcnt lgkmcnt(4)
  v_exp_f32 v68, v60
  v_mfma_f32_16x16x32_bf16 v[24:27], v[44:47], v[36:39], v[24:27]
  s_waitcnt lgkmcnt(2)
  v_exp_f32 v69, v61
  v_mfma_f32_16x16x32_bf16 v[24:27], v[48:51], v[16:19], v[24:27]
  s_waitcnt lgkmcnt(0)
  v_exp_f32 v70, v62
  v_mfma_f32_16x16x32_bf16 v[24:27], v[52:55], v[20:23], v[24:27]
  v_exp_f32 v71, v63
  v_cvt_pk_bf16_f32 v74, v68, v69
  v_and_b32 v78, v11, v74
  v_cvt_pk_bf16_f32 v75, v70, v71
  v_and_b32 v79, v11, v75
  v_xor_b32 v64, v72, v76
  v_xor_b32 v65, v73, v77
  v_mfma_f32_16x16x32_bf16 v[92:95], v[120:123], v[76:79], 0
  v_xor_b32 v66, v74, v78
  v_xor_b32 v67, v75, v79
  v_mfma_f32_16x16x32_bf16 v[68:71], v[12:15], v[72:75], 0
  v_exp_f32 v28, v24
  v_mfma_f32_16x16x32_bf16 v[92:95], v[124:127], v[64:67], v[92:95]
  v_exp_f32 v29, v25
  v_mfma_f32_16x16x32_bf16 v[80:83], v[96:99], v[76:79], 0
  v_cvt_pk_bf16_f32 v28, v28, v29
  v_and_b32 v26, v11, v28
  v_mfma_f32_16x16x32_bf16 v[84:87], v[104:107], v[76:79], 0
  ds_write_b32 v3, v28 offset:1024
  v_xor_b32 v27, v28, v26
  v_mfma_f32_16x16x32_bf16 v[88:91], v[112:115], v[76:79], 0
  ds_write_b128 v3, v[92:95] offset:0
  v_mfma_f32_16x16x16_bf16 v[68:71], v[12:13], v[26:27], v[68:71]
  v_mov_b64 v[48:49], 0
  v_mov_b64 v[50:51], 0
  v_mfma_f32_16x16x32_bf16 v[80:83], v[100:103], v[64:67], v[80:83]
  s_waitcnt lgkmcnt(0)
  s_barrier
  ds_read_b128 v[32:35], v3 offset:14336
  ds_read_b64 v[36:37], v3 offset:15360
  v_mov_b64 v[52:53], 0
  v_mov_b64 v[54:55], 0
  v_mfma_f32_16x16x32_bf16 v[84:87], v[108:111], v[64:67], v[84:87]
  s_cmp_eq_u32 s34, 63
  v_mfma_f32_16x16x32_bf16 v[88:91], v[116:119], v[64:67], v[88:91]
  v_subrev_u32 v30, s44, v68
  v_cmp_lt_u32 vcc, s69, v30
  s_cbranch_scc1 cs0_exit
  s_waitcnt lgkmcnt(1)
  v_mfma_f32_16x16x16_bf16 v[80:83], v[32:33], v[26:27], v[80:83]
  s_cbranch_vccnz cs0_fb
  v_rcp_f32 v30, v68
  v_mfma_f32_16x16x16_bf16 v[84:87], v[34:35], v[26:27], v[84:87]
  s_waitcnt lgkmcnt(0)
  v_mov_b64 v[56:57], 0
  v_mov_b64 v[58:59], 0
  v_mfma_f32_16x16x16_bf16 v[88:91], v[36:37], v[26:27], v[88:91]
  ds_write_b32 v9, v30 offset:8204
  v_cvt_pk_bf16_f32 v40, v80, v81
  v_cvt_pk_bf16_f32 v41, v82, v83
  v_mov_b64 v[60:61], 0
  v_cvt_pk_bf16_f32 v42, v84, v85
  v_cvt_pk_bf16_f32 v43, v86, v87
  ds_write_b64 v9, v[40:41] offset:12288
  ds_write_b64 v9, v[42:43] offset:12296
  v_cvt_pk_bf16_f32 v44, v88, v89
  v_cvt_pk_bf16_f32 v45, v90, v91
  ds_write_b64 v9, v[44:45] offset:13312
  v_mov_b64 v[62:63], 0
  s_waitcnt lgkmcnt(0)
  s_barrier
cs0_wo:
  ds_read_b128 v[32:35], v8 offset:12288
  ds_read_b128 v[36:39], v8 offset:12800
  ds_read_b128 v[40:43], v8 offset:13312
  ds_read_b128 v[44:47], v8 offset:13824
  s_waitcnt lgkmcnt(3)
  v_smfmac_f32_16x16x64_bf16 v[48:51], v[32:35], v[128:135], v1 abid:1
  ds_read2_b32 v[28:29], v0 offset0:0 offset1:4
  s_waitcnt lgkmcnt(3)
  v_smfmac_f32_16x16x64_bf16 v[48:51], v[36:39], v[136:143], v1 abid:1
  s_waitcnt lgkmcnt(2)
  v_smfmac_f32_16x16x64_bf16 v[48:51], v[40:43], v[144:151], v1 abid:1
  s_waitcnt lgkmcnt(1)
  v_smfmac_f32_16x16x64_bf16 v[48:51], v[44:47], v[152:159], v1 abid:1
  s_nop 1
  v_smfmac_f32_16x16x64_bf16 v[52:55], v[32:35], v[160:167], v1 abid:1
  s_nop 2
  v_smfmac_f32_16x16x64_bf16 v[52:55], v[36:39], v[168:175], v1 abid:1
  s_waitcnt lgkmcnt(0)
  v_mul_f32 v48, v28, v48
  v_mul_f32 v49, v29, v49
  v_mul_f32 v50, v28, v50
  v_mul_f32 v51, v29, v51
  v_cvt_pk_bf16_f32 v48, v48, v49
  v_cvt_pk_bf16_f32 v49, v50, v51
  v_smfmac_f32_16x16x64_bf16 v[52:55], v[40:43], v[176:183], v1 abid:1
  buffer_store_dwordx2 v[48:49], v10, s[4:7], s36 offen offset:0 sc1
  v_smfmac_f32_16x16x64_bf16 v[52:55], v[44:47], v[184:191], v1 abid:1
  ds_read_b32 v16, v3 offset:10244
  ds_read_b32 v17, v3 offset:10252
  v_smfmac_f32_16x16x64_bf16 v[56:59], v[32:35], v[192:199], v1 abid:1
  ds_read_b32 v18, v3 offset:11268
  ds_read_b32 v19, v3 offset:11276
  s_nop 0
  v_smfmac_f32_16x16x64_bf16 v[56:59], v[36:39], v[200:207], v1 abid:1
  s_nop 0
  v_mul_f32 v52, v28, v52
  v_mul_f32 v53, v29, v53
  v_mul_f32 v54, v28, v54
  v_mul_f32 v55, v29, v55
  v_cvt_pk_bf16_f32 v52, v52, v53
  v_cvt_pk_bf16_f32 v53, v54, v55
  v_smfmac_f32_16x16x64_bf16 v[56:59], v[40:43], v[208:215], v1 abid:1
  buffer_store_dwordx2 v[52:53], v10, s[4:7], s36 offen offset:2048 sc1
  v_smfmac_f32_16x16x64_bf16 v[56:59], v[44:47], v[216:223], v1 abid:1
  s_nop 1
  v_smfmac_f32_16x16x64_bf16 v[60:63], v[32:35], v[224:231], v1 abid:1
  s_nop 2
  v_smfmac_f32_16x16x64_bf16 v[60:63], v[36:39], v[232:239], v1 abid:1
  s_nop 0
  v_mul_f32 v56, v28, v56
  v_mul_f32 v57, v29, v57
  v_mul_f32 v58, v28, v58
  v_mul_f32 v59, v29, v59
  v_cvt_pk_bf16_f32 v56, v56, v57
  v_cvt_pk_bf16_f32 v57, v58, v59
  v_smfmac_f32_16x16x64_bf16 v[60:63], v[40:43], v[240:247], v1 abid:1
  buffer_store_dwordx2 v[56:57], v10, s[4:7], s51 offen offset:0 sc1
  v_smfmac_f32_16x16x64_bf16 v[60:63], v[44:47], v[248:255], v1 abid:1
  s_add_u32 s34, s34, 1
  s_and_b32 s41, s34, 3
  s_lshl_b32 s41, s41, 15
  s_add_u32 s35, s41, 84934656
  s_mov_b32 s40, 0
  s_nop 2
  v_mul_f32 v60, v28, v60
  v_mul_f32 v61, v29, v61
  v_mul_f32 v62, v28, v62
  v_mul_f32 v63, v29, v63
  v_cvt_pk_bf16_f32 v60, v60, v61
  v_cvt_pk_bf16_f32 v61, v62, v63
  buffer_store_dwordx2 v[60:61], v10, s[4:7], s51 offen offset:2048 sc1
  s_nop 7
  s_nop 7
  s_nop 7
  buffer_load_dwordx4 v[40:43], v3, s[4:7], s37 offen offset:0 sc1
  buffer_load_dwordx4 v[44:47], v3, s[4:7], s37 offen offset:1024 sc1
  s_nop 7
  s_nop 7
  s_nop 7
  s_nop 7
  s_nop 7
  buffer_load_dwordx4 v[40:43], v3, s[4:7], s37 offen offset:0 sc1
  buffer_load_dwordx4 v[44:47], v3, s[4:7], s37 offen offset:1024 sc1
  s_branch cs0_pollA1
cs0_pollA:
  buffer_load_dwordx4 v[40:43], v3, s[4:7], s37 offen offset:0 sc1
  buffer_load_dwordx4 v[44:47], v3, s[4:7], s37 offen offset:1024 sc1
cs0_pollA1:
  s_add_u32 s40, s40, 1
  s_add_u32 s67, s67, 1
  s_mov_b32 s24, 3
  s_cmp_gt_u32 s40, 63
  s_cbranch_scc1 cs0_nanA
cs0_pollA2:
  s_waitcnt vmcnt(3) lgkmcnt(0)
  v_mfma_f32_16x16x32_bf16 v[20:23], v[16:19], v[40:43], 0
  s_waitcnt vmcnt(2) lgkmcnt(0)
  v_mfma_f32_16x16x32_bf16 v[20:23], v[16:19], v[44:47], v[20:23]
  s_nop 7
  v_cmp_class_f32 vcc, v22, s24
  v_add_f32_dpp v20, v20, v20 row_ror:4 row_mask:0xf bank_mask:0xf
  v_add_f32_dpp v21, v21, v21 row_ror:4 row_mask:0xf bank_mask:0xf
  s_nop 0
  v_add_f32_dpp v20, v20, v20 row_ror:8 row_mask:0xf bank_mask:0xf
  v_add_f32_dpp v21, v21, v21 row_ror:8 row_mask:0xf bank_mask:0xf
  v_cvt_pk_bf16_f32 v24, v20, v21
  s_cbranch_vccnz cs0_pollA
cs0_pub:
  buffer_store_dword v24, v2, s[4:7], s38 offen sc1
  s_branch cs0_step
cs0_retryB:
cs0_nanA:
  s_waitcnt vmcnt(0)
  v_max3_u32 v0, v40, v41, v42
  v_max3_u32 v0, v0, v43, v44
  v_max3_u32 v0, v0, v45, v46
  v_max_u32 v0, v0, v47
  v_cmp_eq_u32 vcc, -1, v0
  s_nop 4
  s_cmp_eq_u64 vcc, 0
  s_cselect_b32 s24, 0, 3
  s_cmp_gt_u32 s40, 1048576
  s_cselect_b32 s24, 0, s24
  s_branch cs0_pollA2
cs0_fb:
  s_nop 7
  v_mov_b32 v30, -1.0
  ds_write_b32 v9, v30 offset:8204
  s_waitcnt lgkmcnt(0)
  s_barrier
  ds_read_b64 v[38:39], v3 offset:15368
  v_max3_f32 v28, v56, v57, v58
  v_max3_f32 v28, v28, v59, v60
  v_max3_f32 v28, v28, v61, v62
  v_max3_f32 v28, v28, v63, v24
  v_max_f32 v28, v28, v25
  v_mov_b32 v29, v28
  s_nop 1
  v_permlane32_swap_b32 v28, v29
  v_max_f32 v28, v28, v29
  v_mov_b32 v29, v28
  s_nop 1
  v_permlane16_swap_b32 v28, v29
  v_max_f32 v31, v28, v29
  v_sub_f32 v64, v56, v31
  v_exp_f32 v64, v64
  v_sub_f32 v65, v57, v31
  v_exp_f32 v65, v65
  v_sub_f32 v66, v58, v31
  v_exp_f32 v66, v66
  v_sub_f32 v67, v59, v31
  v_exp_f32 v67, v67
  v_sub_f32 v68, v60, v31
  v_exp_f32 v68, v68
  v_sub_f32 v69, v61, v31
  v_exp_f32 v69, v69
  v_sub_f32 v70, v62, v31
  v_exp_f32 v70, v70
  v_sub_f32 v71, v63, v31
  v_exp_f32 v71, v71
  v_sub_f32 v28, v24, v31
  v_sub_f32 v29, v25, v31
  v_exp_f32 v28, v28
  v_exp_f32 v29, v29
  v_cvt_pk_bf16_f32 v72, v64, v65
  v_cvt_pk_bf16_f32 v73, v66, v67
  v_cvt_pk_bf16_f32 v74, v68, v69
  v_cvt_pk_bf16_f32 v75, v70, v71
  v_and_b32 v76, v11, v72
  v_and_b32 v77, v11, v73
  v_and_b32 v78, v11, v74
  v_and_b32 v79, v11, v75
  v_xor_b32 v64, v72, v76
  v_xor_b32 v65, v73, v77
  v_xor_b32 v66, v74, v78
  v_xor_b32 v67, v75, v79
  v_cvt_pk_bf16_f32 v28, v28, v29
  v_and_b32 v26, v11, v28
  v_xor_b32 v27, v28, v26
  s_nop 1
  v_mfma_f32_16x16x32_bf16 v[92:95], v[120:123], v[76:79], 0
  v_mfma_f32_16x16x32_bf16 v[68:71], v[12:15], v[72:75], 0
  v_mfma_f32_16x16x32_bf16 v[92:95], v[124:127], v[64:67], v[92:95]
  v_mfma_f32_16x16x32_bf16 v[80:83], v[96:99], v[76:79], 0
  v_mfma_f32_16x16x32_bf16 v[84:87], v[104:107], v[76:79], 0
  v_mfma_f32_16x16x32_bf16 v[88:91], v[112:115], v[76:79], 0
  s_nop 3
  v_mfma_f32_16x16x16_bf16 v[68:71], v[12:13], v[26:27], v[68:71]
  v_mfma_f32_16x16x32_bf16 v[80:83], v[100:103], v[64:67], v[80:83]
  v_mfma_f32_16x16x32_bf16 v[84:87], v[108:111], v[64:67], v[84:87]
  v_mfma_f32_16x16x32_bf16 v[88:91], v[116:119], v[64:67], v[88:91]
  s_nop 7
  s_waitcnt lgkmcnt(0)
  v_mfma_f32_16x16x16_bf16 v[80:83], v[32:33], v[26:27], v[80:83]
  v_mfma_f32_16x16x16_bf16 v[84:87], v[34:35], v[26:27], v[84:87]
  v_mfma_f32_16x16x16_bf16 v[88:91], v[36:37], v[26:27], v[88:91]
  v_mfma_f32_16x16x16_bf16 v[92:95], v[38:39], v[26:27], v[92:95]
  s_nop 7
  v_rcp_f32 v30, v68
  v_cvt_pk_bf16_f32 v40, v80, v81
  v_cvt_pk_bf16_f32 v41, v82, v83
  v_cvt_pk_bf16_f32 v42, v84, v85
  v_cvt_pk_bf16_f32 v43, v86, v87
  v_cvt_pk_bf16_f32 v44, v88, v89
  v_cvt_pk_bf16_f32 v45, v90, v91
  v_cvt_pk_bf16_f32 v46, v92, v93
  v_cvt_pk_bf16_f32 v47, v94, v95
  v_mov_b64 v[48:49], 0
  v_mov_b64 v[50:51], 0
  v_mov_b64 v[52:53], 0
  v_mov_b64 v[54:55], 0
  v_mov_b64 v[56:57], 0
  v_mov_b64 v[58:59], 0
  v_mov_b64 v[60:61], 0
  v_mov_b64 v[62:63], 0
  s_barrier
  ds_write_b32 v9, v30 offset:8204
  ds_write_b128 v9, v[40:43] offset:12288
  ds_write_b128 v9, v[44:47] offset:13312
  s_waitcnt lgkmcnt(0)
  s_barrier
  s_branch cs0_wo
cs0_exit:
  s_waitcnt vmcnt(0)
  s_barrier
  s_endpgm
cs1_step:
  s_cmp_lg_u32 s48, 64
  s_cbranch_scc1 cs1_p1w
cs1_p1d:
  v_mov_b64 v[12:13], -1
  v_mov_b64 v[14:15], -1
  v_mov_b64 v[16:17], 0
  v_mov_b64 v[18:19], 0
  v_mov_b64 v[20:21], 0
  v_mov_b64 v[22:23], 0
  v_mov_b64 v[26:27], 0
  v_mov_b64 v[28:29], 0
  v_mov_b64 v[30:31], 0
  s_xor_b32 s37, s37, 0x40000
  s_xor_b32 s36, s36, 0x40000
  s_mov_b32 s40, 0
  v_mov_b64 v[24:25], 0
  s_add_u32 s46, s46, 262144
  s_min_u32 s46, s46, s70
  s_add_u32 s45, s45, 65536
  s_xor_b32 s47, s47, 0x40000
  s_waitcnt vmcnt(0)
  buffer_load_dwordx4 v[40:43], v3, s[4:7], s35 offen offset:0 sc1
  buffer_load_dwordx4 v[44:47], v3, s[4:7], s35 offen offset:1024 sc1
  s_barrier
  s_nop 7
  s_nop 7
  s_nop 7
  buffer_load_dwordx4 v[40:43], v3, s[4:7], s35 offen offset:0 sc1
  buffer_load_dwordx4 v[44:47], v3, s[4:7], s35 offen offset:1024 sc1
  s_branch cs1_chkB1
cs1_chkB:
  buffer_load_dwordx4 v[40:43], v3, s[4:7], s35 offen offset:0 sc1
  buffer_load_dwordx4 v[44:47], v3, s[4:7], s35 offen offset:1024 sc1
cs1_chkB1:
  s_add_u32 s40, s40, 1
  s_add_u32 s68, s68, 1
  s_cmp_gt_u32 s40, 1048576
  s_cselect_b32 s51, -1, -2
  s_waitcnt vmcnt(2)
  v_max3_u32 v0, v40, v41, v42
  v_max3_u32 v0, v0, v43, v44
  v_max3_u32 v0, v0, v45, v46
  v_max_u32 v0, v0, v47
  v_cmp_lt_u32 vcc, s51, v0
  ds_write_b128 v3, v[40:43] offset:2048
  ds_write_b128 v3, v[44:47] offset:3072
  s_cbranch_vccnz cs1_chkB
cs1_okB:
  v_smfmac_f32_16x16x64_bf16 v[16:19], v[40:43], a[16:23], v1
  v_mov_b32 v0, -1
  v_smfmac_f32_16x16x64_bf16 v[20:23], v[40:43], a[80:87], v1
  buffer_store_dword v0, v2, s[4:7], s39 offen sc1
  v_smfmac_f32_16x16x64_bf16 v[16:19], v[44:47], a[24:31], v1
  s_mov_b32 s39, s38
  s_add_u32 s38, s38, 0x8000
  v_smfmac_f32_16x16x64_bf16 v[20:23], v[44:47], a[88:95], v1
  s_waitcnt lgkmcnt(0)
  s_barrier
  ds_read_b128 v[48:51], v3 offset:4096
  ds_read_b128 v[52:55], v3 offset:5120
  s_and_b32 s38, s38, 0xfffdffff
  s_sub_u32 s39, s39, 0x8000
  v_smfmac_f32_16x16x64_bf16 v[24:27], v[40:43], a[144:151], v1
  ds_read_b128 v[56:59], v3 offset:6144
  ds_read_b128 v[60:63], v3 offset:7168
  v_smfmac_f32_16x16x64_bf16 v[28:31], v[40:43], a[208:215], v1
  ds_read_b128 v[32:35], v3 offset:0
  ds_read_b128 v[36:39], v3 offset:1024
  v_smfmac_f32_16x16x64_bf16 v[24:27], v[44:47], a[152:159], v1
  v_smfmac_f32_16x16x64_bf16 v[28:31], v[44:47], a[216:223], v1
  buffer_load_dword v11, v9, s[4:7], s71 offen sc1
  s_waitcnt lgkmcnt(5)
  v_smfmac_f32_16x16x64_bf16 v[16:19], v[48:51], a[32:39], v1
  s_waitcnt lgkmcnt(4)
  v_smfmac_f32_16x16x64_bf16 v[16:19], v[52:55], a[40:47], v1
  buffer_load_dwordx4 v3, s[4:7], s46 offen offset:0 sc1 lds
  s_waitcnt lgkmcnt(3)
  v_smfmac_f32_16x16x64_bf16 v[16:19], v[56:59], a[48:55], v1
  buffer_store_dwordx4 v[12:15], v3, s[4:7], s47 offen offset:0 sc1
  s_waitcnt lgkmcnt(2)
  v_smfmac_f32_16x16x64_bf16 v[16:19], v[60:63], a[56:63], v1
  s_waitcnt lgkmcnt(1)
  v_smfmac_f32_16x16x64_bf16 v[16:19], v[32:35], a[0:7], v1
  s_waitcnt lgkmcnt(0)
  v_smfmac_f32_16x16x64_bf16 v[16:19], v[36:39], a[8:15], v1
  buffer_store_dwordx4 v[12:15], v3, s[4:7], s47 offen offset:1024 sc1
  buffer_load_dwordx4 v3, s[4:7], s46 offen offset:1024 sc1 lds
  v_smfmac_f32_16x16x64_bf16 v[20:23], v[48:51], a[96:103], v1
  s_nop 2
  v_smfmac_f32_16x16x64_bf16 v[20:23], v[52:55], a[104:111], v1
  s_nop 0
  v_add_f32 v16, v16, v18
  v_add_f32 v17, v17, v19
  v_smfmac_f32_16x16x64_bf16 v[20:23], v[56:59], a[112:119], v1
  buffer_store_dwordx4 v[12:15], v3, s[4:7], s47 offen offset:2048 sc1
  v_mul_f32 v16, s43, v16
  v_mul_f32 v17, s43, v17
  v_smfmac_f32_16x16x64_bf16 v[20:23], v[60:63], a[120:127], v1
  buffer_load_dwordx4 v3, s[4:7], s46 offen offset:2048 sc1 lds
  v_cvt_pk_bf16_f32 v16, v16, v17
  v_smfmac_f32_16x16x64_bf16 v[20:23], v[32:35], a[64:71], v1
  ds_write_b32 v5, v16 offset:12800
  v_smfmac_f32_16x16x64_bf16 v[20:23], v[36:39], a[72:79], v1
  s_nop 1
  v_smfmac_f32_16x16x64_bf16 v[24:27], v[48:51], a[160:167], v1
  s_nop 2
  v_smfmac_f32_16x16x64_bf16 v[24:27], v[52:55], a[168:175], v1
  buffer_load_dwordx4 v3, s[4:7], s46 offen offset:3072 sc1 lds
  v_add_f32 v20, v20, v22
  v_add_f32 v21, v21, v23
  v_mul_f32 v20, s43, v20
  v_mul_f32 v21, s43, v21
  v_cvt_pk_bf16_f32 v20, v20, v21
  v_smfmac_f32_16x16x64_bf16 v[24:27], v[56:59], a[176:183], v1
  ds_write_b32 v5, v20 offset:13056
  v_smfmac_f32_16x16x64_bf16 v[24:27], v[60:63], a[184:191], v1
  s_and_b32 s39, s39, 0x1ffff
  s_add_u32 s39, s39, 84934656
  v_mov_b64 v[12:13], 0
  v_smfmac_f32_16x16x64_bf16 v[24:27], v[32:35], a[128:135], v1
  s_add_u32 s51, s36, 4096
  v_mov_b64 v[14:15], 0
  v_smfmac_f32_16x16x64_bf16 v[24:27], v[36:39], a[136:143], v1
  s_waitcnt lgkmcnt(0)
  s_barrier
  v_smfmac_f32_16x16x64_bf16 v[28:31], v[48:51], a[224:231], v1
  s_nop 2
  v_smfmac_f32_16x16x64_bf16 v[28:31], v[52:55], a[232:239], v1
  s_nop 0
  v_add_f32 v24, v24, v26
  v_smfmac_f32_16x16x64_bf16 v[28:31], v[56:59], a[240:247], v1
  v_add_f32 v25, v25, v27
  v_smfmac_f32_16x16x64_bf16 v[28:31], v[60:63], a[248:255], v1
  v_cvt_pk_bf16_f32 v24, v24, v25
  v_smfmac_f32_16x16x64_bf16 v[28:31], v[32:35], a[192:199], v1
  ds_write_b32 v6, v24 offset:9216
  v_mov_b64 v[16:17], 0
  v_smfmac_f32_16x16x64_bf16 v[28:31], v[36:39], a[200:207], v1
  v_mov_b64 v[18:19], 0
  s_nop 0
  v_smfmac_f32_16x16x64_bf16 v[12:15], v[32:35], v[192:199], v1
  s_nop 2
  v_smfmac_f32_16x16x64_bf16 v[12:15], v[36:39], v[200:207], v1
  s_nop 0
  v_add_f32 v28, v28, v30
  v_add_f32 v29, v29, v31
  v_cvt_pk_bf16_f32 v28, v28, v29
  v_smfmac_f32_16x16x64_bf16 v[12:15], v[40:43], v[208:215], v1
  ds_write_b32 v6, v28 offset:9728
  v_smfmac_f32_16x16x64_bf16 v[12:15], v[44:47], v[216:223], v1
  ds_read_b128 v[192:195], v7 offset:16384
  v_smfmac_f32_16x16x64_bf16 v[12:15], v[48:51], v[224:231], v1
  ds_read_b128 v[196:199], v7 offset:17408
  v_mov_b64 v[20:21], 0
  v_smfmac_f32_16x16x64_bf16 v[12:15], v[52:55], v[232:239], v1
  ds_read_b128 v[200:203], v7 offset:18432
  v_mov_b64 v[22:23], 0
  v_smfmac_f32_16x16x64_bf16 v[12:15], v[56:59], v[240:247], v1
  ds_read_b128 v[204:207], v7 offset:19456
  v_smfmac_f32_16x16x64_bf16 v[12:15], v[60:63], v[248:255], v1
  ds_read_b128 v[208:211], v7 offset:20480
  ds_read_b128 v[212:215], v7 offset:21504
  v_smfmac_f32_16x16x64_bf16 v[16:19], v[32:35], v[64:71], v1
  ds_read_b128 v[216:219], v7 offset:22528
  ds_read_b128 v[220:223], v7 offset:23552
  s_nop 0
  v_smfmac_f32_16x16x64_bf16 v[16:19], v[36:39], v[72:79], v1
  s_waitcnt lgkmcnt(8)
  s_barrier
  ds_read_b128 v[224:227], v7 offset:24576
  v_add_f32 v12, v12, v14
  v_smfmac_f32_16x16x64_bf16 v[16:19], v[40:43], v[80:87], v1
  ds_read_b128 v[228:231], v7 offset:25600
  v_add_f32 v13, v13, v15
  v_smfmac_f32_16x16x64_bf16 v[16:19], v[44:47], v[88:95], v1
  ds_read_b128 v[232:235], v7 offset:26624
  v_cvt_pk_bf16_f32 v12, v12, v13
  v_smfmac_f32_16x16x64_bf16 v[16:19], v[48:51], v[96:103], v1
  ds_write_b32 v3, v12 offset:14336
  v_mov_b32 v29, 0
  v_smfmac_f32_16x16x64_bf16 v[16:19], v[52:55], v[104:111], v1
  ds_read_b128 v[236:239], v7 offset:27648
  v_mov_b32 v31, 0
  v_smfmac_f32_16x16x64_bf16 v[16:19], v[56:59], v[112:119], v1
  ds_read_b128 v[240:243], v7 offset:28672
  v_lshrrev_b32 v0, 7, v8
  v_smfmac_f32_16x16x64_bf16 v[16:19], v[60:63], v[120:127], v1
  ds_read_b128 v[244:247], v7 offset:29696
  ds_read_b128 v[248:251], v7 offset:30720
  s_waitcnt lgkmcnt(6)
  v_smfmac_f32_16x16x64_bf16 v[20:23], v[32:35], v[192:199], v1
  ds_read_b128 v[252:255], v7 offset:31744
  s_nop 1
  v_smfmac_f32_16x16x64_bf16 v[20:23], v[36:39], v[200:207], v1
  s_nop 0
  v_add_f32 v16, v16, v18
  v_add_f32 v17, v17, v19
  v_cvt_pk_bf16_f32 v16, v16, v17
  v_smfmac_f32_16x16x64_bf16 v[20:23], v[40:43], v[208:215], v1
  ds_write_b32 v3, v16 offset:14340
  v_lshlrev_b32 v0, 5, v0
  v_smfmac_f32_16x16x64_bf16 v[20:23], v[44:47], v[216:223], v1
  s_waitcnt vmcnt(9)
  v_add_u32 v0, 8204, v0
  v_smfmac_f32_16x16x64_bf16 v[20:23], v[48:51], v[224:231], v1
  s_cmp_eq_u32 s34, 63
  v_lshrrev_b32 v12, 2, v3
  s_waitcnt lgkmcnt(1)
  v_smfmac_f32_16x16x64_bf16 v[20:23], v[52:55], v[232:239], v1
  v_smfmac_f32_16x16x64_bf16 v[20:23], v[56:59], v[240:247], v1
  v_smfmac_f32_16x16x64_bf16 v[20:23], v[60:63], v[248:255], v1
  s_waitcnt lgkmcnt(0)
  s_barrier
  ds_read_b128 v[24:27], v3 offset:0
  ds_read_b32 v28, v3 offset:1024
  ds_read_b128 v[192:195], v7 offset:32768
  ds_read_b128 v[196:199], v7 offset:33792
  ds_read_b128 v[200:203], v7 offset:34816
  ds_read_b128 v[204:207], v7 offset:35840
  ds_read_b128 v[208:211], v7 offset:36864
  ds_read_b128 v[212:215], v7 offset:37888
  ds_read_b128 v[216:219], v7 offset:38912
  ds_read_b128 v[220:223], v7 offset:39936
  v_add_f32 v20, v20, v22
  v_add_f32 v21, v21, v23
  v_cvt_pk_bf16_f32 v30, v20, v21
  s_waitcnt lgkmcnt(8)
  s_mov_b32 s24, 0xff00ff
  v_mfma_f32_16x16x16_bf16 v[24:27], v[30:31], v[28:29], v[24:27]
  buffer_store_dword v30, v12, s[4:7], s45 offen offset:1536 sc1
  s_cbranch_scc1 cs1_exit
  s_mov_b32 s25, s24
  v_mov_b64 v[48:49], 0
  v_mov_b64 v[50:51], 0
  v_mov_b64 v[52:53], 0
  v_mov_b64 v[54:55], 0
  v_mov_b64 v[56:57], 0
  v_cvt_pk_bf16_f32 v24, v24, v25
  v_cvt_pk_bf16_f32 v25, v26, v27
  s_mov_b64 exec, s[24:25]
  ds_write_b64 v4, v[24:25] offset:13320
  s_mov_b64 exec, -1
  ds_write_b32 v3, v30 offset:15368
  v_mov_b64 v[58:59], 0
  v_mov_b64 v[60:61], 0
  v_mov_b64 v[62:63], 0
  s_waitcnt lgkmcnt(0)
  s_barrier
cs1_wo:
  ds_read_b128 v[32:35], v8 offset:12288
  ds_read_b128 v[36:39], v8 offset:12800
  ds_read_b128 v[40:43], v8 offset:13312
  ds_read_b128 v[44:47], v8 offset:13824
  s_waitcnt lgkmcnt(3)
  v_smfmac_f32_16x16x64_bf16 v[48:51], v[32:35], v[128:135], v1 abid:1
  ds_read2_b32 v[28:29], v0 offset0:0 offset1:4
  s_waitcnt lgkmcnt(3)
  v_smfmac_f32_16x16x64_bf16 v[48:51], v[36:39], v[136:143], v1 abid:1
  ds_read_b128 v[224:227], v7 offset:40960
  ds_read_b128 v[228:231], v7 offset:41984
  s_waitcnt lgkmcnt(4)
  v_smfmac_f32_16x16x64_bf16 v[48:51], v[40:43], v[144:151], v1 abid:1
  ds_read_b128 v[232:235], v7 offset:43008
  ds_read_b128 v[236:239], v7 offset:44032
  s_waitcnt lgkmcnt(5)
  v_smfmac_f32_16x16x64_bf16 v[48:51], v[44:47], v[152:159], v1 abid:1
  ds_read_b128 v[240:243], v7 offset:45056
  ds_read_b128 v[244:247], v7 offset:46080
  v_smfmac_f32_16x16x64_bf16 v[52:55], v[32:35], v[160:167], v1 abid:1
  ds_read_b128 v[248:251], v7 offset:47104
  ds_read_b128 v[252:255], v7 offset:48128
  s_nop 0
  v_smfmac_f32_16x16x64_bf16 v[52:55], v[36:39], v[168:175], v1 abid:1
  s_waitcnt lgkmcnt(8)
  v_cmp_gt_f32 vcc, 0, v28
  v_mul_f32 v48, v28, v48
  v_mul_f32 v49, v29, v49
  v_mul_f32 v50, v28, v50
  v_mul_f32 v51, v29, v51
  v_cvt_pk_bf16_f32 v48, v48, v49
  v_cvt_pk_bf16_f32 v49, v50, v51
  v_smfmac_f32_16x16x64_bf16 v[52:55], v[40:43], v[176:183], v1 abid:1
  s_cbranch_vccnz cs1_redo
  buffer_store_dwordx2 v[48:49], v10, s[4:7], s36 offen offset:0 sc1
  v_smfmac_f32_16x16x64_bf16 v[52:55], v[44:47], v[184:191], v1 abid:1
  ds_read_b32 v16, v3 offset:10244
  ds_read_b32 v17, v3 offset:10252
  v_smfmac_f32_16x16x64_bf16 v[56:59], v[32:35], v[192:199], v1 abid:1
  ds_read_b32 v18, v3 offset:11268
  ds_read_b32 v19, v3 offset:11276
  s_nop 0
  v_smfmac_f32_16x16x64_bf16 v[56:59], v[36:39], v[200:207], v1 abid:1
  s_nop 0
  v_mul_f32 v52, v28, v52
  v_mul_f32 v53, v29, v53
  v_mul_f32 v54, v28, v54
  v_mul_f32 v55, v29, v55
  v_cvt_pk_bf16_f32 v52, v52, v53
  v_cvt_pk_bf16_f32 v53, v54, v55
  v_smfmac_f32_16x16x64_bf16 v[56:59], v[40:43], v[208:215], v1 abid:1
  buffer_store_dwordx2 v[52:53], v10, s[4:7], s36 offen offset:2048 sc1
  v_smfmac_f32_16x16x64_bf16 v[56:59], v[44:47], v[216:223], v1 abid:1
  s_nop 1
  s_waitcnt lgkmcnt(4)
  v_smfmac_f32_16x16x64_bf16 v[60:63], v[32:35], v[224:231], v1 abid:1
  s_nop 2
  v_smfmac_f32_16x16x64_bf16 v[60:63], v[36:39], v[232:239], v1 abid:1
  s_nop 0
  v_mul_f32 v56, v28, v56
  v_mul_f32 v57, v29, v57
  v_mul_f32 v58, v28, v58
  v_mul_f32 v59, v29, v59
  v_cvt_pk_bf16_f32 v56, v56, v57
  v_cvt_pk_bf16_f32 v57, v58, v59
  v_smfmac_f32_16x16x64_bf16 v[60:63], v[40:43], v[240:247], v1 abid:1
  buffer_store_dwordx2 v[56:57], v10, s[4:7], s51 offen offset:0 sc1
  v_smfmac_f32_16x16x64_bf16 v[60:63], v[44:47], v[248:255], v1 abid:1
  s_add_u32 s34, s34, 1
  s_and_b32 s41, s34, 3
  s_lshl_b32 s41, s41, 15
  s_add_u32 s35, s41, 84936704
  s_mov_b32 s40, 0
  s_nop 2
  v_mul_f32 v60, v28, v60
  v_mul_f32 v61, v29, v61
  v_mul_f32 v62, v28, v62
  v_mul_f32 v63, v29, v63
  v_cvt_pk_bf16_f32 v60, v60, v61
  v_cvt_pk_bf16_f32 v61, v62, v63
  buffer_store_dwordx2 v[60:61], v10, s[4:7], s51 offen offset:2048 sc1
  ds_read_b128 v[192:195], v7 offset:0
  ds_read_b128 v[196:199], v7 offset:1024
  ds_read_b128 v[200:203], v7 offset:2048
  ds_read_b128 v[204:207], v7 offset:3072
  ds_read_b128 v[208:211], v7 offset:4096
  ds_read_b128 v[212:215], v7 offset:5120
  ds_read_b128 v[216:219], v7 offset:6144
  ds_read_b128 v[220:223], v7 offset:7168
  ds_read_b128 v[224:227], v7 offset:8192
  ds_read_b128 v[228:231], v7 offset:9216
  ds_read_b128 v[232:235], v7 offset:10240
  ds_read_b128 v[236:239], v7 offset:11264
  buffer_load_dwordx4 v[32:35], v3, s[4:7], s37 offen offset:0 sc1
  buffer_load_dwordx4 v[36:39], v3, s[4:7], s37 offen offset:1024 sc1
  ds_read_b128 v[240:243], v7 offset:12288
  ds_read_b128 v[244:247], v7 offset:13312
  ds_read_b128 v[248:251], v7 offset:14336
  ds_read_b128 v[252:255], v7 offset:15360
  s_nop 7
  s_nop 7
  s_nop 7
  buffer_load_dwordx4 v[32:35], v3, s[4:7], s37 offen offset:0 sc1
  buffer_load_dwordx4 v[36:39], v3, s[4:7], s37 offen offset:1024 sc1
  s_branch cs1_pollA1
cs1_pollA:
  buffer_load_dwordx4 v[32:35], v3, s[4:7], s37 offen offset:0 sc1
  buffer_load_dwordx4 v[36:39], v3, s[4:7], s37 offen offset:1024 sc1
cs1_pollA1:
  s_add_u32 s40, s40, 1
  s_add_u32 s67, s67, 1
  s_mov_b32 s24, 3
  s_cmp_gt_u32 s40, 63
  s_cbranch_scc1 cs1_nanA
cs1_pollA2:
  s_waitcnt vmcnt(3) lgkmcnt(0)
  v_mfma_f32_16x16x32_bf16 v[20:23], v[16:19], v[32:35], 0
  s_waitcnt vmcnt(2) lgkmcnt(0)
  v_mfma_f32_16x16x32_bf16 v[20:23], v[16:19], v[36:39], v[20:23]
  s_nop 7
  v_cmp_class_f32 vcc, v22, s24
  v_add_f32_dpp v20, v20, v20 row_ror:4 row_mask:0xf bank_mask:0xf
  v_add_f32_dpp v21, v21, v21 row_ror:4 row_mask:0xf bank_mask:0xf
  s_nop 0
  v_add_f32_dpp v20, v20, v20 row_ror:8 row_mask:0xf bank_mask:0xf
  v_add_f32_dpp v21, v21, v21 row_ror:8 row_mask:0xf bank_mask:0xf
  v_cvt_pk_bf16_f32 v24, v20, v21
  s_cbranch_vccnz cs1_pollA
cs1_pub:
  buffer_store_dword v24, v2, s[4:7], s38 offen sc1
  s_branch cs1_step
cs1_p1w:
  s_mov_b32 s51, 0
L_p1w_3:
  v_readlane_b32 s41, v11, 0
  v_readlane_b32 s42, v11, 1
  v_readlane_b32 s50, v11, 2
  v_readlane_b32 s48, v11, 3
  s_min_u32 s41, s41, s50
  s_min_u32 s42, s42, s48
  s_lshl_b32 s41, s41, 2
  s_lshl_b32 s42, s42, 2
  s_add_u32 s42, s42, 2
  s_min_u32 s48, s41, s42
  s_max_u32 s48, s48, 1
  s_sub_u32 s48, s48, 1
  s_cmp_eq_u32 s48, 63
  s_cselect_b32 s48, 64, s48
  s_cmp_lt_u32 s34, s48
  s_cbranch_scc1 cs1_p1d
  s_cmp_gt_u32 s51, 131072
  s_cbranch_scc1 cs1_p1d
  s_add_u32 s51, s51, 1
  buffer_load_dword v11, v9, s[4:7], s71 offen sc1
  s_waitcnt vmcnt(0)
  s_branch L_p1w_3
cs1_retryB:
cs1_nanA:
  s_waitcnt vmcnt(0)
  v_max3_u32 v0, v32, v33, v34
  v_max3_u32 v0, v0, v35, v36
  v_max3_u32 v0, v0, v37, v38
  v_max_u32 v0, v0, v39
  v_cmp_eq_u32 vcc, -1, v0
  s_nop 4
  s_cmp_eq_u64 vcc, 0
  s_cselect_b32 s24, 0, 3
  s_cmp_gt_u32 s40, 1048576
  s_cselect_b32 s24, 0, s24
  s_branch cs1_pollA2
cs1_redo:
  s_nop 7
  v_mov_b64 v[48:49], 0
  v_mov_b64 v[50:51], 0
  v_mov_b64 v[52:53], 0
  v_mov_b64 v[54:55], 0
  v_mov_b64 v[56:57], 0
  v_mov_b64 v[58:59], 0
  v_mov_b64 v[60:61], 0
  v_mov_b64 v[62:63], 0
  s_waitcnt lgkmcnt(0)
  s_barrier
  s_barrier
  s_branch cs1_wo
cs1_exit:
  s_waitcnt vmcnt(0)
  s_barrier
  s_endpgm
cs2_step:
  v_mov_b64 v[12:13], -1
  v_mov_b64 v[14:15], -1
  v_mov_b64 v[16:17], 0
  v_mov_b64 v[18:19], 0
  v_mov_b64 v[20:21], 0
  v_mov_b64 v[22:23], 0
  v_mov_b64 v[26:27], 0
  v_mov_b64 v[28:29], 0
  v_mov_b64 v[30:31], 0
  s_xor_b32 s37, s37, 0x40000
  s_xor_b32 s36, s36, 0x40000
  s_mov_b32 s40, 0
  v_mov_b64 v[24:25], 0
  s_add_u32 s46, s46, 262144
  s_min_u32 s46, s46, s70
  s_add_u32 s45, s45, 65536
  s_xor_b32 s47, s47, 0x40000
  s_waitcnt vmcnt(0)
  buffer_load_dwordx4 v[48:51], v3, s[4:7], s35 offen offset:0 sc1
  buffer_load_dwordx4 v[52:55], v3, s[4:7], s35 offen offset:1024 sc1
  s_barrier
  s_nop 7
  s_nop 7
  s_nop 7
  buffer_load_dwordx4 v[48:51], v3, s[4:7], s35 offen offset:0 sc1
  buffer_load_dwordx4 v[52:55], v3, s[4:7], s35 offen offset:1024 sc1
  s_branch cs2_chkB1
cs2_chkB:
  buffer_load_dwordx4 v[48:51], v3, s[4:7], s35 offen offset:0 sc1
  buffer_load_dwordx4 v[52:55], v3, s[4:7], s35 offen offset:1024 sc1
cs2_chkB1:
  s_add_u32 s40, s40, 1
  s_add_u32 s68, s68, 1
  s_cmp_gt_u32 s40, 1048576
  s_cselect_b32 s51, -1, -2
  s_waitcnt vmcnt(2)
  v_max3_u32 v0, v48, v49, v50
  v_max3_u32 v0, v0, v51, v52
  v_max3_u32 v0, v0, v53, v54
  v_max_u32 v0, v0, v55
  v_cmp_lt_u32 vcc, s51, v0
  ds_write_b128 v3, v[48:51] offset:4096
  ds_write_b128 v3, v[52:55] offset:5120
  s_cbranch_vccnz cs2_chkB
cs2_okB:
  v_smfmac_f32_16x16x64_bf16 v[16:19], v[48:51], a[32:39], v1
  v_mov_b32 v0, -1
  v_smfmac_f32_16x16x64_bf16 v[20:23], v[48:51], a[96:103], v1
  buffer_store_dword v0, v2, s[4:7], s39 offen sc1
  v_smfmac_f32_16x16x64_bf16 v[16:19], v[52:55], a[40:47], v1
  s_mov_b32 s39, s38
  s_add_u32 s38, s38, 0x8000
  v_smfmac_f32_16x16x64_bf16 v[20:23], v[52:55], a[104:111], v1
  s_waitcnt lgkmcnt(0)
  s_barrier
  ds_read_b128 v[56:59], v3 offset:6144
  ds_read_b128 v[60:63], v3 offset:7168
  s_and_b32 s38, s38, 0xfffdffff
  s_sub_u32 s39, s39, 0x8000
  v_smfmac_f32_16x16x64_bf16 v[24:27], v[48:51], a[160:167], v1
  ds_read_b128 v[32:35], v3 offset:0
  ds_read_b128 v[36:39], v3 offset:1024
  v_smfmac_f32_16x16x64_bf16 v[28:31], v[48:51], a[224:231], v1
  ds_read_b128 v[40:43], v3 offset:2048
  ds_read_b128 v[44:47], v3 offset:3072
  v_smfmac_f32_16x16x64_bf16 v[24:27], v[52:55], a[168:175], v1
  v_smfmac_f32_16x16x64_bf16 v[28:31], v[52:55], a[232:239], v1
  s_waitcnt lgkmcnt(5)
  v_smfmac_f32_16x16x64_bf16 v[16:19], v[56:59], a[48:55], v1
  s_waitcnt lgkmcnt(4)
  v_smfmac_f32_16x16x64_bf16 v[16:19], v[60:63], a[56:63], v1
  s_waitcnt lgkmcnt(3)
  v_smfmac_f32_16x16x64_bf16 v[16:19], v[32:35], a[0:7], v1
  buffer_load_dwordx4 v3, s[4:7], s46 offen offset:0 sc1 lds
  s_waitcnt lgkmcnt(2)
  v_smfmac_f32_16x16x64_bf16 v[16:19], v[36:39], a[8:15], v1
  buffer_store_dwordx4 v[12:15], v3, s[4:7], s47 offen offset:0 sc1
  s_waitcnt lgkmcnt(1)
  v_smfmac_f32_16x16x64_bf16 v[16:19], v[40:43], a[16:23], v1
  s_waitcnt lgkmcnt(0)
  v_smfmac_f32_16x16x64_bf16 v[16:19], v[44:47], a[24:31], v1
  s_nop 1
  v_smfmac_f32_16x16x64_bf16 v[20:23], v[56:59], a[112:119], v1
  buffer_store_dwordx4 v[12:15], v3, s[4:7], s47 offen offset:1024 sc1
  buffer_load_dwordx4 v3, s[4:7], s46 offen offset:1024 sc1 lds
  s_nop 0
  v_smfmac_f32_16x16x64_bf16 v[20:23], v[60:63], a[120:127], v1
  s_nop 0
  v_add_f32 v16, v16, v18
  v_add_f32 v17, v17, v19
  v_smfmac_f32_16x16x64_bf16 v[20:23], v[32:35], a[64:71], v1
  v_mul_f32 v16, s43, v16
  v_mul_f32 v17, s43, v17
  v_smfmac_f32_16x16x64_bf16 v[20:23], v[36:39], a[72:79], v1
  buffer_store_dwordx4 v[12:15], v3, s[4:7], s47 offen offset:2048 sc1
  v_cvt_pk_bf16_f32 v16, v16, v17
  v_smfmac_f32_16x16x64_bf16 v[20:23], v[40:43], a[80:87], v1
  ds_write_b32 v5, v16 offset:13312
  buffer_load_dwordx4 v3, s[4:7], s46 offen offset:2048 sc1 lds
  v_smfmac_f32_16x16x64_bf16 v[20:23], v[44:47], a[88:95], v1
  s_nop 1
  v_smfmac_f32_16x16x64_bf16 v[24:27], v[56:59], a[176:183], v1
  s_nop 2
  v_smfmac_f32_16x16x64_bf16 v[24:27], v[60:63], a[184:191], v1
  s_nop 0
  v_add_f32 v20, v20, v22
  v_add_f32 v21, v21, v23
  v_mul_f32 v20, s43, v20
  v_mul_f32 v21, s43, v21
  v_cvt_pk_bf16_f32 v20, v20, v21
  v_smfmac_f32_16x16x64_bf16 v[24:27], v[32:35], a[128:135], v1
  ds_write_b32 v5, v20 offset:13568
  buffer_load_dwordx4 v3, s[4:7], s46 offen offset:3072 sc1 lds
  v_smfmac_f32_16x16x64_bf16 v[24:27], v[36:39], a[136:143], v1
  s_and_b32 s39, s39, 0x1ffff
  s_add_u32 s39, s39, 84934656
  v_mov_b64 v[12:13], 0
  v_smfmac_f32_16x16x64_bf16 v[24:27], v[40:43], a[144:151], v1
  s_add_u32 s51, s36, 4096
  v_mov_b64 v[14:15], 0
  v_smfmac_f32_16x16x64_bf16 v[24:27], v[44:47], a[152:159], v1
  s_waitcnt lgkmcnt(0)
  s_barrier
  v_smfmac_f32_16x16x64_bf16 v[28:31], v[56:59], a[240:247], v1
  s_nop 2
  v_smfmac_f32_16x16x64_bf16 v[28:31], v[60:63], a[248:255], v1
  s_nop 0
  v_add_f32 v24, v24, v26
  v_smfmac_f32_16x16x64_bf16 v[28:31], v[32:35], a[192:199], v1
  v_add_f32 v25, v25, v27
  v_smfmac_f32_16x16x64_bf16 v[28:31], v[36:39], a[200:207], v1
  v_cvt_pk_bf16_f32 v24, v24, v25
  v_smfmac_f32_16x16x64_bf16 v[28:31], v[40:43], a[208:215], v1
  ds_write_b32 v6, v24 offset:10240
  v_mov_b64 v[16:17], 0
  v_smfmac_f32_16x16x64_bf16 v[28:31], v[44:47], a[216:223], v1
  v_mov_b64 v[18:19], 0
  s_nop 0
  v_smfmac_f32_16x16x64_bf16 v[12:15], v[32:35], v[192:199], v1
  s_nop 2
  v_smfmac_f32_16x16x64_bf16 v[12:15], v[36:39], v[200:207], v1
  s_nop 0
  v_add_f32 v28, v28, v30
  v_add_f32 v29, v29, v31
  v_cvt_pk_bf16_f32 v28, v28, v29
  v_smfmac_f32_16x16x64_bf16 v[12:15], v[40:43], v[208:215], v1
  ds_write_b32 v6, v28 offset:10752
  v_smfmac_f32_16x16x64_bf16 v[12:15], v[44:47], v[216:223], v1
  ds_read_b128 v[192:195], v7 offset:16384
  v_smfmac_f32_16x16x64_bf16 v[12:15], v[48:51], v[224:231], v1
  ds_read_b128 v[196:199], v7 offset:17408
  v_mov_b64 v[20:21], 0
  v_smfmac_f32_16x16x64_bf16 v[12:15], v[52:55], v[232:239], v1
  ds_read_b128 v[200:203], v7 offset:18432
  v_mov_b64 v[22:23], 0
  v_smfmac_f32_16x16x64_bf16 v[12:15], v[56:59], v[240:247], v1
  ds_read_b128 v[204:207], v7 offset:19456
  v_smfmac_f32_16x16x64_bf16 v[12:15], v[60:63], v[248:255], v1
  ds_read_b128 v[208:211], v7 offset:20480
  ds_read_b128 v[212:215], v7 offset:21504
  v_smfmac_f32_16x16x64_bf16 v[16:19], v[32:35], v[64:71], v1
  ds_read_b128 v[216:219], v7 offset:22528
  ds_read_b128 v[220:223], v7 offset:23552
  s_nop 0
  v_smfmac_f32_16x16x64_bf16 v[16:19], v[36:39], v[72:79], v1
  s_waitcnt lgkmcnt(8)
  s_barrier
  ds_read_b128 v[224:227], v7 offset:24576
  v_add_f32 v12, v12, v14
  v_smfmac_f32_16x16x64_bf16 v[16:19], v[40:43], v[80:87], v1
  ds_read_b128 v[228:231], v7 offset:25600
  v_add_f32 v13, v13, v15
  v_smfmac_f32_16x16x64_bf16 v[16:19], v[44:47], v[88:95], v1
  ds_read_b128 v[232:235], v7 offset:26624
  v_cvt_pk_bf16_f32 v12, v12, v13
  v_smfmac_f32_16x16x64_bf16 v[16:19], v[48:51], v[96:103], v1
  ds_write_b32 v3, v12 offset:14344
  v_mov_b32 v29, 0
  v_smfmac_f32_16x16x64_bf16 v[16:19], v[52:55], v[104:111], v1
  ds_read_b128 v[236:239], v7 offset:27648
  v_mov_b32 v31, 0
  v_smfmac_f32_16x16x64_bf16 v[16:19], v[56:59], v[112:119], v1
  ds_read_b128 v[240:243], v7 offset:28672
  v_lshrrev_b32 v0, 7, v8
  v_smfmac_f32_16x16x64_bf16 v[16:19], v[60:63], v[120:127], v1
  ds_read_b128 v[244:247], v7 offset:29696
  ds_read_b128 v[248:251], v7 offset:30720
  s_waitcnt lgkmcnt(6)
  v_smfmac_f32_16x16x64_bf16 v[20:23], v[32:35], v[192:199], v1
  ds_read_b128 v[252:255], v7 offset:31744
  s_nop 1
  v_smfmac_f32_16x16x64_bf16 v[20:23], v[36:39], v[200:207], v1
  s_nop 0
  v_add_f32 v16, v16, v18
  v_add_f32 v17, v17, v19
  v_cvt_pk_bf16_f32 v16, v16, v17
  v_smfmac_f32_16x16x64_bf16 v[20:23], v[40:43], v[208:215], v1
  ds_write_b32 v3, v16 offset:14348
  v_lshlrev_b32 v0, 5, v0
  v_smfmac_f32_16x16x64_bf16 v[20:23], v[44:47], v[216:223], v1
  s_waitcnt vmcnt(8)
  v_add_u32 v0, 8204, v0
  v_smfmac_f32_16x16x64_bf16 v[20:23], v[48:51], v[224:231], v1
  s_cmp_eq_u32 s34, 63
  v_lshrrev_b32 v12, 2, v3
  s_waitcnt lgkmcnt(1)
  v_smfmac_f32_16x16x64_bf16 v[20:23], v[52:55], v[232:239], v1
  v_smfmac_f32_16x16x64_bf16 v[20:23], v[56:59], v[240:247], v1
  v_smfmac_f32_16x16x64_bf16 v[20:23], v[60:63], v[248:255], v1
  s_waitcnt lgkmcnt(0)
  s_barrier
  ds_read_b128 v[24:27], v3 offset:0
  ds_read_b32 v28, v3 offset:1024
  ds_read_b128 v[192:195], v7 offset:32768
  ds_read_b128 v[196:199], v7 offset:33792
  ds_read_b128 v[200:203], v7 offset:34816
  ds_read_b128 v[204:207], v7 offset:35840
  ds_read_b128 v[208:211], v7 offset:36864
  ds_read_b128 v[212:215], v7 offset:37888
  ds_read_b128 v[216:219], v7 offset:38912
  ds_read_b128 v[220:223], v7 offset:39936
  v_add_f32 v20, v20, v22
  v_add_f32 v21, v21, v23
  v_cvt_pk_bf16_f32 v30, v20, v21
  s_waitcnt lgkmcnt(8)
  s_mov_b32 s24, 0xff00ff00
  v_mfma_f32_16x16x16_bf16 v[24:27], v[30:31], v[28:29], v[24:27]
  buffer_store_dword v30, v12, s[4:7], s45 offen offset:1792 sc1
  s_cbranch_scc1 cs2_exit
  s_mov_b32 s25, s24
  v_mov_b64 v[48:49], 0
  v_mov_b64 v[50:51], 0
  v_mov_b64 v[52:53], 0
  v_mov_b64 v[54:55], 0
  v_mov_b64 v[56:57], 0
  v_cvt_pk_bf16_f32 v24, v24, v25
  v_cvt_pk_bf16_f32 v25, v26, v27
  s_mov_b64 exec, s[24:25]
  ds_write_b64 v4, v[24:25] offset:13320
  s_mov_b64 exec, -1
  ds_write_b32 v3, v30 offset:15372
  v_mov_b64 v[58:59], 0
  v_mov_b64 v[60:61], 0
  v_mov_b64 v[62:63], 0
  s_waitcnt lgkmcnt(0)
  s_barrier
cs2_wo:
  ds_read_b128 v[32:35], v8 offset:12288
  ds_read_b128 v[36:39], v8 offset:12800
  ds_read_b128 v[40:43], v8 offset:13312
  ds_read_b128 v[44:47], v8 offset:13824
  s_waitcnt lgkmcnt(3)
  v_smfmac_f32_16x16x64_bf16 v[48:51], v[32:35], v[128:135], v1 abid:1
  ds_read2_b32 v[28:29], v0 offset0:0 offset1:4
  s_waitcnt lgkmcnt(3)
  v_smfmac_f32_16x16x64_bf16 v[48:51], v[36:39], v[136:143], v1 abid:1
  ds_read_b128 v[224:227], v7 offset:40960
  ds_read_b128 v[228:231], v7 offset:41984
  s_waitcnt lgkmcnt(4)
  v_smfmac_f32_16x16x64_bf16 v[48:51], v[40:43], v[144:151], v1 abid:1
  ds_read_b128 v[232:235], v7 offset:43008
  ds_read_b128 v[236:239], v7 offset:44032
  s_waitcnt lgkmcnt(5)
  v_smfmac_f32_16x16x64_bf16 v[48:51], v[44:47], v[152:159], v1 abid:1
  ds_read_b128 v[240:243], v7 offset:45056
  ds_read_b128 v[244:247], v7 offset:46080
  v_smfmac_f32_16x16x64_bf16 v[52:55], v[32:35], v[160:167], v1 abid:1
  ds_read_b128 v[248:251], v7 offset:47104
  ds_read_b128 v[252:255], v7 offset:48128
  s_nop 0
  v_smfmac_f32_16x16x64_bf16 v[52:55], v[36:39], v[168:175], v1 abid:1
  s_waitcnt lgkmcnt(8)
  v_cmp_gt_f32 vcc, 0, v28
  v_mul_f32 v48, v28, v48
  v_mul_f32 v49, v29, v49
  v_mul_f32 v50, v28, v50
  v_mul_f32 v51, v29, v51
  v_cvt_pk_bf16_f32 v48, v48, v49
  v_cvt_pk_bf16_f32 v49, v50, v51
  v_smfmac_f32_16x16x64_bf16 v[52:55], v[40:43], v[176:183], v1 abid:1
  s_cbranch_vccnz cs2_redo
  buffer_store_dwordx2 v[48:49], v10, s[4:7], s36 offen offset:0 sc1
  v_smfmac_f32_16x16x64_bf16 v[52:55], v[44:47], v[184:191], v1 abid:1
  ds_read_b32 v16, v3 offset:10244
  ds_read_b32 v17, v3 offset:10252
  v_smfmac_f32_16x16x64_bf16 v[56:59], v[32:35], v[192:199], v1 abid:1
  ds_read_b32 v18, v3 offset:11268
  ds_read_b32 v19, v3 offset:11276
  s_nop 0
  v_smfmac_f32_16x16x64_bf16 v[56:59], v[36:39], v[200:207], v1 abid:1
  s_nop 0
  v_mul_f32 v52, v28, v52
  v_mul_f32 v53, v29, v53
  v_mul_f32 v54, v28, v54
  v_mul_f32 v55, v29, v55
  v_cvt_pk_bf16_f32 v52, v52, v53
  v_cvt_pk_bf16_f32 v53, v54, v55
  v_smfmac_f32_16x16x64_bf16 v[56:59], v[40:43], v[208:215], v1 abid:1
  buffer_store_dwordx2 v[52:53], v10, s[4:7], s36 offen offset:2048 sc1
  v_smfmac_f32_16x16x64_bf16 v[56:59], v[44:47], v[216:223], v1 abid:1
  s_nop 1
  s_waitcnt lgkmcnt(4)
  v_smfmac_f32_16x16x64_bf16 v[60:63], v[32:35], v[224:231], v1 abid:1
  s_nop 2
  v_smfmac_f32_16x16x64_bf16 v[60:63], v[36:39], v[232:239], v1 abid:1
  s_nop 0
  v_mul_f32 v56, v28, v56
  v_mul_f32 v57, v29, v57
  v_mul_f32 v58, v28, v58
  v_mul_f32 v59, v29, v59
  v_cvt_pk_bf16_f32 v56, v56, v57
  v_cvt_pk_bf16_f32 v57, v58, v59
  v_smfmac_f32_16x16x64_bf16 v[60:63], v[40:43], v[240:247], v1 abid:1
  buffer_store_dwordx2 v[56:57], v10, s[4:7], s51 offen offset:0 sc1
  v_smfmac_f32_16x16x64_bf16 v[60:63], v[44:47], v[248:255], v1 abid:1
  s_add_u32 s34, s34, 1
  s_and_b32 s41, s34, 3
  s_lshl_b32 s41, s41, 15
  s_add_u32 s35, s41, 84938752
  s_mov_b32 s40, 0
  s_nop 2
  v_mul_f32 v60, v28, v60
  v_mul_f32 v61, v29, v61
  v_mul_f32 v62, v28, v62
  v_mul_f32 v63, v29, v63
  v_cvt_pk_bf16_f32 v60, v60, v61
  v_cvt_pk_bf16_f32 v61, v62, v63
  buffer_store_dwordx2 v[60:61], v10, s[4:7], s51 offen offset:2048 sc1
  ds_read_b128 v[192:195], v7 offset:0
  ds_read_b128 v[196:199], v7 offset:1024
  ds_read_b128 v[200:203], v7 offset:2048
  ds_read_b128 v[204:207], v7 offset:3072
  s_waitcnt vmcnt(1)
  buffer_load_dwordx4 v[32:35], v3, s[4:7], s37 offen offset:0 sc1
  buffer_load_dwordx4 v[36:39], v3, s[4:7], s37 offen offset:1024 sc1
  ds_read_b128 v[208:211], v7 offset:4096
  ds_read_b128 v[212:215], v7 offset:5120
  ds_read_b128 v[216:219], v7 offset:6144
  ds_read_b128 v[220:223], v7 offset:7168
  ds_read_b128 v[224:227], v7 offset:8192
  ds_read_b128 v[228:231], v7 offset:9216
  ds_read_b128 v[232:235], v7 offset:10240
  ds_read_b128 v[236:239], v7 offset:11264
  ds_read_b128 v[240:243], v7 offset:12288
  ds_read_b128 v[244:247], v7 offset:13312
  ds_read_b128 v[248:251], v7 offset:14336
  ds_read_b128 v[252:255], v7 offset:15360
  s_nop 7
  s_nop 7
  buffer_load_dwordx4 v[32:35], v3, s[4:7], s37 offen offset:0 sc1
  buffer_load_dwordx4 v[36:39], v3, s[4:7], s37 offen offset:1024 sc1
  s_branch cs2_pollA1
cs2_pollA:
  buffer_load_dwordx4 v[32:35], v3, s[4:7], s37 offen offset:0 sc1
  buffer_load_dwordx4 v[36:39], v3, s[4:7], s37 offen offset:1024 sc1
cs2_pollA1:
  s_add_u32 s40, s40, 1
  s_add_u32 s67, s67, 1
  s_mov_b32 s24, 3
  s_cmp_gt_u32 s40, 63
  s_cbranch_scc1 cs2_nanA
cs2_pollA2:
  s_waitcnt vmcnt(3) lgkmcnt(0)
  v_mfma_f32_16x16x32_bf16 v[20:23], v[16:19], v[32:35], 0
  s_waitcnt vmcnt(2) lgkmcnt(0)
  v_mfma_f32_16x16x32_bf16 v[20:23], v[16:19], v[36:39], v[20:23]
  s_nop 7
  v_cmp_class_f32 vcc, v22, s24
  v_add_f32_dpp v20, v20, v20 row_ror:4 row_mask:0xf bank_mask:0xf
  v_add_f32_dpp v21, v21, v21 row_ror:4 row_mask:0xf bank_mask:0xf
  s_nop 0
  v_add_f32_dpp v20, v20, v20 row_ror:8 row_mask:0xf bank_mask:0xf
  v_add_f32_dpp v21, v21, v21 row_ror:8 row_mask:0xf bank_mask:0xf
  v_cvt_pk_bf16_f32 v24, v20, v21
  s_cbranch_vccnz cs2_pollA
cs2_pub:
  buffer_store_dword v24, v2, s[4:7], s38 offen sc1
  s_branch cs2_step
cs2_retryB:
cs2_nanA:
  s_waitcnt vmcnt(0)
  v_max3_u32 v0, v32, v33, v34
  v_max3_u32 v0, v0, v35, v36
  v_max3_u32 v0, v0, v37, v38
  v_max_u32 v0, v0, v39
  v_cmp_eq_u32 vcc, -1, v0
  s_nop 4
  s_cmp_eq_u64 vcc, 0
  s_cselect_b32 s24, 0, 3
  s_cmp_gt_u32 s40, 1048576
  s_cselect_b32 s24, 0, s24
  s_branch cs2_pollA2
cs2_redo:
  s_nop 7
  v_mov_b64 v[48:49], 0
  v_mov_b64 v[50:51], 0
  v_mov_b64 v[52:53], 0
  v_mov_b64 v[54:55], 0
  v_mov_b64 v[56:57], 0
  v_mov_b64 v[58:59], 0
  v_mov_b64 v[60:61], 0
  v_mov_b64 v[62:63], 0
  s_waitcnt lgkmcnt(0)
  s_barrier
  s_barrier
  s_branch cs2_wo
cs2_exit:
  s_waitcnt vmcnt(0)
  s_barrier
  s_endpgm
cs3_step:
  v_mov_b64 v[12:13], -1
  v_mov_b64 v[14:15], -1
  v_mov_b64 v[16:17], 0
  v_mov_b64 v[18:19], 0
  v_mov_b64 v[20:21], 0
  v_mov_b64 v[22:23], 0
  v_mov_b64 v[26:27], 0
  v_mov_b64 v[28:29], 0
  v_mov_b64 v[30:31], 0
  s_xor_b32 s37, s37, 0x40000
  s_xor_b32 s36, s36, 0x40000
  s_mov_b32 s40, 0
  v_mov_b64 v[24:25], 0
  s_add_u32 s46, s46, 262144
  s_min_u32 s46, s46, s70
  s_add_u32 s45, s45, 65536
  s_xor_b32 s47, s47, 0x40000
  s_nop 7
  s_nop 7
  s_nop 3
  buffer_load_dwordx4 v[56:59], v3, s[4:7], s35 offen offset:0 sc1
  buffer_load_dwordx4 v[60:63], v3, s[4:7], s35 offen offset:1024 sc1
  s_barrier
  s_nop 7
  s_nop 7
  s_nop 7
  buffer_load_dwordx4 v[56:59], v3, s[4:7], s35 offen offset:0 sc1
  buffer_load_dwordx4 v[60:63], v3, s[4:7], s35 offen offset:1024 sc1
  s_branch cs3_chkB1
cs3_chkB:
  buffer_load_dwordx4 v[56:59], v3, s[4:7], s35 offen offset:0 sc1
  buffer_load_dwordx4 v[60:63], v3, s[4:7], s35 offen offset:1024 sc1
cs3_chkB1:
  s_add_u32 s40, s40, 1
  s_add_u32 s68, s68, 1
  s_cmp_gt_u32 s40, 1048576
  s_cselect_b32 s51, -1, -2
  s_waitcnt vmcnt(2)
  v_max3_u32 v0, v56, v57, v58
  v_max3_u32 v0, v0, v59, v60
  v_max3_u32 v0, v0, v61, v62
  v_max_u32 v0, v0, v63
  v_cmp_lt_u32 vcc, s51, v0
  ds_write_b128 v3, v[56:59] offset:6144
  ds_write_b128 v3, v[60:63] offset:7168
  s_cbranch_vccnz cs3_chkB
cs3_okB:
  v_smfmac_f32_16x16x64_bf16 v[16:19], v[56:59], a[48:55], v1
  v_mov_b32 v0, -1
  v_smfmac_f32_16x16x64_bf16 v[20:23], v[56:59], a[112:119], v1
  buffer_store_dword v0, v2, s[4:7], s39 offen sc1
  v_smfmac_f32_16x16x64_bf16 v[16:19], v[60:63], a[56:63], v1
  s_mov_b32 s39, s38
  s_add_u32 s38, s38, 0x8000
  v_smfmac_f32_16x16x64_bf16 v[20:23], v[60:63], a[120:127], v1
  s_waitcnt lgkmcnt(0)
  s_barrier
  ds_read_b128 v[32:35], v3 offset:0
  ds_read_b128 v[36:39], v3 offset:1024
  s_and_b32 s38, s38, 0xfffdffff
  s_sub_u32 s39, s39, 0x8000
  v_smfmac_f32_16x16x64_bf16 v[24:27], v[56:59], a[176:183], v1
  ds_read_b128 v[40:43], v3 offset:2048
  ds_read_b128 v[44:47], v3 offset:3072
  v_smfmac_f32_16x16x64_bf16 v[28:31], v[56:59], a[240:247], v1
  ds_read_b128 v[48:51], v3 offset:4096
  ds_read_b128 v[52:55], v3 offset:5120
  v_smfmac_f32_16x16x64_bf16 v[24:27], v[60:63], a[184:191], v1
  v_smfmac_f32_16x16x64_bf16 v[28:31], v[60:63], a[248:255], v1
  s_waitcnt lgkmcnt(5)
  v_smfmac_f32_16x16x64_bf16 v[16:19], v[32:35], a[0:7], v1
  s_waitcnt lgkmcnt(4)
  v_smfmac_f32_16x16x64_bf16 v[16:19], v[36:39], a[8:15], v1
  s_waitcnt lgkmcnt(3)
  v_smfmac_f32_16x16x64_bf16 v[16:19], v[40:43], a[16:23], v1
  s_waitcnt lgkmcnt(2)
  v_smfmac_f32_16x16x64_bf16 v[16:19], v[44:47], a[24:31], v1
  buffer_load_dwordx4 v3, s[4:7], s46 offen offset:0 sc1 lds
  s_waitcnt lgkmcnt(1)
  v_smfmac_f32_16x16x64_bf16 v[16:19], v[48:51], a[32:39], v1
  buffer_store_dwordx4 v[12:15], v3, s[4:7], s47 offen offset:0 sc1
  s_waitcnt lgkmcnt(0)
  v_smfmac_f32_16x16x64_bf16 v[16:19], v[52:55], a[40:47], v1
  s_nop 1
  v_smfmac_f32_16x16x64_bf16 v[20:23], v[32:35], a[64:71], v1
  s_nop 2
  v_smfmac_f32_16x16x64_bf16 v[20:23], v[36:39], a[72:79], v1
  buffer_store_dwordx4 v[12:15], v3, s[4:7], s47 offen offset:1024 sc1
  buffer_load_dwordx4 v3, s[4:7], s46 offen offset:1024 sc1 lds
  v_add_f32 v16, v16, v18
  v_add_f32 v17, v17, v19
  v_smfmac_f32_16x16x64_bf16 v[20:23], v[40:43], a[80:87], v1
  v_mul_f32 v16, s43, v16
  v_mul_f32 v17, s43, v17
  v_smfmac_f32_16x16x64_bf16 v[20:23], v[44:47], a[88:95], v1
  v_cvt_pk_bf16_f32 v16, v16, v17
  v_smfmac_f32_16x16x64_bf16 v[20:23], v[48:51], a[96:103], v1
  ds_write_b32 v5, v16 offset:13824
  v_smfmac_f32_16x16x64_bf16 v[20:23], v[52:55], a[104:111], v1
  buffer_load_dwordx4 v3, s[4:7], s46 offen offset:2048 sc1 lds
  s_nop 0
  v_smfmac_f32_16x16x64_bf16 v[24:27], v[32:35], a[128:135], v1
  s_nop 2
  v_smfmac_f32_16x16x64_bf16 v[24:27], v[36:39], a[136:143], v1
  s_nop 0
  v_add_f32 v20, v20, v22
  v_add_f32 v21, v21, v23
  v_mul_f32 v20, s43, v20
  v_mul_f32 v21, s43, v21
  v_cvt_pk_bf16_f32 v20, v20, v21
  v_smfmac_f32_16x16x64_bf16 v[24:27], v[40:43], a[144:151], v1
  ds_write_b32 v5, v20 offset:14080
  v_smfmac_f32_16x16x64_bf16 v[24:27], v[44:47], a[152:159], v1
  s_and_b32 s39, s39, 0x1ffff
  s_add_u32 s39, s39, 84934656
  v_mov_b64 v[12:13], 0
  buffer_load_dwordx4 v3, s[4:7], s46 offen offset:3072 sc1 lds
  v_smfmac_f32_16x16x64_bf16 v[24:27], v[48:51], a[160:167], v1
  s_add_u32 s51, s36, 4096
  v_mov_b64 v[14:15], 0
  v_smfmac_f32_16x16x64_bf16 v[24:27], v[52:55], a[168:175], v1
  s_waitcnt lgkmcnt(0)
  s_barrier
  v_smfmac_f32_16x16x64_bf16 v[28:31], v[32:35], a[192:199], v1
  s_nop 2
  v_smfmac_f32_16x16x64_bf16 v[28:31], v[36:39], a[200:207], v1
  s_nop 0
  v_add_f32 v24, v24, v26
  v_smfmac_f32_16x16x64_bf16 v[28:31], v[40:43], a[208:215], v1
  v_add_f32 v25, v25, v27
  v_smfmac_f32_16x16x64_bf16 v[28:31], v[44:47], a[216:223], v1
  v_cvt_pk_bf16_f32 v24, v24, v25
  v_smfmac_f32_16x16x64_bf16 v[28:31], v[48:51], a[224:231], v1
  ds_write_b32 v6, v24 offset:11264
  v_mov_b64 v[16:17], 0
  v_smfmac_f32_16x16x64_bf16 v[28:31], v[52:55], a[232:239], v1
  v_mov_b64 v[18:19], 0
  s_nop 0
  v_smfmac_f32_16x16x64_bf16 v[12:15], v[32:35], v[192:199], v1
  s_nop 2
  v_smfmac_f32_16x16x64_bf16 v[12:15], v[36:39], v[200:207], v1
  s_nop 0
  v_add_f32 v28, v28, v30
  v_add_f32 v29, v29, v31
  v_cvt_pk_bf16_f32 v28, v28, v29
  v_smfmac_f32_16x16x64_bf16 v[12:15], v[40:43], v[208:215], v1
  ds_write_b32 v6, v28 offset:11776
  v_smfmac_f32_16x16x64_bf16 v[12:15], v[44:47], v[216:223], v1
  v_smfmac_f32_16x16x64_bf16 v[12:15], v[48:51], v[224:231], v1
  v_smfmac_f32_16x16x64_bf16 v[12:15], v[52:55], v[232:239], v1
  v_smfmac_f32_16x16x64_bf16 v[12:15], v[56:59], v[240:247], v1
  v_smfmac_f32_16x16x64_bf16 v[12:15], v[60:63], v[248:255], v1
  s_nop 1
  v_smfmac_f32_16x16x64_bf16 v[16:19], v[32:35], v[64:71], v1
  v_mov_b32 v11, s34
  s_nop 1
  v_smfmac_f32_16x16x64_bf16 v[16:19], v[36:39], v[72:79], v1
  s_waitcnt lgkmcnt(0)
  s_barrier
  v_add_f32 v12, v12, v14
  v_smfmac_f32_16x16x64_bf16 v[16:19], v[40:43], v[80:87], v1
  v_add_f32 v13, v13, v15
  v_smfmac_f32_16x16x64_bf16 v[16:19], v[44:47], v[88:95], v1
  v_cvt_pk_bf16_f32 v12, v12, v13
  v_smfmac_f32_16x16x64_bf16 v[16:19], v[48:51], v[96:103], v1
  ds_write_b32 v3, v12 offset:15360
  v_smfmac_f32_16x16x64_bf16 v[16:19], v[52:55], v[104:111], v1
  s_mov_b64 exec, 1
  buffer_store_dword v11, off, s[4:7], s49 sc1
  s_mov_b64 exec, -1
  v_smfmac_f32_16x16x64_bf16 v[16:19], v[56:59], v[112:119], v1
  v_smfmac_f32_16x16x64_bf16 v[16:19], v[60:63], v[120:127], v1
  s_waitcnt vmcnt(8)
  ds_read_b64_tr_b16 v[32:33], v4 offset:8192
  ds_read_b64_tr_b16 v[34:35], v4 offset:8704
  ds_read_b64_tr_b16 v[36:37], v4 offset:9216
  ds_read_b64_tr_b16 v[38:39], v4 offset:9728
  ds_read_b64_tr_b16 v[40:41], v4 offset:10240
  ds_read_b64_tr_b16 v[42:43], v4 offset:10752
  ds_read_b64_tr_b16 v[44:45], v4 offset:11264
  v_add_f32 v16, v16, v18
  v_add_f32 v17, v17, v19
  v_cvt_pk_bf16_f32 v16, v16, v17
  ds_write_b32 v3, v16 offset:15364
  ds_read_b64_tr_b16 v[46:47], v4 offset:11776
  s_add_u32 s42, s45, 4194304
  s_cmp_eq_u32 s34, 63
  s_waitcnt lgkmcnt(0)
  s_barrier
  ds_read_b128 v[16:19], v3 offset:14336
  ds_read_b64 v[20:21], v3 offset:15360
  s_mov_b32 exec_lo, 0x33333333
  s_mov_b32 exec_hi, 0x33333333
  buffer_store_dwordx4 v[32:35], v9, s[4:7], s45 offen offset:0 sc1
  buffer_store_dwordx4 v[36:39], v9, s[4:7], s45 offen offset:512 sc1
  buffer_store_dwordx4 v[40:43], v9, s[4:7], s45 offen offset:1024 sc1
  buffer_store_dwordx4 v[44:47], v9, s[4:7], s45 offen offset:1536 sc1
  s_mov_b64 exec, -1
  s_waitcnt lgkmcnt(0)
  buffer_store_dwordx4 v[16:19], v3, s[4:7], s42 offen sc1
  buffer_store_dwordx2 v[20:21], v4, s[4:7], s42 offen offset:1024 sc1
  s_cbranch_scc1 cs3_exit
  ds_read_b128 v[192:195], v7 offset:16384
  ds_read_b128 v[196:199], v7 offset:17408
  ds_read_b128 v[200:203], v7 offset:18432
  ds_read_b128 v[204:207], v7 offset:19456
  ds_read_b128 v[208:211], v7 offset:20480
  ds_read_b128 v[212:215], v7 offset:21504
  ds_read_b128 v[216:219], v7 offset:22528
  ds_read_b128 v[220:223], v7 offset:23552
  v_lshrrev_b32 v0, 7, v8
  v_lshlrev_b32 v0, 5, v0
  v_add_u32 v0, 8204, v0
  v_mov_b64 v[48:49], 0
  v_mov_b64 v[50:51], 0
  v_mov_b64 v[52:53], 0
  v_mov_b64 v[54:55], 0
  v_mov_b64 v[56:57], 0
  v_mov_b64 v[58:59], 0
  v_mov_b64 v[60:61], 0
  v_mov_b64 v[62:63], 0
  s_barrier
cs3_wo:
  ds_read_b128 v[32:35], v8 offset:12288
  ds_read_b128 v[36:39], v8 offset:12800
  ds_read_b128 v[40:43], v8 offset:13312
  ds_read_b128 v[44:47], v8 offset:13824
  s_waitcnt lgkmcnt(3)
  v_smfmac_f32_16x16x64_bf16 v[48:51], v[32:35], v[128:135], v1 abid:1
  ds_read2_b32 v[28:29], v0 offset0:0 offset1:4
  s_waitcnt lgkmcnt(3)
  v_smfmac_f32_16x16x64_bf16 v[48:51], v[36:39], v[136:143], v1 abid:1
  ds_read_b128 v[224:227], v7 offset:24576
  ds_read_b128 v[228:231], v7 offset:25600
  s_waitcnt lgkmcnt(4)
  v_smfmac_f32_16x16x64_bf16 v[48:51], v[40:43], v[144:151], v1 abid:1
  ds_read_b128 v[232:235], v7 offset:26624
  ds_read_b128 v[236:239], v7 offset:27648
  s_waitcnt lgkmcnt(5)
  v_smfmac_f32_16x16x64_bf16 v[48:51], v[44:47], v[152:159], v1 abid:1
  ds_read_b128 v[240:243], v7 offset:28672
  ds_read_b128 v[244:247], v7 offset:29696
  v_smfmac_f32_16x16x64_bf16 v[52:55], v[32:35], v[160:167], v1 abid:1
  ds_read_b128 v[248:251], v7 offset:30720
  ds_read_b128 v[252:255], v7 offset:31744
  s_nop 0
  v_smfmac_f32_16x16x64_bf16 v[52:55], v[36:39], v[168:175], v1 abid:1
  s_waitcnt lgkmcnt(8)
  v_cmp_gt_f32 vcc, 0, v28
  v_mul_f32 v48, v28, v48
  v_mul_f32 v49, v29, v49
  v_mul_f32 v50, v28, v50
  v_mul_f32 v51, v29, v51
  v_cvt_pk_bf16_f32 v48, v48, v49
  v_cvt_pk_bf16_f32 v49, v50, v51
  v_smfmac_f32_16x16x64_bf16 v[52:55], v[40:43], v[176:183], v1 abid:1
  s_cbranch_vccnz cs3_redo
  buffer_store_dwordx2 v[48:49], v10, s[4:7], s36 offen offset:0 sc1
  v_smfmac_f32_16x16x64_bf16 v[52:55], v[44:47], v[184:191], v1 abid:1
  ds_read_b32 v16, v3 offset:10244
  ds_read_b32 v17, v3 offset:10252
  v_smfmac_f32_16x16x64_bf16 v[56:59], v[32:35], v[192:199], v1 abid:1
  ds_read_b32 v18, v3 offset:11268
  ds_read_b32 v19, v3 offset:11276
  s_nop 0
  v_smfmac_f32_16x16x64_bf16 v[56:59], v[36:39], v[200:207], v1 abid:1
  s_nop 0
  v_mul_f32 v52, v28, v52
  v_mul_f32 v53, v29, v53
  v_mul_f32 v54, v28, v54
  v_mul_f32 v55, v29, v55
  v_cvt_pk_bf16_f32 v52, v52, v53
  v_cvt_pk_bf16_f32 v53, v54, v55
  v_smfmac_f32_16x16x64_bf16 v[56:59], v[40:43], v[208:215], v1 abid:1
  buffer_store_dwordx2 v[52:53], v10, s[4:7], s36 offen offset:2048 sc1
  v_smfmac_f32_16x16x64_bf16 v[56:59], v[44:47], v[216:223], v1 abid:1
  s_nop 1
  s_waitcnt lgkmcnt(4)
  v_smfmac_f32_16x16x64_bf16 v[60:63], v[32:35], v[224:231], v1 abid:1
  s_nop 2
  v_smfmac_f32_16x16x64_bf16 v[60:63], v[36:39], v[232:239], v1 abid:1
  s_nop 0
  v_mul_f32 v56, v28, v56
  v_mul_f32 v57, v29, v57
  v_mul_f32 v58, v28, v58
  v_mul_f32 v59, v29, v59
  v_cvt_pk_bf16_f32 v56, v56, v57
  v_cvt_pk_bf16_f32 v57, v58, v59
  v_smfmac_f32_16x16x64_bf16 v[60:63], v[40:43], v[240:247], v1 abid:1
  buffer_store_dwordx2 v[56:57], v10, s[4:7], s51 offen offset:0 sc1
  v_smfmac_f32_16x16x64_bf16 v[60:63], v[44:47], v[248:255], v1 abid:1
  s_add_u32 s34, s34, 1
  s_and_b32 s41, s34, 3
  s_lshl_b32 s41, s41, 15
  s_add_u32 s35, s41, 84940800
  s_mov_b32 s40, 0
  s_nop 2
  v_mul_f32 v60, v28, v60
  v_mul_f32 v61, v29, v61
  v_mul_f32 v62, v28, v62
  v_mul_f32 v63, v29, v63
  v_cvt_pk_bf16_f32 v60, v60, v61
  v_cvt_pk_bf16_f32 v61, v62, v63
  buffer_store_dwordx2 v[60:61], v10, s[4:7], s51 offen offset:2048 sc1
  ds_read_b128 v[192:195], v7 offset:0
  ds_read_b128 v[196:199], v7 offset:1024
  ds_read_b128 v[200:203], v7 offset:2048
  ds_read_b128 v[204:207], v7 offset:3072
  ds_read_b128 v[208:211], v7 offset:4096
  ds_read_b128 v[212:215], v7 offset:5120
  ds_read_b128 v[216:219], v7 offset:6144
  ds_read_b128 v[220:223], v7 offset:7168
  ds_read_b128 v[224:227], v7 offset:8192
  ds_read_b128 v[228:231], v7 offset:9216
  ds_read_b128 v[232:235], v7 offset:10240
  ds_read_b128 v[236:239], v7 offset:11264
  ds_read_b128 v[240:243], v7 offset:12288
  ds_read_b128 v[244:247], v7 offset:13312
  ds_read_b128 v[248:251], v7 offset:14336
  ds_read_b128 v[252:255], v7 offset:15360
  s_waitcnt vmcnt(0)
  buffer_load_dwordx4 v[32:35], v3, s[4:7], s37 offen offset:0 sc1
  buffer_load_dwordx4 v[36:39], v3, s[4:7], s37 offen offset:1024 sc1
  s_nop 7
  s_nop 7
  s_nop 7
  s_nop 7
  buffer_load_dwordx4 v[32:35], v3, s[4:7], s37 offen offset:0 sc1
  buffer_load_dwordx4 v[36:39], v3, s[4:7], s37 offen offset:1024 sc1
  s_branch cs3_pollA1
cs3_pollA:
  buffer_load_dwordx4 v[32:35], v3, s[4:7], s37 offen offset:0 sc1
  buffer_load_dwordx4 v[36:39], v3, s[4:7], s37 offen offset:1024 sc1
cs3_pollA1:
  s_add_u32 s40, s40, 1
  s_add_u32 s67, s67, 1
  s_mov_b32 s24, 3
  s_cmp_gt_u32 s40, 63
  s_cbranch_scc1 cs3_nanA
cs3_pollA2:
  s_waitcnt vmcnt(3) lgkmcnt(0)
  v_mfma_f32_16x16x32_bf16 v[20:23], v[16:19], v[32:35], 0
  s_waitcnt vmcnt(2) lgkmcnt(0)
  v_mfma_f32_16x16x32_bf16 v[20:23], v[16:19], v[36:39], v[20:23]
  s_nop 7
  v_cmp_class_f32 vcc, v22, s24
  v_add_f32_dpp v20, v20, v20 row_ror:4 row_mask:0xf bank_mask:0xf
  v_add_f32_dpp v21, v21, v21 row_ror:4 row_mask:0xf bank_mask:0xf
  s_nop 0
  v_add_f32_dpp v20, v20, v20 row_ror:8 row_mask:0xf bank_mask:0xf
  v_add_f32_dpp v21, v21, v21 row_ror:8 row_mask:0xf bank_mask:0xf
  v_cvt_pk_bf16_f32 v24, v20, v21
  s_cbranch_vccnz cs3_pollA
cs3_pub:
  buffer_store_dword v24, v2, s[4:7], s38 offen sc1
  s_branch cs3_step
cs3_retryB:
cs3_nanA:
  s_waitcnt vmcnt(0)
  v_max3_u32 v0, v32, v33, v34
  v_max3_u32 v0, v0, v35, v36
  v_max3_u32 v0, v0, v37, v38
  v_max_u32 v0, v0, v39
  v_cmp_eq_u32 vcc, -1, v0
  s_nop 4
  s_cmp_eq_u64 vcc, 0
  s_cselect_b32 s24, 0, 3
  s_cmp_gt_u32 s40, 1048576
  s_cselect_b32 s24, 0, s24
  s_branch cs3_pollA2
cs3_redo:
  s_nop 7
  v_mov_b64 v[48:49], 0
  v_mov_b64 v[50:51], 0
  v_mov_b64 v[52:53], 0
  v_mov_b64 v[54:55], 0
  v_mov_b64 v[56:57], 0
  v_mov_b64 v[58:59], 0
  v_mov_b64 v[60:61], 0
  v_mov_b64 v[62:63], 0
  s_waitcnt lgkmcnt(0)
  s_barrier
  s_barrier
  s_branch cs3_wo
cs3_exit:
  s_waitcnt vmcnt(0)
  s_barrier
  v_mov_b32 v11, 64
  s_mov_b64 exec, 1
  buffer_store_dword v11, off, s[4:7], s49 sc1
  s_endpgm
L_worker:
  s_cmp_lg_u32 s2, 231
  s_cbranch_scc1 L_noinit
  v_lshlrev_b32 v1, 4, v0
  v_mov_b32 v4, 0
  v_mov_b32 v5, 0
  v_mov_b32 v6, 0
  v_mov_b32 v7, 0
  s_mov_b32 s41, 85196800
  buffer_store_dwordx4 v[4:7], v1, s[4:7], s41 offen sc1
  s_add_u32 s41, s41, 4096
  buffer_store_dwordx4 v[4:7], v1, s[4:7], s41 offen sc1
  s_add_u32 s41, s41, 4096
  buffer_store_dwordx4 v[4:7], v1, s[4:7], s41 offen sc1
  s_add_u32 s41, s41, 4096
  buffer_store_dwordx4 v[4:7], v1, s[4:7], s41 offen sc1
  s_add_u32 s41, s41, 4096
  buffer_store_dwordx4 v[4:7], v1, s[4:7], s41 offen sc1
  s_add_u32 s41, s41, 4096
  buffer_store_dwordx4 v[4:7], v1, s[4:7], s41 offen sc1
  s_add_u32 s41, s41, 4096
  buffer_store_dwordx4 v[4:7], v1, s[4:7], s41 offen sc1
  s_add_u32 s41, s41, 4096
  buffer_store_dwordx4 v[4:7], v1, s[4:7], s41 offen sc1
  s_add_u32 s41, s41, 4096
  buffer_store_dwordx4 v[4:7], v1, s[4:7], s41 offen sc1
  s_add_u32 s41, s41, 4096
  s_waitcnt vmcnt(0)
  s_barrier
  v_mov_b32 v4, 1
  v_cmp_eq_u32 vcc, 0, v0
  s_and_saveexec_b64 s[56:57], vcc
  buffer_store_dword v4, off, s[8:11], 0 offset:16 sc1
  s_mov_b64 exec, s[56:57]
L_noinit:
  v_lshrrev_b32 v1, 6, v0
  v_and_b32 v0, 63, v0
  s_nop 0
  v_readfirstlane_b32 s33, v1
  s_sub_u32 s41, s3, 1
  s_lshl_b32 s41, s41, 5
  s_add_u32 s41, s41, s32
  s_lshr_b32 s34, s41, 1
  s_and_b32 s35, s41, 1
  s_lshl_b32 s44, s41, 6
  s_add_u32 s44, s44, 85200896
  s_cmp_ge_u32 s34, 110
  s_cbranch_scc1 p1_gate
  s_lshr_b32 s47, s34, 5
  s_and_b32 s42, s34, 31
  s_mov_b32 s16, s64
  s_and_b32 s17, s65, 0xffff
  s_mov_b32 s18, 0x200000
  s_mov_b32 s19, 0x00020000
  s_mov_b32 s12, s70
  s_mov_b32 s13, s71
  s_cmp_eq_u32 s47, 1
  s_cselect_b32 s12, s72, s12
  s_cselect_b32 s13, s73, s13
  s_cmp_eq_u32 s47, 2
  s_cselect_b32 s12, s68, s12
  s_cselect_b32 s13, s69, s13
  s_cmp_eq_u32 s47, 3
  s_cselect_b32 s12, s80, s12
  s_cselect_b32 s13, s81, s13
  s_mov_b32 s14, 0x400000
  s_mov_b32 s36, 8192
  s_cselect_b32 s14, 1835008, s14
  s_cselect_b32 s36, 3584, s36
  s_and_b32 s13, s13, 0xffff
  s_mov_b32 s15, 0x00020000
  v_lshrrev_b32 v1, 4, v0
  v_bfe_u32 v2, v0, 1, 3
  v_and_b32 v3, 1, v0
  v_xor_b32 v2, v2, v1
  v_lshlrev_b32 v2, 5, v2
  v_lshl_add_u32 v2, v3, 4, v2
  v_mul_lo_u32 v1, v1, s36
  s_lshl_b32 s41, s42, 8
  v_add3_u32 v1, v1, v2, s41
  v_xor_b32 v2, 128, v2
  v_lshrrev_b32 v3, 4, v0
  v_mul_lo_u32 v3, v3, s36
  v_add3_u32 v2, v3, v2, s41
  s_lshl_b32 s50, s36, 2
  s_mul_i32 s41, s33, s50
  s_lshl_b32 s41, s41, 5
  s_lshl_b32 s51, s33, 15
  s_add_u32 m0, s51, 0
  s_nop 0
  buffer_load_dwordx4 v1, s[12:15], s41 offen lds
  s_add_u32 s41, s41, s50
  s_add_u32 m0, s51, 1024
  s_nop 0
  buffer_load_dwordx4 v1, s[12:15], s41 offen lds
  s_add_u32 s41, s41, s50
  s_add_u32 m0, s51, 2048
  s_nop 0
  buffer_load_dwordx4 v2, s[12:15], s41 offen lds
  s_add_u32 s41, s41, s50
  s_add_u32 m0, s51, 3072
  s_nop 0
  buffer_load_dwordx4 v2, s[12:15], s41 offen lds
  s_add_u32 s41, s41, s50
  s_add_u32 m0, s51, 4096
  s_nop 0
  buffer_load_dwordx4 v1, s[12:15], s41 offen lds
  s_add_u32 s41, s41, s50
  s_add_u32 m0, s51, 5120
  s_nop 0
  buffer_load_dwordx4 v1, s[12:15], s41 offen lds
  s_add_u32 s41, s41, s50
  s_add_u32 m0, s51, 6144
  s_nop 0
  buffer_load_dwordx4 v2, s[12:15], s41 offen lds
  s_add_u32 s41, s41, s50
  s_add_u32 m0, s51, 7168
  s_nop 0
  buffer_load_dwordx4 v2, s[12:15], s41 offen lds
  s_add_u32 s41, s41, s50
  s_add_u32 m0, s51, 8192
  s_nop 0
  buffer_load_dwordx4 v1, s[12:15], s41 offen lds
  s_add_u32 s41, s41, s50
  s_add_u32 m0, s51, 9216
  s_nop 0
  buffer_load_dwordx4 v1, s[12:15], s41 offen lds
  s_add_u32 s41, s41, s50
  s_add_u32 m0, s51, 10240
  s_nop 0
  buffer_load_dwordx4 v2, s[12:15], s41 offen lds
  s_add_u32 s41, s41, s50
  s_add_u32 m0, s51, 11264
  s_nop 0
  buffer_load_dwordx4 v2, s[12:15], s41 offen lds
  s_add_u32 s41, s41, s50
  s_add_u32 m0, s51, 12288
  s_nop 0
  buffer_load_dwordx4 v1, s[12:15], s41 offen lds
  s_add_u32 s41, s41, s50
  s_add_u32 m0, s51, 13312
  s_nop 0
  buffer_load_dwordx4 v1, s[12:15], s41 offen lds
  s_add_u32 s41, s41, s50
  s_add_u32 m0, s51, 14336
  s_nop 0
  buffer_load_dwordx4 v2, s[12:15], s41 offen lds
  s_add_u32 s41, s41, s50
  s_add_u32 m0, s51, 15360
  s_nop 0
  buffer_load_dwordx4 v2, s[12:15], s41 offen lds
  s_add_u32 s41, s41, s50
  s_add_u32 m0, s51, 16384
  s_nop 0
  buffer_load_dwordx4 v1, s[12:15], s41 offen lds
  s_add_u32 s41, s41, s50
  s_add_u32 m0, s51, 17408
  s_nop 0
  buffer_load_dwordx4 v1, s[12:15], s41 offen lds
  s_add_u32 s41, s41, s50
  s_add_u32 m0, s51, 18432
  s_nop 0
  buffer_load_dwordx4 v2, s[12:15], s41 offen lds
  s_add_u32 s41, s41, s50
  s_add_u32 m0, s51, 19456
  s_nop 0
  buffer_load_dwordx4 v2, s[12:15], s41 offen lds
  s_add_u32 s41, s41, s50
  s_add_u32 m0, s51, 20480
  s_nop 0
  buffer_load_dwordx4 v1, s[12:15], s41 offen lds
  s_add_u32 s41, s41, s50
  s_add_u32 m0, s51, 21504
  s_nop 0
  buffer_load_dwordx4 v1, s[12:15], s41 offen lds
  s_add_u32 s41, s41, s50
  s_add_u32 m0, s51, 22528
  s_nop 0
  buffer_load_dwordx4 v2, s[12:15], s41 offen lds
  s_add_u32 s41, s41, s50
  s_add_u32 m0, s51, 23552
  s_nop 0
  buffer_load_dwordx4 v2, s[12:15], s41 offen lds
  s_add_u32 s41, s41, s50
  s_add_u32 m0, s51, 24576
  s_nop 0
  buffer_load_dwordx4 v1, s[12:15], s41 offen lds
  s_add_u32 s41, s41, s50
  s_add_u32 m0, s51, 25600
  s_nop 0
  buffer_load_dwordx4 v1, s[12:15], s41 offen lds
  s_add_u32 s41, s41, s50
  s_add_u32 m0, s51, 26624
  s_nop 0
  buffer_load_dwordx4 v2, s[12:15], s41 offen lds
  s_add_u32 s41, s41, s50
  s_add_u32 m0, s51, 27648
  s_nop 0
  buffer_load_dwordx4 v2, s[12:15], s41 offen lds
  s_add_u32 s41, s41, s50
  s_add_u32 m0, s51, 28672
  s_nop 0
  buffer_load_dwordx4 v1, s[12:15], s41 offen lds
  s_add_u32 s41, s41, s50
  s_add_u32 m0, s51, 29696
  s_nop 0
  buffer_load_dwordx4 v1, s[12:15], s41 offen lds
  s_add_u32 s41, s41, s50
  s_add_u32 m0, s51, 30720
  s_nop 0
  buffer_load_dwordx4 v2, s[12:15], s41 offen lds
  s_add_u32 s41, s41, s50
  s_add_u32 m0, s51, 31744
  s_nop 0
  buffer_load_dwordx4 v2, s[12:15], s41 offen lds
  s_add_u32 s41, s41, s50
  v_lshrrev_b32 v4, 4, v0
  v_bfe_u32 v5, v0, 2, 2
  v_and_b32 v6, 3, v0
  v_and_b32 v7, 1, v4
  v_lshl_add_u32 v7, v7, 2, v5
  v_lshl_add_u32 v8, v4, 3, v5
  v_lshlrev_b32 v8, 8, v8
  v_lshl_add_u32 v8, v6, 3, v8
  s_and_b32 s41, s33, 1
  s_lshl_b32 s41, s41, 2
  s_add_u32 s50, s41, 0
  v_xor_b32 v9, s50, v7
  v_lshl_add_u32 v10, v9, 5, v8
  s_add_u32 s50, s41, 1
  v_xor_b32 v9, s50, v7
  v_lshl_add_u32 v11, v9, 5, v8
  s_add_u32 s50, s41, 2
  v_xor_b32 v9, s50, v7
  v_lshl_add_u32 v12, v9, 5, v8
  s_add_u32 s50, s41, 3
  v_xor_b32 v9, s50, v7
  v_lshl_add_u32 v13, v9, 5, v8
  v_lshlrev_b32 v14, 4, v0
  v_and_b32 v15, 15, v0
  s_lshr_b32 s50, s33, 1
  s_lshl_b32 s50, s50, 15
  v_lshlrev_b32 v16, 10, v15
  v_add_u32 v16, s50, v16
  v_xor_b32 v17, v4, v15
  v_lshl_add_u32 v16, v17, 4, v16
  v_xor_b32 v17, 64, v16
  v_xor_b32 v18, 128, v16
  v_xor_b32 v19, 192, v16
  s_lshl_b32 s50, s35, 1
  s_lshr_b32 s51, s33, 1
  s_add_u32 s50, s50, s51
  s_and_b32 s51, s33, 1
  s_cmp_eq_u32 s47, 3
  s_cbranch_scc1 p1_addr_h
  s_lshl_b32 s38, s50, 18
  s_lshl_b32 s41, s42, 13
  s_add_u32 s38, s38, s41
  s_mov_b32 s48, 1048576
  s_mov_b32 s39, 4096
  s_lshl_b32 s41, s51, 11
  s_lshl_b32 s51, s51, 12
  s_cmp_eq_u32 s47, 1
  s_cselect_b32 s41, s51, s41
  s_cselect_b32 s39, 2048, s39
  s_mov_b32 s51, 16777216
  s_cselect_b32 s51, 33554432, s51
  s_cmp_eq_u32 s47, 2
  s_cselect_b32 s51, 0, s51
  s_add_u32 s38, s38, s41
  s_add_u32 s38, s38, s51
  v_mov_b32 v32, 0
  v_mov_b32 v33, 0
  v_mov_b32 v34, 0
  v_mov_b32 v35, 0
  v_mov_b32 v36, 0
  v_mov_b32 v37, 0
  v_mov_b32 v38, 0
  v_mov_b32 v39, 0
  v_mov_b32 v40, 0
  v_mov_b32 v41, 0
  v_mov_b32 v42, 0
  v_mov_b32 v43, 0
  v_mov_b32 v44, 0
  v_mov_b32 v45, 0
  v_mov_b32 v46, 0
  v_mov_b32 v47, 0
  s_branch p1_addr_d
p1_addr_h:
  s_mov_b32 s20, s82
  s_and_b32 s21, s83, 0xffff
  s_mov_b32 s22, 0xe00
  s_mov_b32 s23, 0x00020000
  s_mul_i32 s38, s50, 114688
  s_lshl_b32 s41, s42, 12
  s_add_u32 s38, s38, s41
  s_lshl_b32 s41, s51, 11
  s_add_u32 s38, s38, s41
  s_add_u32 s38, s38, 67108864
  s_mov_b32 s48, 458752
  s_mov_b32 s39, 57344
  s_lshl_b32 s41, s42, 8
  s_lshl_b32 s51, s51, 7
  s_add_u32 s41, s41, s51
  v_lshlrev_b32 v9, 3, v4
  buffer_load_dwordx2 v[48:49], v9, s[20:23], s41 offen offset:0
  buffer_load_dwordx2 v[50:51], v9, s[20:23], s41 offen offset:32
  buffer_load_dwordx2 v[52:53], v9, s[20:23], s41 offen offset:64
  buffer_load_dwordx2 v[54:55], v9, s[20:23], s41 offen offset:96
  s_waitcnt vmcnt(0)
  v_lshlrev_b32 v32, 16, v48
  v_and_b32 v33, 0xffff0000, v48
  v_lshlrev_b32 v34, 16, v49
  v_and_b32 v35, 0xffff0000, v49
  v_lshlrev_b32 v36, 16, v50
  v_and_b32 v37, 0xffff0000, v50
  v_lshlrev_b32 v38, 16, v51
  v_and_b32 v39, 0xffff0000, v51
  v_lshlrev_b32 v40, 16, v52
  v_and_b32 v41, 0xffff0000, v52
  v_lshlrev_b32 v42, 16, v53
  v_and_b32 v43, 0xffff0000, v53
  v_lshlrev_b32 v44, 16, v54
  v_and_b32 v45, 0xffff0000, v54
  v_lshlrev_b32 v46, 16, v55
  v_and_b32 v47, 0xffff0000, v55
p1_addr_d:
  s_mov_b32 s40, 0
L_rdy_4:
  buffer_load_dword v9, off, s[8:11], 0 offset:16 sc1
  s_add_u32 s40, s40, 1
  s_waitcnt vmcnt(0)
  v_readfirstlane_b32 s41, v9
  s_cmp_gt_u32 s40, 1048576
  s_cbranch_scc1 L_rdy_4_d
  s_cmp_eq_u32 s41, 0
  s_cbranch_scc1 L_rdy_4
L_rdy_4_d:
  s_waitcnt vmcnt(0)
  s_barrier
  ds_read_b64_tr_b16 a[0:1], v10 offset:0
  ds_read_b64_tr_b16 a[2:3], v10 offset:1024
  ds_read_b64_tr_b16 a[64:65], v11 offset:0
  ds_read_b64_tr_b16 a[66:67], v11 offset:1024
  ds_read_b64_tr_b16 a[128:129], v12 offset:0
  ds_read_b64_tr_b16 a[130:131], v12 offset:1024
  ds_read_b64_tr_b16 a[192:193], v13 offset:0
  ds_read_b64_tr_b16 a[194:195], v13 offset:1024
  ds_read_b64_tr_b16 a[4:5], v10 offset:8192
  ds_read_b64_tr_b16 a[6:7], v10 offset:9216
  ds_read_b64_tr_b16 a[68:69], v11 offset:8192
  ds_read_b64_tr_b16 a[70:71], v11 offset:9216
  ds_read_b64_tr_b16 a[132:133], v12 offset:8192
  ds_read_b64_tr_b16 a[134:135], v12 offset:9216
  ds_read_b64_tr_b16 a[196:197], v13 offset:8192
  ds_read_b64_tr_b16 a[198:199], v13 offset:9216
  ds_read_b64_tr_b16 a[8:9], v10 offset:16384
  ds_read_b64_tr_b16 a[10:11], v10 offset:17408
  ds_read_b64_tr_b16 a[72:73], v11 offset:16384
  ds_read_b64_tr_b16 a[74:75], v11 offset:17408
  ds_read_b64_tr_b16 a[136:137], v12 offset:16384
  ds_read_b64_tr_b16 a[138:139], v12 offset:17408
  ds_read_b64_tr_b16 a[200:201], v13 offset:16384
  ds_read_b64_tr_b16 a[202:203], v13 offset:17408
  ds_read_b64_tr_b16 a[12:13], v10 offset:24576
  ds_read_b64_tr_b16 a[14:15], v10 offset:25600
  ds_read_b64_tr_b16 a[76:77], v11 offset:24576
  ds_read_b64_tr_b16 a[78:79], v11 offset:25600
  ds_read_b64_tr_b16 a[140:141], v12 offset:24576
  ds_read_b64_tr_b16 a[142:143], v12 offset:25600
  ds_read_b64_tr_b16 a[204:205], v13 offset:24576
  ds_read_b64_tr_b16 a[206:207], v13 offset:25600
  ds_read_b64_tr_b16 a[16:17], v10 offset:32768
  ds_read_b64_tr_b16 a[18:19], v10 offset:33792
  ds_read_b64_tr_b16 a[80:81], v11 offset:32768
  ds_read_b64_tr_b16 a[82:83], v11 offset:33792
  ds_read_b64_tr_b16 a[144:145], v12 offset:32768
  ds_read_b64_tr_b16 a[146:147], v12 offset:33792
  ds_read_b64_tr_b16 a[208:209], v13 offset:32768
  ds_read_b64_tr_b16 a[210:211], v13 offset:33792
  ds_read_b64_tr_b16 a[20:21], v10 offset:40960
  ds_read_b64_tr_b16 a[22:23], v10 offset:41984
  ds_read_b64_tr_b16 a[84:85], v11 offset:40960
  ds_read_b64_tr_b16 a[86:87], v11 offset:41984
  ds_read_b64_tr_b16 a[148:149], v12 offset:40960
  ds_read_b64_tr_b16 a[150:151], v12 offset:41984
  ds_read_b64_tr_b16 a[212:213], v13 offset:40960
  ds_read_b64_tr_b16 a[214:215], v13 offset:41984
  ds_read_b64_tr_b16 a[24:25], v10 offset:49152
  ds_read_b64_tr_b16 a[26:27], v10 offset:50176
  ds_read_b64_tr_b16 a[88:89], v11 offset:49152
  ds_read_b64_tr_b16 a[90:91], v11 offset:50176
  ds_read_b64_tr_b16 a[152:153], v12 offset:49152
  ds_read_b64_tr_b16 a[154:155], v12 offset:50176
  ds_read_b64_tr_b16 a[216:217], v13 offset:49152
  ds_read_b64_tr_b16 a[218:219], v13 offset:50176
  ds_read_b64_tr_b16 a[28:29], v10 offset:57344
  ds_read_b64_tr_b16 a[30:31], v10 offset:58368
  ds_read_b64_tr_b16 a[92:93], v11 offset:57344
  ds_read_b64_tr_b16 a[94:95], v11 offset:58368
  ds_read_b64_tr_b16 a[156:157], v12 offset:57344
  ds_read_b64_tr_b16 a[158:159], v12 offset:58368
  ds_read_b64_tr_b16 a[220:221], v13 offset:57344
  ds_read_b64_tr_b16 a[222:223], v13 offset:58368
  v_add_u32 v10, 65536, v10
  v_add_u32 v11, 65536, v11
  v_add_u32 v12, 65536, v12
  v_add_u32 v13, 65536, v13
  ds_read_b64_tr_b16 a[32:33], v10 offset:0
  ds_read_b64_tr_b16 a[34:35], v10 offset:1024
  ds_read_b64_tr_b16 a[96:97], v11 offset:0
  ds_read_b64_tr_b16 a[98:99], v11 offset:1024
  ds_read_b64_tr_b16 a[160:161], v12 offset:0
  ds_read_b64_tr_b16 a[162:163], v12 offset:1024
  ds_read_b64_tr_b16 a[224:225], v13 offset:0
  ds_read_b64_tr_b16 a[226:227], v13 offset:1024
  ds_read_b64_tr_b16 a[36:37], v10 offset:8192
  ds_read_b64_tr_b16 a[38:39], v10 offset:9216
  ds_read_b64_tr_b16 a[100:101], v11 offset:8192
  ds_read_b64_tr_b16 a[102:103], v11 offset:9216
  ds_read_b64_tr_b16 a[164:165], v12 offset:8192
  ds_read_b64_tr_b16 a[166:167], v12 offset:9216
  ds_read_b64_tr_b16 a[228:229], v13 offset:8192
  ds_read_b64_tr_b16 a[230:231], v13 offset:9216
  ds_read_b64_tr_b16 a[40:41], v10 offset:16384
  ds_read_b64_tr_b16 a[42:43], v10 offset:17408
  ds_read_b64_tr_b16 a[104:105], v11 offset:16384
  ds_read_b64_tr_b16 a[106:107], v11 offset:17408
  ds_read_b64_tr_b16 a[168:169], v12 offset:16384
  ds_read_b64_tr_b16 a[170:171], v12 offset:17408
  ds_read_b64_tr_b16 a[232:233], v13 offset:16384
  ds_read_b64_tr_b16 a[234:235], v13 offset:17408
  ds_read_b64_tr_b16 a[44:45], v10 offset:24576
  ds_read_b64_tr_b16 a[46:47], v10 offset:25600
  ds_read_b64_tr_b16 a[108:109], v11 offset:24576
  ds_read_b64_tr_b16 a[110:111], v11 offset:25600
  ds_read_b64_tr_b16 a[172:173], v12 offset:24576
  ds_read_b64_tr_b16 a[174:175], v12 offset:25600
  ds_read_b64_tr_b16 a[236:237], v13 offset:24576
  ds_read_b64_tr_b16 a[238:239], v13 offset:25600
  ds_read_b64_tr_b16 a[48:49], v10 offset:32768
  ds_read_b64_tr_b16 a[50:51], v10 offset:33792
  ds_read_b64_tr_b16 a[112:113], v11 offset:32768
  ds_read_b64_tr_b16 a[114:115], v11 offset:33792
  ds_read_b64_tr_b16 a[176:177], v12 offset:32768
  ds_read_b64_tr_b16 a[178:179], v12 offset:33792
  ds_read_b64_tr_b16 a[240:241], v13 offset:32768
  ds_read_b64_tr_b16 a[242:243], v13 offset:33792
  ds_read_b64_tr_b16 a[52:53], v10 offset:40960
  ds_read_b64_tr_b16 a[54:55], v10 offset:41984
  ds_read_b64_tr_b16 a[116:117], v11 offset:40960
  ds_read_b64_tr_b16 a[118:119], v11 offset:41984
  ds_read_b64_tr_b16 a[180:181], v12 offset:40960
  ds_read_b64_tr_b16 a[182:183], v12 offset:41984
  ds_read_b64_tr_b16 a[244:245], v13 offset:40960
  ds_read_b64_tr_b16 a[246:247], v13 offset:41984
  ds_read_b64_tr_b16 a[56:57], v10 offset:49152
  ds_read_b64_tr_b16 a[58:59], v10 offset:50176
  ds_read_b64_tr_b16 a[120:121], v11 offset:49152
  ds_read_b64_tr_b16 a[122:123], v11 offset:50176
  ds_read_b64_tr_b16 a[184:185], v12 offset:49152
  ds_read_b64_tr_b16 a[186:187], v12 offset:50176
  ds_read_b64_tr_b16 a[248:249], v13 offset:49152
  ds_read_b64_tr_b16 a[250:251], v13 offset:50176
  ds_read_b64_tr_b16 a[60:61], v10 offset:57344
  ds_read_b64_tr_b16 a[62:63], v10 offset:58368
  ds_read_b64_tr_b16 a[124:125], v11 offset:57344
  ds_read_b64_tr_b16 a[126:127], v11 offset:58368
  ds_read_b64_tr_b16 a[188:189], v12 offset:57344
  ds_read_b64_tr_b16 a[190:191], v12 offset:58368
  ds_read_b64_tr_b16 a[252:253], v13 offset:57344
  ds_read_b64_tr_b16 a[254:255], v13 offset:58368
  s_waitcnt lgkmcnt(0)
  s_barrier
  s_lshl_b32 s37, s35, 16
  s_lshl_b32 s45, s33, 14
  s_add_u32 s37, s37, s45
  s_mov_b32 s46, 0
  s_add_u32 m0, s45, 0
  v_xor_b32 v9, 0, v14
  buffer_load_dwordx4 v9, s[16:19], s37 offen lds
  s_add_u32 s37, s37, 1024
  s_add_u32 m0, s45, 1024
  v_xor_b32 v9, 16, v14
  buffer_load_dwordx4 v9, s[16:19], s37 offen lds
  s_add_u32 s37, s37, 1024
  s_add_u32 m0, s45, 2048
  v_xor_b32 v9, 32, v14
  buffer_load_dwordx4 v9, s[16:19], s37 offen lds
  s_add_u32 s37, s37, 1024
  s_add_u32 m0, s45, 3072
  v_xor_b32 v9, 48, v14
  buffer_load_dwordx4 v9, s[16:19], s37 offen lds
  s_add_u32 s37, s37, 1024
  s_add_u32 m0, s45, 4096
  v_xor_b32 v9, 64, v14
  buffer_load_dwordx4 v9, s[16:19], s37 offen lds
  s_add_u32 s37, s37, 1024
  s_add_u32 m0, s45, 5120
  v_xor_b32 v9, 80, v14
  buffer_load_dwordx4 v9, s[16:19], s37 offen lds
  s_add_u32 s37, s37, 1024
  s_add_u32 m0, s45, 6144
  v_xor_b32 v9, 96, v14
  buffer_load_dwordx4 v9, s[16:19], s37 offen lds
  s_add_u32 s37, s37, 1024
  s_add_u32 m0, s45, 7168
  v_xor_b32 v9, 112, v14
  buffer_load_dwordx4 v9, s[16:19], s37 offen lds
  s_add_u32 s37, s37, 1024
  s_add_u32 m0, s45, 8192
  v_xor_b32 v9, 128, v14
  buffer_load_dwordx4 v9, s[16:19], s37 offen lds
  s_add_u32 s37, s37, 1024
  s_add_u32 m0, s45, 9216
  v_xor_b32 v9, 144, v14
  buffer_load_dwordx4 v9, s[16:19], s37 offen lds
  s_add_u32 s37, s37, 1024
  s_add_u32 m0, s45, 10240
  v_xor_b32 v9, 160, v14
  buffer_load_dwordx4 v9, s[16:19], s37 offen lds
  s_add_u32 s37, s37, 1024
  s_add_u32 m0, s45, 11264
  v_xor_b32 v9, 176, v14
  buffer_load_dwordx4 v9, s[16:19], s37 offen lds
  s_add_u32 s37, s37, 1024
  s_add_u32 m0, s45, 12288
  v_xor_b32 v9, 192, v14
  buffer_load_dwordx4 v9, s[16:19], s37 offen lds
  s_add_u32 s37, s37, 1024
  s_add_u32 m0, s45, 13312
  v_xor_b32 v9, 208, v14
  buffer_load_dwordx4 v9, s[16:19], s37 offen lds
  s_add_u32 s37, s37, 1024
  s_add_u32 m0, s45, 14336
  v_xor_b32 v9, 224, v14
  buffer_load_dwordx4 v9, s[16:19], s37 offen lds
  s_add_u32 s37, s37, 1024
  s_add_u32 m0, s45, 15360
  v_xor_b32 v9, 240, v14
  buffer_load_dwordx4 v9, s[16:19], s37 offen lds
  s_add_u32 s37, s37, 1024
  s_waitcnt vmcnt(0)
  s_cmp_eq_u32 s47, 1
  s_cbranch_scc1 p1_loop_v
p1_loop_t:
  s_waitcnt vmcnt(4)
  s_barrier
  s_add_u32 s37, s37, 114688
  s_xor_b32 s45, s45, 65536
  s_cmp_lt_u32 s46, 2
  s_cbranch_scc1 p1_nf_5
  s_cmp_lg_u32 s33, 0
  s_cbranch_scc1 p1_nf_5
  s_sub_u32 s41, s46, 1
  v_mov_b32 v9, s41
  s_mov_b64 exec, 1
  buffer_store_dword v9, off, s[4:7], s44 sc1
  s_mov_b64 exec, -1
p1_nf_5:
  ds_read_b128 v[48:51], v16 offset:0
  ds_read_b128 v[52:55], v16 offset:16384
  ds_read_b128 v[56:59], v17 offset:0
  ds_read_b128 v[60:63], v17 offset:16384
  s_waitcnt lgkmcnt(2)
  v_mfma_f32_16x16x32_bf16 v[64:67], a[0:3], v[48:51], v[32:35]
  v_mfma_f32_16x16x32_bf16 v[68:71], a[64:67], v[48:51], v[36:39]
  s_add_u32 m0, s45, 0
  v_xor_b32 v9, 0, v14
  v_mfma_f32_16x16x32_bf16 v[72:75], a[128:131], v[48:51], v[40:43]
  v_mfma_f32_16x16x32_bf16 v[76:79], a[192:195], v[48:51], v[44:47]
  buffer_load_dwordx4 v9, s[16:19], s37 offen lds
  s_add_u32 s37, s37, 1024
  v_mfma_f32_16x16x32_bf16 v[80:83], a[0:3], v[52:55], v[32:35]
  v_mfma_f32_16x16x32_bf16 v[84:87], a[64:67], v[52:55], v[36:39]
  v_mfma_f32_16x16x32_bf16 v[88:91], a[128:131], v[52:55], v[40:43]
  v_mfma_f32_16x16x32_bf16 v[92:95], a[192:195], v[52:55], v[44:47]
  ds_read_b128 v[48:51], v18 offset:0
  ds_read_b128 v[52:55], v18 offset:16384
  s_waitcnt lgkmcnt(2)
  v_mfma_f32_16x16x32_bf16 v[64:67], a[4:7], v[56:59], v[64:67]
  v_mfma_f32_16x16x32_bf16 v[68:71], a[68:71], v[56:59], v[68:71]
  s_add_u32 m0, s45, 1024
  v_xor_b32 v9, 16, v14
  v_mfma_f32_16x16x32_bf16 v[72:75], a[132:135], v[56:59], v[72:75]
  v_mfma_f32_16x16x32_bf16 v[76:79], a[196:199], v[56:59], v[76:79]
  buffer_load_dwordx4 v9, s[16:19], s37 offen lds
  s_add_u32 s37, s37, 1024
  v_mfma_f32_16x16x32_bf16 v[80:83], a[4:7], v[60:63], v[80:83]
  v_mfma_f32_16x16x32_bf16 v[84:87], a[68:71], v[60:63], v[84:87]
  v_mfma_f32_16x16x32_bf16 v[88:91], a[132:135], v[60:63], v[88:91]
  v_mfma_f32_16x16x32_bf16 v[92:95], a[196:199], v[60:63], v[92:95]
  ds_read_b128 v[56:59], v19 offset:0
  ds_read_b128 v[60:63], v19 offset:16384
  s_waitcnt lgkmcnt(2)
  v_mfma_f32_16x16x32_bf16 v[64:67], a[8:11], v[48:51], v[64:67]
  v_mfma_f32_16x16x32_bf16 v[68:71], a[72:75], v[48:51], v[68:71]
  s_add_u32 m0, s45, 2048
  v_xor_b32 v9, 32, v14
  v_mfma_f32_16x16x32_bf16 v[72:75], a[136:139], v[48:51], v[72:75]
  v_mfma_f32_16x16x32_bf16 v[76:79], a[200:203], v[48:51], v[76:79]
  buffer_load_dwordx4 v9, s[16:19], s37 offen lds
  s_add_u32 s37, s37, 1024
  v_mfma_f32_16x16x32_bf16 v[80:83], a[8:11], v[52:55], v[80:83]
  v_mfma_f32_16x16x32_bf16 v[84:87], a[72:75], v[52:55], v[84:87]
  v_mfma_f32_16x16x32_bf16 v[88:91], a[136:139], v[52:55], v[88:91]
  v_mfma_f32_16x16x32_bf16 v[92:95], a[200:203], v[52:55], v[92:95]
  ds_read_b128 v[48:51], v16 offset:256
  ds_read_b128 v[52:55], v16 offset:16640
  s_waitcnt lgkmcnt(2)
  v_mfma_f32_16x16x32_bf16 v[64:67], a[12:15], v[56:59], v[64:67]
  v_mfma_f32_16x16x32_bf16 v[68:71], a[76:79], v[56:59], v[68:71]
  s_add_u32 m0, s45, 3072
  v_xor_b32 v9, 48, v14
  v_mfma_f32_16x16x32_bf16 v[72:75], a[140:143], v[56:59], v[72:75]
  v_mfma_f32_16x16x32_bf16 v[76:79], a[204:207], v[56:59], v[76:79]
  buffer_load_dwordx4 v9, s[16:19], s37 offen lds
  s_add_u32 s37, s37, 1024
  v_mfma_f32_16x16x32_bf16 v[80:83], a[12:15], v[60:63], v[80:83]
  v_mfma_f32_16x16x32_bf16 v[84:87], a[76:79], v[60:63], v[84:87]
  v_mfma_f32_16x16x32_bf16 v[88:91], a[140:143], v[60:63], v[88:91]
  v_mfma_f32_16x16x32_bf16 v[92:95], a[204:207], v[60:63], v[92:95]
  ds_read_b128 v[56:59], v17 offset:256
  ds_read_b128 v[60:63], v17 offset:16640
  s_waitcnt lgkmcnt(2)
  v_mfma_f32_16x16x32_bf16 v[64:67], a[16:19], v[48:51], v[64:67]
  v_mfma_f32_16x16x32_bf16 v[68:71], a[80:83], v[48:51], v[68:71]
  s_add_u32 m0, s45, 4096
  v_xor_b32 v9, 64, v14
  v_mfma_f32_16x16x32_bf16 v[72:75], a[144:147], v[48:51], v[72:75]
  v_mfma_f32_16x16x32_bf16 v[76:79], a[208:211], v[48:51], v[76:79]
  buffer_load_dwordx4 v9, s[16:19], s37 offen lds
  s_add_u32 s37, s37, 1024
  v_mfma_f32_16x16x32_bf16 v[80:83], a[16:19], v[52:55], v[80:83]
  v_mfma_f32_16x16x32_bf16 v[84:87], a[80:83], v[52:55], v[84:87]
  v_mfma_f32_16x16x32_bf16 v[88:91], a[144:147], v[52:55], v[88:91]
  v_mfma_f32_16x16x32_bf16 v[92:95], a[208:211], v[52:55], v[92:95]
  ds_read_b128 v[48:51], v18 offset:256
  ds_read_b128 v[52:55], v18 offset:16640
  s_waitcnt lgkmcnt(2)
  v_mfma_f32_16x16x32_bf16 v[64:67], a[20:23], v[56:59], v[64:67]
  v_mfma_f32_16x16x32_bf16 v[68:71], a[84:87], v[56:59], v[68:71]
  s_add_u32 m0, s45, 5120
  v_xor_b32 v9, 80, v14
  v_mfma_f32_16x16x32_bf16 v[72:75], a[148:151], v[56:59], v[72:75]
  v_mfma_f32_16x16x32_bf16 v[76:79], a[212:215], v[56:59], v[76:79]
  buffer_load_dwordx4 v9, s[16:19], s37 offen lds
  s_add_u32 s37, s37, 1024
  v_mfma_f32_16x16x32_bf16 v[80:83], a[20:23], v[60:63], v[80:83]
  v_mfma_f32_16x16x32_bf16 v[84:87], a[84:87], v[60:63], v[84:87]
  v_mfma_f32_16x16x32_bf16 v[88:91], a[148:151], v[60:63], v[88:91]
  v_mfma_f32_16x16x32_bf16 v[92:95], a[212:215], v[60:63], v[92:95]
  ds_read_b128 v[56:59], v19 offset:256
  ds_read_b128 v[60:63], v19 offset:16640
  s_waitcnt lgkmcnt(2)
  v_mfma_f32_16x16x32_bf16 v[64:67], a[24:27], v[48:51], v[64:67]
  v_mfma_f32_16x16x32_bf16 v[68:71], a[88:91], v[48:51], v[68:71]
  s_add_u32 m0, s45, 6144
  v_xor_b32 v9, 96, v14
  v_mfma_f32_16x16x32_bf16 v[72:75], a[152:155], v[48:51], v[72:75]
  v_mfma_f32_16x16x32_bf16 v[76:79], a[216:219], v[48:51], v[76:79]
  buffer_load_dwordx4 v9, s[16:19], s37 offen lds
  s_add_u32 s37, s37, 1024
  v_mfma_f32_16x16x32_bf16 v[80:83], a[24:27], v[52:55], v[80:83]
  v_mfma_f32_16x16x32_bf16 v[84:87], a[88:91], v[52:55], v[84:87]
  v_mfma_f32_16x16x32_bf16 v[88:91], a[152:155], v[52:55], v[88:91]
  v_mfma_f32_16x16x32_bf16 v[92:95], a[216:219], v[52:55], v[92:95]
  ds_read_b128 v[48:51], v16 offset:512
  ds_read_b128 v[52:55], v16 offset:16896
  s_waitcnt lgkmcnt(2)
  v_mfma_f32_16x16x32_bf16 v[64:67], a[28:31], v[56:59], v[64:67]
  v_mfma_f32_16x16x32_bf16 v[68:71], a[92:95], v[56:59], v[68:71]
  s_add_u32 m0, s45, 7168
  v_xor_b32 v9, 112, v14
  v_mfma_f32_16x16x32_bf16 v[72:75], a[156:159], v[56:59], v[72:75]
  v_mfma_f32_16x16x32_bf16 v[76:79], a[220:223], v[56:59], v[76:79]
  buffer_load_dwordx4 v9, s[16:19], s37 offen lds
  s_add_u32 s37, s37, 1024
  v_mfma_f32_16x16x32_bf16 v[80:83], a[28:31], v[60:63], v[80:83]
  v_mfma_f32_16x16x32_bf16 v[84:87], a[92:95], v[60:63], v[84:87]
  v_mfma_f32_16x16x32_bf16 v[88:91], a[156:159], v[60:63], v[88:91]
  v_mfma_f32_16x16x32_bf16 v[92:95], a[220:223], v[60:63], v[92:95]
  ds_read_b128 v[56:59], v17 offset:512
  ds_read_b128 v[60:63], v17 offset:16896
  s_waitcnt lgkmcnt(2)
  v_mfma_f32_16x16x32_bf16 v[64:67], a[32:35], v[48:51], v[64:67]
  v_mfma_f32_16x16x32_bf16 v[68:71], a[96:99], v[48:51], v[68:71]
  s_add_u32 m0, s45, 8192
  v_xor_b32 v9, 128, v14
  v_mfma_f32_16x16x32_bf16 v[72:75], a[160:163], v[48:51], v[72:75]
  v_mfma_f32_16x16x32_bf16 v[76:79], a[224:227], v[48:51], v[76:79]
  buffer_load_dwordx4 v9, s[16:19], s37 offen lds
  s_add_u32 s37, s37, 1024
  v_mfma_f32_16x16x32_bf16 v[80:83], a[32:35], v[52:55], v[80:83]
  v_mfma_f32_16x16x32_bf16 v[84:87], a[96:99], v[52:55], v[84:87]
  v_mfma_f32_16x16x32_bf16 v[88:91], a[160:163], v[52:55], v[88:91]
  v_mfma_f32_16x16x32_bf16 v[92:95], a[224:227], v[52:55], v[92:95]
  ds_read_b128 v[48:51], v18 offset:512
  ds_read_b128 v[52:55], v18 offset:16896
  s_waitcnt lgkmcnt(2)
  v_mfma_f32_16x16x32_bf16 v[64:67], a[36:39], v[56:59], v[64:67]
  v_mfma_f32_16x16x32_bf16 v[68:71], a[100:103], v[56:59], v[68:71]
  s_add_u32 m0, s45, 9216
  v_xor_b32 v9, 144, v14
  v_mfma_f32_16x16x32_bf16 v[72:75], a[164:167], v[56:59], v[72:75]
  v_mfma_f32_16x16x32_bf16 v[76:79], a[228:231], v[56:59], v[76:79]
  buffer_load_dwordx4 v9, s[16:19], s37 offen lds
  s_add_u32 s37, s37, 1024
  v_mfma_f32_16x16x32_bf16 v[80:83], a[36:39], v[60:63], v[80:83]
  v_mfma_f32_16x16x32_bf16 v[84:87], a[100:103], v[60:63], v[84:87]
  v_mfma_f32_16x16x32_bf16 v[88:91], a[164:167], v[60:63], v[88:91]
  v_mfma_f32_16x16x32_bf16 v[92:95], a[228:231], v[60:63], v[92:95]
  ds_read_b128 v[56:59], v19 offset:512
  ds_read_b128 v[60:63], v19 offset:16896
  s_waitcnt lgkmcnt(2)
  v_mfma_f32_16x16x32_bf16 v[64:67], a[40:43], v[48:51], v[64:67]
  v_mfma_f32_16x16x32_bf16 v[68:71], a[104:107], v[48:51], v[68:71]
  s_add_u32 m0, s45, 10240
  v_xor_b32 v9, 160, v14
  v_mfma_f32_16x16x32_bf16 v[72:75], a[168:171], v[48:51], v[72:75]
  v_mfma_f32_16x16x32_bf16 v[76:79], a[232:235], v[48:51], v[76:79]
  buffer_load_dwordx4 v9, s[16:19], s37 offen lds
  s_add_u32 s37, s37, 1024
  v_mfma_f32_16x16x32_bf16 v[80:83], a[40:43], v[52:55], v[80:83]
  v_mfma_f32_16x16x32_bf16 v[84:87], a[104:107], v[52:55], v[84:87]
  v_mfma_f32_16x16x32_bf16 v[88:91], a[168:171], v[52:55], v[88:91]
  v_mfma_f32_16x16x32_bf16 v[92:95], a[232:235], v[52:55], v[92:95]
  ds_read_b128 v[48:51], v16 offset:768
  ds_read_b128 v[52:55], v16 offset:17152
  s_waitcnt lgkmcnt(2)
  v_mfma_f32_16x16x32_bf16 v[64:67], a[44:47], v[56:59], v[64:67]
  v_mfma_f32_16x16x32_bf16 v[68:71], a[108:111], v[56:59], v[68:71]
  s_add_u32 m0, s45, 11264
  v_xor_b32 v9, 176, v14
  v_mfma_f32_16x16x32_bf16 v[72:75], a[172:175], v[56:59], v[72:75]
  v_mfma_f32_16x16x32_bf16 v[76:79], a[236:239], v[56:59], v[76:79]
  buffer_load_dwordx4 v9, s[16:19], s37 offen lds
  s_add_u32 s37, s37, 1024
  v_mfma_f32_16x16x32_bf16 v[80:83], a[44:47], v[60:63], v[80:83]
  v_mfma_f32_16x16x32_bf16 v[84:87], a[108:111], v[60:63], v[84:87]
  v_mfma_f32_16x16x32_bf16 v[88:91], a[172:175], v[60:63], v[88:91]
  v_mfma_f32_16x16x32_bf16 v[92:95], a[236:239], v[60:63], v[92:95]
  ds_read_b128 v[56:59], v17 offset:768
  ds_read_b128 v[60:63], v17 offset:17152
  s_waitcnt lgkmcnt(2)
  v_mfma_f32_16x16x32_bf16 v[64:67], a[48:51], v[48:51], v[64:67]
  v_mfma_f32_16x16x32_bf16 v[68:71], a[112:115], v[48:51], v[68:71]
  s_add_u32 m0, s45, 12288
  v_xor_b32 v9, 192, v14
  v_mfma_f32_16x16x32_bf16 v[72:75], a[176:179], v[48:51], v[72:75]
  v_mfma_f32_16x16x32_bf16 v[76:79], a[240:243], v[48:51], v[76:79]
  buffer_load_dwordx4 v9, s[16:19], s37 offen lds
  s_add_u32 s37, s37, 1024
  v_mfma_f32_16x16x32_bf16 v[80:83], a[48:51], v[52:55], v[80:83]
  v_mfma_f32_16x16x32_bf16 v[84:87], a[112:115], v[52:55], v[84:87]
  v_mfma_f32_16x16x32_bf16 v[88:91], a[176:179], v[52:55], v[88:91]
  v_mfma_f32_16x16x32_bf16 v[92:95], a[240:243], v[52:55], v[92:95]
  ds_read_b128 v[48:51], v18 offset:768
  ds_read_b128 v[52:55], v18 offset:17152
  s_waitcnt lgkmcnt(2)
  v_mfma_f32_16x16x32_bf16 v[64:67], a[52:55], v[56:59], v[64:67]
  v_mfma_f32_16x16x32_bf16 v[68:71], a[116:119], v[56:59], v[68:71]
  s_add_u32 m0, s45, 13312
  v_xor_b32 v9, 208, v14
  v_mfma_f32_16x16x32_bf16 v[72:75], a[180:183], v[56:59], v[72:75]
  v_mfma_f32_16x16x32_bf16 v[76:79], a[244:247], v[56:59], v[76:79]
  buffer_load_dwordx4 v9, s[16:19], s37 offen lds
  s_add_u32 s37, s37, 1024
  v_mfma_f32_16x16x32_bf16 v[80:83], a[52:55], v[60:63], v[80:83]
  v_mfma_f32_16x16x32_bf16 v[84:87], a[116:119], v[60:63], v[84:87]
  v_mfma_f32_16x16x32_bf16 v[88:91], a[180:183], v[60:63], v[88:91]
  v_mfma_f32_16x16x32_bf16 v[92:95], a[244:247], v[60:63], v[92:95]
  ds_read_b128 v[56:59], v19 offset:768
  ds_read_b128 v[60:63], v19 offset:17152
  s_waitcnt lgkmcnt(2)
  v_mfma_f32_16x16x32_bf16 v[64:67], a[56:59], v[48:51], v[64:67]
  v_mfma_f32_16x16x32_bf16 v[68:71], a[120:123], v[48:51], v[68:71]
  s_add_u32 m0, s45, 14336
  v_xor_b32 v9, 224, v14
  v_mfma_f32_16x16x32_bf16 v[72:75], a[184:187], v[48:51], v[72:75]
  v_mfma_f32_16x16x32_bf16 v[76:79], a[248:251], v[48:51], v[76:79]
  buffer_load_dwordx4 v9, s[16:19], s37 offen lds
  s_add_u32 s37, s37, 1024
  v_mfma_f32_16x16x32_bf16 v[80:83], a[56:59], v[52:55], v[80:83]
  v_mfma_f32_16x16x32_bf16 v[84:87], a[120:123], v[52:55], v[84:87]
  v_mfma_f32_16x16x32_bf16 v[88:91], a[184:187], v[52:55], v[88:91]
  v_mfma_f32_16x16x32_bf16 v[92:95], a[248:251], v[52:55], v[92:95]
  s_waitcnt lgkmcnt(0)
  v_mfma_f32_16x16x32_bf16 v[64:67], a[60:63], v[56:59], v[64:67]
  v_mfma_f32_16x16x32_bf16 v[68:71], a[124:127], v[56:59], v[68:71]
  s_add_u32 m0, s45, 15360
  v_xor_b32 v9, 240, v14
  v_mfma_f32_16x16x32_bf16 v[72:75], a[188:191], v[56:59], v[72:75]
  v_mfma_f32_16x16x32_bf16 v[76:79], a[252:255], v[56:59], v[76:79]
  buffer_load_dwordx4 v9, s[16:19], s37 offen lds
  s_add_u32 s37, s37, 1024
  v_mfma_f32_16x16x32_bf16 v[80:83], a[60:63], v[60:63], v[80:83]
  v_mfma_f32_16x16x32_bf16 v[84:87], a[124:127], v[60:63], v[84:87]
  v_mfma_f32_16x16x32_bf16 v[88:91], a[188:191], v[60:63], v[88:91]
  v_mfma_f32_16x16x32_bf16 v[92:95], a[252:255], v[60:63], v[92:95]
  v_xor_b32 v16, 65536, v16
  v_xor_b32 v17, 65536, v17
  v_xor_b32 v18, 65536, v18
  v_xor_b32 v19, 65536, v19
  s_add_u32 s41, s38, s39
  s_nop 3
  s_cmp_lg_u32 s47, 3
  s_cbranch_scc1 p1_nh_6
  v_max_f32 v64, 0, v64
  v_max_f32 v65, 0, v65
  v_max_f32 v66, 0, v66
  v_max_f32 v67, 0, v67
  v_max_f32 v68, 0, v68
  v_max_f32 v69, 0, v69
  v_max_f32 v70, 0, v70
  v_max_f32 v71, 0, v71
  v_max_f32 v72, 0, v72
  v_max_f32 v73, 0, v73
  v_max_f32 v74, 0, v74
  v_max_f32 v75, 0, v75
  v_max_f32 v76, 0, v76
  v_max_f32 v77, 0, v77
  v_max_f32 v78, 0, v78
  v_max_f32 v79, 0, v79
  v_max_f32 v80, 0, v80
  v_max_f32 v81, 0, v81
  v_max_f32 v82, 0, v82
  v_max_f32 v83, 0, v83
  v_max_f32 v84, 0, v84
  v_max_f32 v85, 0, v85
  v_max_f32 v86, 0, v86
  v_max_f32 v87, 0, v87
  v_max_f32 v88, 0, v88
  v_max_f32 v89, 0, v89
  v_max_f32 v90, 0, v90
  v_max_f32 v91, 0, v91
  v_max_f32 v92, 0, v92
  v_max_f32 v93, 0, v93
  v_max_f32 v94, 0, v94
  v_max_f32 v95, 0, v95
  v_mul_f32 v64, v64, v64
  v_mul_f32 v65, v65, v65
  v_mul_f32 v66, v66, v66
  v_mul_f32 v67, v67, v67
  v_mul_f32 v68, v68, v68
  v_mul_f32 v69, v69, v69
  v_mul_f32 v70, v70, v70
  v_mul_f32 v71, v71, v71
  v_mul_f32 v72, v72, v72
  v_mul_f32 v73, v73, v73
  v_mul_f32 v74, v74, v74
  v_mul_f32 v75, v75, v75
  v_mul_f32 v76, v76, v76
  v_mul_f32 v77, v77, v77
  v_mul_f32 v78, v78, v78
  v_mul_f32 v79, v79, v79
  v_mul_f32 v80, v80, v80
  v_mul_f32 v81, v81, v81
  v_mul_f32 v82, v82, v82
  v_mul_f32 v83, v83, v83
  v_mul_f32 v84, v84, v84
  v_mul_f32 v85, v85, v85
  v_mul_f32 v86, v86, v86
  v_mul_f32 v87, v87, v87
  v_mul_f32 v88, v88, v88
  v_mul_f32 v89, v89, v89
  v_mul_f32 v90, v90, v90
  v_mul_f32 v91, v91, v91
  v_mul_f32 v92, v92, v92
  v_mul_f32 v93, v93, v93
  v_mul_f32 v94, v94, v94
  v_mul_f32 v95, v95, v95
p1_nh_6:
  v_cvt_pk_bf16_f32 v96, v64, v65
  v_cvt_pk_bf16_f32 v97, v66, v67
  v_cvt_pk_bf16_f32 v98, v68, v69
  v_cvt_pk_bf16_f32 v99, v70, v71
  buffer_store_dwordx4 v[96:99], v14, s[4:7], s38 offen offset:0 sc1
  v_cvt_pk_bf16_f32 v100, v72, v73
  v_cvt_pk_bf16_f32 v101, v74, v75
  v_cvt_pk_bf16_f32 v102, v76, v77
  v_cvt_pk_bf16_f32 v103, v78, v79
  buffer_store_dwordx4 v[100:103], v14, s[4:7], s38 offen offset:1024 sc1
  v_cvt_pk_bf16_f32 v104, v80, v81
  v_cvt_pk_bf16_f32 v105, v82, v83
  v_cvt_pk_bf16_f32 v106, v84, v85
  v_cvt_pk_bf16_f32 v107, v86, v87
  buffer_store_dwordx4 v[104:107], v14, s[4:7], s41 offen offset:0 sc1
  v_cvt_pk_bf16_f32 v108, v88, v89
  v_cvt_pk_bf16_f32 v109, v90, v91
  v_cvt_pk_bf16_f32 v110, v92, v93
  v_cvt_pk_bf16_f32 v111, v94, v95
  buffer_store_dwordx4 v[108:111], v14, s[4:7], s41 offen offset:1024 sc1
  s_add_u32 s38, s38, s48
  s_add_u32 s46, s46, 1
  s_cmp_lt_u32 s46, 16
  s_cbranch_scc1 p1_loop_t
  s_branch p1_fin
p1_loop_v:
  s_waitcnt vmcnt(4)
  s_barrier
  s_add_u32 s37, s37, 114688
  s_xor_b32 s45, s45, 65536
  s_cmp_lt_u32 s46, 2
  s_cbranch_scc1 p1_nf_7
  s_cmp_lg_u32 s33, 0
  s_cbranch_scc1 p1_nf_7
  s_sub_u32 s41, s46, 1
  v_mov_b32 v9, s41
  s_mov_b64 exec, 1
  buffer_store_dword v9, off, s[4:7], s44 sc1
  s_mov_b64 exec, -1
p1_nf_7:
  ds_read_b128 v[48:51], v16 offset:0
  ds_read_b128 v[52:55], v16 offset:16384
  ds_read_b128 v[56:59], v17 offset:0
  ds_read_b128 v[60:63], v17 offset:16384
  s_waitcnt lgkmcnt(2)
  v_mfma_f32_16x16x32_bf16 v[64:67], v[48:51], a[0:3], 0
  v_mfma_f32_16x16x32_bf16 v[68:71], v[48:51], a[64:67], 0
  s_add_u32 m0, s45, 0
  v_xor_b32 v9, 0, v14
  v_mfma_f32_16x16x32_bf16 v[72:75], v[48:51], a[128:131], 0
  v_mfma_f32_16x16x32_bf16 v[76:79], v[48:51], a[192:195], 0
  buffer_load_dwordx4 v9, s[16:19], s37 offen lds
  s_add_u32 s37, s37, 1024
  v_mfma_f32_16x16x32_bf16 v[80:83], v[52:55], a[0:3], 0
  v_mfma_f32_16x16x32_bf16 v[84:87], v[52:55], a[64:67], 0
  v_mfma_f32_16x16x32_bf16 v[88:91], v[52:55], a[128:131], 0
  v_mfma_f32_16x16x32_bf16 v[92:95], v[52:55], a[192:195], 0
  ds_read_b128 v[48:51], v18 offset:0
  ds_read_b128 v[52:55], v18 offset:16384
  s_waitcnt lgkmcnt(2)
  v_mfma_f32_16x16x32_bf16 v[64:67], v[56:59], a[4:7], v[64:67]
  v_mfma_f32_16x16x32_bf16 v[68:71], v[56:59], a[68:71], v[68:71]
  s_add_u32 m0, s45, 1024
  v_xor_b32 v9, 16, v14
  v_mfma_f32_16x16x32_bf16 v[72:75], v[56:59], a[132:135], v[72:75]
  v_mfma_f32_16x16x32_bf16 v[76:79], v[56:59], a[196:199], v[76:79]
  buffer_load_dwordx4 v9, s[16:19], s37 offen lds
  s_add_u32 s37, s37, 1024
  v_mfma_f32_16x16x32_bf16 v[80:83], v[60:63], a[4:7], v[80:83]
  v_mfma_f32_16x16x32_bf16 v[84:87], v[60:63], a[68:71], v[84:87]
  v_mfma_f32_16x16x32_bf16 v[88:91], v[60:63], a[132:135], v[88:91]
  v_mfma_f32_16x16x32_bf16 v[92:95], v[60:63], a[196:199], v[92:95]
  ds_read_b128 v[56:59], v19 offset:0
  ds_read_b128 v[60:63], v19 offset:16384
  s_waitcnt lgkmcnt(2)
  v_mfma_f32_16x16x32_bf16 v[64:67], v[48:51], a[8:11], v[64:67]
  v_mfma_f32_16x16x32_bf16 v[68:71], v[48:51], a[72:75], v[68:71]
  s_add_u32 m0, s45, 2048
  v_xor_b32 v9, 32, v14
  v_mfma_f32_16x16x32_bf16 v[72:75], v[48:51], a[136:139], v[72:75]
  v_mfma_f32_16x16x32_bf16 v[76:79], v[48:51], a[200:203], v[76:79]
  buffer_load_dwordx4 v9, s[16:19], s37 offen lds
  s_add_u32 s37, s37, 1024
  v_mfma_f32_16x16x32_bf16 v[80:83], v[52:55], a[8:11], v[80:83]
  v_mfma_f32_16x16x32_bf16 v[84:87], v[52:55], a[72:75], v[84:87]
  v_mfma_f32_16x16x32_bf16 v[88:91], v[52:55], a[136:139], v[88:91]
  v_mfma_f32_16x16x32_bf16 v[92:95], v[52:55], a[200:203], v[92:95]
  ds_read_b128 v[48:51], v16 offset:256
  ds_read_b128 v[52:55], v16 offset:16640
  s_waitcnt lgkmcnt(2)
  v_mfma_f32_16x16x32_bf16 v[64:67], v[56:59], a[12:15], v[64:67]
  v_mfma_f32_16x16x32_bf16 v[68:71], v[56:59], a[76:79], v[68:71]
  s_add_u32 m0, s45, 3072
  v_xor_b32 v9, 48, v14
  v_mfma_f32_16x16x32_bf16 v[72:75], v[56:59], a[140:143], v[72:75]
  v_mfma_f32_16x16x32_bf16 v[76:79], v[56:59], a[204:207], v[76:79]
  buffer_load_dwordx4 v9, s[16:19], s37 offen lds
  s_add_u32 s37, s37, 1024
  v_mfma_f32_16x16x32_bf16 v[80:83], v[60:63], a[12:15], v[80:83]
  v_mfma_f32_16x16x32_bf16 v[84:87], v[60:63], a[76:79], v[84:87]
  v_mfma_f32_16x16x32_bf16 v[88:91], v[60:63], a[140:143], v[88:91]
  v_mfma_f32_16x16x32_bf16 v[92:95], v[60:63], a[204:207], v[92:95]
  ds_read_b128 v[56:59], v17 offset:256
  ds_read_b128 v[60:63], v17 offset:16640
  s_waitcnt lgkmcnt(2)
  v_mfma_f32_16x16x32_bf16 v[64:67], v[48:51], a[16:19], v[64:67]
  v_mfma_f32_16x16x32_bf16 v[68:71], v[48:51], a[80:83], v[68:71]
  s_add_u32 m0, s45, 4096
  v_xor_b32 v9, 64, v14
  v_mfma_f32_16x16x32_bf16 v[72:75], v[48:51], a[144:147], v[72:75]
  v_mfma_f32_16x16x32_bf16 v[76:79], v[48:51], a[208:211], v[76:79]
  buffer_load_dwordx4 v9, s[16:19], s37 offen lds
  s_add_u32 s37, s37, 1024
  v_mfma_f32_16x16x32_bf16 v[80:83], v[52:55], a[16:19], v[80:83]
  v_mfma_f32_16x16x32_bf16 v[84:87], v[52:55], a[80:83], v[84:87]
  v_mfma_f32_16x16x32_bf16 v[88:91], v[52:55], a[144:147], v[88:91]
  v_mfma_f32_16x16x32_bf16 v[92:95], v[52:55], a[208:211], v[92:95]
  ds_read_b128 v[48:51], v18 offset:256
  ds_read_b128 v[52:55], v18 offset:16640
  s_waitcnt lgkmcnt(2)
  v_mfma_f32_16x16x32_bf16 v[64:67], v[56:59], a[20:23], v[64:67]
  v_mfma_f32_16x16x32_bf16 v[68:71], v[56:59], a[84:87], v[68:71]
  s_add_u32 m0, s45, 5120
  v_xor_b32 v9, 80, v14
  v_mfma_f32_16x16x32_bf16 v[72:75], v[56:59], a[148:151], v[72:75]
  v_mfma_f32_16x16x32_bf16 v[76:79], v[56:59], a[212:215], v[76:79]
  buffer_load_dwordx4 v9, s[16:19], s37 offen lds
  s_add_u32 s37, s37, 1024
  v_mfma_f32_16x16x32_bf16 v[80:83], v[60:63], a[20:23], v[80:83]
  v_mfma_f32_16x16x32_bf16 v[84:87], v[60:63], a[84:87], v[84:87]
  v_mfma_f32_16x16x32_bf16 v[88:91], v[60:63], a[148:151], v[88:91]
  v_mfma_f32_16x16x32_bf16 v[92:95], v[60:63], a[212:215], v[92:95]
  ds_read_b128 v[56:59], v19 offset:256
  ds_read_b128 v[60:63], v19 offset:16640
  s_waitcnt lgkmcnt(2)
  v_mfma_f32_16x16x32_bf16 v[64:67], v[48:51], a[24:27], v[64:67]
  v_mfma_f32_16x16x32_bf16 v[68:71], v[48:51], a[88:91], v[68:71]
  s_add_u32 m0, s45, 6144
  v_xor_b32 v9, 96, v14
  v_mfma_f32_16x16x32_bf16 v[72:75], v[48:51], a[152:155], v[72:75]
  v_mfma_f32_16x16x32_bf16 v[76:79], v[48:51], a[216:219], v[76:79]
  buffer_load_dwordx4 v9, s[16:19], s37 offen lds
  s_add_u32 s37, s37, 1024
  v_mfma_f32_16x16x32_bf16 v[80:83], v[52:55], a[24:27], v[80:83]
  v_mfma_f32_16x16x32_bf16 v[84:87], v[52:55], a[88:91], v[84:87]
  v_mfma_f32_16x16x32_bf16 v[88:91], v[52:55], a[152:155], v[88:91]
  v_mfma_f32_16x16x32_bf16 v[92:95], v[52:55], a[216:219], v[92:95]
  ds_read_b128 v[48:51], v16 offset:512
  ds_read_b128 v[52:55], v16 offset:16896
  s_waitcnt lgkmcnt(2)
  v_mfma_f32_16x16x32_bf16 v[64:67], v[56:59], a[28:31], v[64:67]
  v_mfma_f32_16x16x32_bf16 v[68:71], v[56:59], a[92:95], v[68:71]
  s_add_u32 m0, s45, 7168
  v_xor_b32 v9, 112, v14
  v_mfma_f32_16x16x32_bf16 v[72:75], v[56:59], a[156:159], v[72:75]
  v_mfma_f32_16x16x32_bf16 v[76:79], v[56:59], a[220:223], v[76:79]
  buffer_load_dwordx4 v9, s[16:19], s37 offen lds
  s_add_u32 s37, s37, 1024
  v_mfma_f32_16x16x32_bf16 v[80:83], v[60:63], a[28:31], v[80:83]
  v_mfma_f32_16x16x32_bf16 v[84:87], v[60:63], a[92:95], v[84:87]
  v_mfma_f32_16x16x32_bf16 v[88:91], v[60:63], a[156:159], v[88:91]
  v_mfma_f32_16x16x32_bf16 v[92:95], v[60:63], a[220:223], v[92:95]
  ds_read_b128 v[56:59], v17 offset:512
  ds_read_b128 v[60:63], v17 offset:16896
  s_waitcnt lgkmcnt(2)
  v_mfma_f32_16x16x32_bf16 v[64:67], v[48:51], a[32:35], v[64:67]
  v_mfma_f32_16x16x32_bf16 v[68:71], v[48:51], a[96:99], v[68:71]
  s_add_u32 m0, s45, 8192
  v_xor_b32 v9, 128, v14
  v_mfma_f32_16x16x32_bf16 v[72:75], v[48:51], a[160:163], v[72:75]
  v_mfma_f32_16x16x32_bf16 v[76:79], v[48:51], a[224:227], v[76:79]
  buffer_load_dwordx4 v9, s[16:19], s37 offen lds
  s_add_u32 s37, s37, 1024
  v_mfma_f32_16x16x32_bf16 v[80:83], v[52:55], a[32:35], v[80:83]
  v_mfma_f32_16x16x32_bf16 v[84:87], v[52:55], a[96:99], v[84:87]
  v_mfma_f32_16x16x32_bf16 v[88:91], v[52:55], a[160:163], v[88:91]
  v_mfma_f32_16x16x32_bf16 v[92:95], v[52:55], a[224:227], v[92:95]
  ds_read_b128 v[48:51], v18 offset:512
  ds_read_b128 v[52:55], v18 offset:16896
  s_waitcnt lgkmcnt(2)
  v_mfma_f32_16x16x32_bf16 v[64:67], v[56:59], a[36:39], v[64:67]
  v_mfma_f32_16x16x32_bf16 v[68:71], v[56:59], a[100:103], v[68:71]
  s_add_u32 m0, s45, 9216
  v_xor_b32 v9, 144, v14
  v_mfma_f32_16x16x32_bf16 v[72:75], v[56:59], a[164:167], v[72:75]
  v_mfma_f32_16x16x32_bf16 v[76:79], v[56:59], a[228:231], v[76:79]
  buffer_load_dwordx4 v9, s[16:19], s37 offen lds
  s_add_u32 s37, s37, 1024
  v_mfma_f32_16x16x32_bf16 v[80:83], v[60:63], a[36:39], v[80:83]
  v_mfma_f32_16x16x32_bf16 v[84:87], v[60:63], a[100:103], v[84:87]
  v_mfma_f32_16x16x32_bf16 v[88:91], v[60:63], a[164:167], v[88:91]
  v_mfma_f32_16x16x32_bf16 v[92:95], v[60:63], a[228:231], v[92:95]
  ds_read_b128 v[56:59], v19 offset:512
  ds_read_b128 v[60:63], v19 offset:16896
  s_waitcnt lgkmcnt(2)
  v_mfma_f32_16x16x32_bf16 v[64:67], v[48:51], a[40:43], v[64:67]
  v_mfma_f32_16x16x32_bf16 v[68:71], v[48:51], a[104:107], v[68:71]
  s_add_u32 m0, s45, 10240
  v_xor_b32 v9, 160, v14
  v_mfma_f32_16x16x32_bf16 v[72:75], v[48:51], a[168:171], v[72:75]
  v_mfma_f32_16x16x32_bf16 v[76:79], v[48:51], a[232:235], v[76:79]
  buffer_load_dwordx4 v9, s[16:19], s37 offen lds
  s_add_u32 s37, s37, 1024
  v_mfma_f32_16x16x32_bf16 v[80:83], v[52:55], a[40:43], v[80:83]
  v_mfma_f32_16x16x32_bf16 v[84:87], v[52:55], a[104:107], v[84:87]
  v_mfma_f32_16x16x32_bf16 v[88:91], v[52:55], a[168:171], v[88:91]
  v_mfma_f32_16x16x32_bf16 v[92:95], v[52:55], a[232:235], v[92:95]
  ds_read_b128 v[48:51], v16 offset:768
  ds_read_b128 v[52:55], v16 offset:17152
  s_waitcnt lgkmcnt(2)
  v_mfma_f32_16x16x32_bf16 v[64:67], v[56:59], a[44:47], v[64:67]
  v_mfma_f32_16x16x32_bf16 v[68:71], v[56:59], a[108:111], v[68:71]
  s_add_u32 m0, s45, 11264
  v_xor_b32 v9, 176, v14
  v_mfma_f32_16x16x32_bf16 v[72:75], v[56:59], a[172:175], v[72:75]
  v_mfma_f32_16x16x32_bf16 v[76:79], v[56:59], a[236:239], v[76:79]
  buffer_load_dwordx4 v9, s[16:19], s37 offen lds
  s_add_u32 s37, s37, 1024
  v_mfma_f32_16x16x32_bf16 v[80:83], v[60:63], a[44:47], v[80:83]
  v_mfma_f32_16x16x32_bf16 v[84:87], v[60:63], a[108:111], v[84:87]
  v_mfma_f32_16x16x32_bf16 v[88:91], v[60:63], a[172:175], v[88:91]
  v_mfma_f32_16x16x32_bf16 v[92:95], v[60:63], a[236:239], v[92:95]
  ds_read_b128 v[56:59], v17 offset:768
  ds_read_b128 v[60:63], v17 offset:17152
  s_waitcnt lgkmcnt(2)
  v_mfma_f32_16x16x32_bf16 v[64:67], v[48:51], a[48:51], v[64:67]
  v_mfma_f32_16x16x32_bf16 v[68:71], v[48:51], a[112:115], v[68:71]
  s_add_u32 m0, s45, 12288
  v_xor_b32 v9, 192, v14
  v_mfma_f32_16x16x32_bf16 v[72:75], v[48:51], a[176:179], v[72:75]
  v_mfma_f32_16x16x32_bf16 v[76:79], v[48:51], a[240:243], v[76:79]
  buffer_load_dwordx4 v9, s[16:19], s37 offen lds
  s_add_u32 s37, s37, 1024
  v_mfma_f32_16x16x32_bf16 v[80:83], v[52:55], a[48:51], v[80:83]
  v_mfma_f32_16x16x32_bf16 v[84:87], v[52:55], a[112:115], v[84:87]
  v_mfma_f32_16x16x32_bf16 v[88:91], v[52:55], a[176:179], v[88:91]
  v_mfma_f32_16x16x32_bf16 v[92:95], v[52:55], a[240:243], v[92:95]
  ds_read_b128 v[48:51], v18 offset:768
  ds_read_b128 v[52:55], v18 offset:17152
  s_waitcnt lgkmcnt(2)
  v_mfma_f32_16x16x32_bf16 v[64:67], v[56:59], a[52:55], v[64:67]
  v_mfma_f32_16x16x32_bf16 v[68:71], v[56:59], a[116:119], v[68:71]
  s_add_u32 m0, s45, 13312
  v_xor_b32 v9, 208, v14
  v_mfma_f32_16x16x32_bf16 v[72:75], v[56:59], a[180:183], v[72:75]
  v_mfma_f32_16x16x32_bf16 v[76:79], v[56:59], a[244:247], v[76:79]
  buffer_load_dwordx4 v9, s[16:19], s37 offen lds
  s_add_u32 s37, s37, 1024
  v_mfma_f32_16x16x32_bf16 v[80:83], v[60:63], a[52:55], v[80:83]
  v_mfma_f32_16x16x32_bf16 v[84:87], v[60:63], a[116:119], v[84:87]
  v_mfma_f32_16x16x32_bf16 v[88:91], v[60:63], a[180:183], v[88:91]
  v_mfma_f32_16x16x32_bf16 v[92:95], v[60:63], a[244:247], v[92:95]
  ds_read_b128 v[56:59], v19 offset:768
  ds_read_b128 v[60:63], v19 offset:17152
  s_waitcnt lgkmcnt(2)
  v_mfma_f32_16x16x32_bf16 v[64:67], v[48:51], a[56:59], v[64:67]
  v_mfma_f32_16x16x32_bf16 v[68:71], v[48:51], a[120:123], v[68:71]
  s_add_u32 m0, s45, 14336
  v_xor_b32 v9, 224, v14
  v_mfma_f32_16x16x32_bf16 v[72:75], v[48:51], a[184:187], v[72:75]
  v_mfma_f32_16x16x32_bf16 v[76:79], v[48:51], a[248:251], v[76:79]
  buffer_load_dwordx4 v9, s[16:19], s37 offen lds
  s_add_u32 s37, s37, 1024
  v_mfma_f32_16x16x32_bf16 v[80:83], v[52:55], a[56:59], v[80:83]
  v_mfma_f32_16x16x32_bf16 v[84:87], v[52:55], a[120:123], v[84:87]
  v_mfma_f32_16x16x32_bf16 v[88:91], v[52:55], a[184:187], v[88:91]
  v_mfma_f32_16x16x32_bf16 v[92:95], v[52:55], a[248:251], v[92:95]
  s_waitcnt lgkmcnt(0)
  v_mfma_f32_16x16x32_bf16 v[64:67], v[56:59], a[60:63], v[64:67]
  v_mfma_f32_16x16x32_bf16 v[68:71], v[56:59], a[124:127], v[68:71]
  s_add_u32 m0, s45, 15360
  v_xor_b32 v9, 240, v14
  v_mfma_f32_16x16x32_bf16 v[72:75], v[56:59], a[188:191], v[72:75]
  v_mfma_f32_16x16x32_bf16 v[76:79], v[56:59], a[252:255], v[76:79]
  buffer_load_dwordx4 v9, s[16:19], s37 offen lds
  s_add_u32 s37, s37, 1024
  v_mfma_f32_16x16x32_bf16 v[80:83], v[60:63], a[60:63], v[80:83]
  v_mfma_f32_16x16x32_bf16 v[84:87], v[60:63], a[124:127], v[84:87]
  v_mfma_f32_16x16x32_bf16 v[88:91], v[60:63], a[188:191], v[88:91]
  v_mfma_f32_16x16x32_bf16 v[92:95], v[60:63], a[252:255], v[92:95]
  v_xor_b32 v16, 65536, v16
  v_xor_b32 v17, 65536, v17
  v_xor_b32 v18, 65536, v18
  v_xor_b32 v19, 65536, v19
  s_add_u32 s41, s38, s39
  s_nop 3
  v_cvt_pk_bf16_f32 v96, v64, v65
  v_cvt_pk_bf16_f32 v97, v66, v67
  v_cvt_pk_bf16_f32 v98, v80, v81
  v_cvt_pk_bf16_f32 v99, v82, v83
  buffer_store_dwordx4 v[96:99], v14, s[4:7], s38 offen offset:0 sc1
  v_cvt_pk_bf16_f32 v100, v68, v69
  v_cvt_pk_bf16_f32 v101, v70, v71
  v_cvt_pk_bf16_f32 v102, v84, v85
  v_cvt_pk_bf16_f32 v103, v86, v87
  buffer_store_dwordx4 v[100:103], v14, s[4:7], s38 offen offset:1024 sc1
  v_cvt_pk_bf16_f32 v104, v72, v73
  v_cvt_pk_bf16_f32 v105, v74, v75
  v_cvt_pk_bf16_f32 v106, v88, v89
  v_cvt_pk_bf16_f32 v107, v90, v91
  buffer_store_dwordx4 v[104:107], v14, s[4:7], s41 offen offset:0 sc1
  v_cvt_pk_bf16_f32 v108, v76, v77
  v_cvt_pk_bf16_f32 v109, v78, v79
  v_cvt_pk_bf16_f32 v110, v92, v93
  v_cvt_pk_bf16_f32 v111, v94, v95
  buffer_store_dwordx4 v[108:111], v14, s[4:7], s41 offen offset:1024 sc1
  s_add_u32 s38, s38, s48
  s_add_u32 s46, s46, 1
  s_cmp_lt_u32 s46, 16
  s_cbranch_scc1 p1_loop_v
  s_branch p1_fin
p1_gate:
  s_mov_b32 s16, s64
  s_and_b32 s17, s65, 0xffff
  s_mov_b32 s18, 0x200000
  s_mov_b32 s19, 0x00020000
  s_mov_b32 s20, s88
  s_and_b32 s21, s89, 0xffff
  s_mov_b32 s22, 0x400
  s_mov_b32 s23, 0x00020000
  v_lshlrev_b32 v14, 4, v0
  buffer_load_dwordx4 v[4:7], v14, s[20:23], 0 offen
  s_sub_u32 s41, s34, 110
  s_lshl_b32 s41, s41, 1
  s_add_u32 s41, s41, s35
  s_lshl_b32 s41, s41, 2
  s_add_u32 s41, s41, s33
  s_lshl_b32 s37, s41, 17
  s_lshl_b32 s38, s41, 9
  s_add_u32 s38, s38, 85262336
  s_mov_b32 s46, 0
  s_mov_b32 s40, 0
L_rdy_8:
  buffer_load_dword v9, off, s[8:11], 0 offset:16 sc1
  s_add_u32 s40, s40, 1
  s_waitcnt vmcnt(0)
  v_readfirstlane_b32 s41, v9
  s_cmp_gt_u32 s40, 1048576
  s_cbranch_scc1 L_rdy_8_d
  s_cmp_eq_u32 s41, 0
  s_cbranch_scc1 L_rdy_8
L_rdy_8_d:
p1_gate_l:
  s_add_u32 s41, s37, 0
  buffer_load_dwordx4 v[32:35], v14, s[16:19], s41 offen offset:0
  s_add_u32 s41, s37, 0
  buffer_load_dwordx4 v[36:39], v14, s[16:19], s41 offen offset:1024
  s_add_u32 s41, s37, 0
  buffer_load_dwordx4 v[40:43], v14, s[16:19], s41 offen offset:2048
  s_add_u32 s41, s37, 0
  buffer_load_dwordx4 v[44:47], v14, s[16:19], s41 offen offset:3072
  s_add_u32 s41, s37, 4096
  buffer_load_dwordx4 v[48:51], v14, s[16:19], s41 offen offset:0
  s_add_u32 s41, s37, 4096
  buffer_load_dwordx4 v[52:55], v14, s[16:19], s41 offen offset:1024
  s_add_u32 s41, s37, 4096
  buffer_load_dwordx4 v[56:59], v14, s[16:19], s41 offen offset:2048
  s_add_u32 s41, s37, 4096
  buffer_load_dwordx4 v[60:63], v14, s[16:19], s41 offen offset:3072
  s_add_u32 s41, s37, 8192
  buffer_load_dwordx4 v[64:67], v14, s[16:19], s41 offen offset:0
  s_add_u32 s41, s37, 8192
  buffer_load_dwordx4 v[68:71], v14, s[16:19], s41 offen offset:1024
  s_add_u32 s41, s37, 8192
  buffer_load_dwordx4 v[72:75], v14, s[16:19], s41 offen offset:2048
  s_add_u32 s41, s37, 8192
  buffer_load_dwordx4 v[76:79], v14, s[16:19], s41 offen offset:3072
  s_add_u32 s41, s37, 12288
  buffer_load_dwordx4 v[80:83], v14, s[16:19], s41 offen offset:0
  s_add_u32 s41, s37, 12288
  buffer_load_dwordx4 v[84:87], v14, s[16:19], s41 offen offset:1024
  s_add_u32 s41, s37, 12288
  buffer_load_dwordx4 v[88:91], v14, s[16:19], s41 offen offset:2048
  s_add_u32 s41, s37, 12288
  buffer_load_dwordx4 v[92:95], v14, s[16:19], s41 offen offset:3072
  v_mov_b32 v20, 0
  s_waitcnt vmcnt(15)
  v_dot2_f32_bf16 v8, v32, v4, 0
  s_nop 2
  v_dot2_f32_bf16 v8, v33, v5, v8
  v_dot2_f32_bf16 v8, v34, v6, v8
  v_dot2_f32_bf16 v8, v35, v7, v8
  s_nop 2
  v_mov_b32 v9, v8
  s_nop 1
  v_add_f32_dpp v9, v9, v9 row_ror:1 row_mask:0xf bank_mask:0xf
  s_nop 1
  v_add_f32_dpp v9, v9, v9 row_ror:2 row_mask:0xf bank_mask:0xf
  s_nop 1
  v_add_f32_dpp v9, v9, v9 row_ror:4 row_mask:0xf bank_mask:0xf
  s_nop 1
  v_add_f32_dpp v9, v9, v9 row_ror:8 row_mask:0xf bank_mask:0xf
  s_nop 1
  v_mov_b32 v10, v9
  s_nop 1
  v_permlane32_swap_b32 v9, v10
  v_add_f32 v9, v9, v10
  v_mov_b32 v10, v9
  s_nop 1
  v_permlane16_swap_b32 v9, v10
  v_add_f32 v9, v9, v10
  v_cmp_eq_u32 vcc, 0, v0
  s_nop 1
  v_cndmask_b32 v20, v20, v9, vcc
  s_waitcnt vmcnt(14)
  v_dot2_f32_bf16 v8, v36, v4, 0
  s_nop 2
  v_dot2_f32_bf16 v8, v37, v5, v8
  v_dot2_f32_bf16 v8, v38, v6, v8
  v_dot2_f32_bf16 v8, v39, v7, v8
  s_nop 2
  v_mov_b32 v9, v8
  s_nop 1
  v_add_f32_dpp v9, v9, v9 row_ror:1 row_mask:0xf bank_mask:0xf
  s_nop 1
  v_add_f32_dpp v9, v9, v9 row_ror:2 row_mask:0xf bank_mask:0xf
  s_nop 1
  v_add_f32_dpp v9, v9, v9 row_ror:4 row_mask:0xf bank_mask:0xf
  s_nop 1
  v_add_f32_dpp v9, v9, v9 row_ror:8 row_mask:0xf bank_mask:0xf
  s_nop 1
  v_mov_b32 v10, v9
  s_nop 1
  v_permlane32_swap_b32 v9, v10
  v_add_f32 v9, v9, v10
  v_mov_b32 v10, v9
  s_nop 1
  v_permlane16_swap_b32 v9, v10
  v_add_f32 v9, v9, v10
  v_cmp_eq_u32 vcc, 1, v0
  s_nop 1
  v_cndmask_b32 v20, v20, v9, vcc
  s_waitcnt vmcnt(13)
  v_dot2_f32_bf16 v8, v40, v4, 0
  s_nop 2
  v_dot2_f32_bf16 v8, v41, v5, v8
  v_dot2_f32_bf16 v8, v42, v6, v8
  v_dot2_f32_bf16 v8, v43, v7, v8
  s_nop 2
  v_mov_b32 v9, v8
  s_nop 1
  v_add_f32_dpp v9, v9, v9 row_ror:1 row_mask:0xf bank_mask:0xf
  s_nop 1
  v_add_f32_dpp v9, v9, v9 row_ror:2 row_mask:0xf bank_mask:0xf
  s_nop 1
  v_add_f32_dpp v9, v9, v9 row_ror:4 row_mask:0xf bank_mask:0xf
  s_nop 1
  v_add_f32_dpp v9, v9, v9 row_ror:8 row_mask:0xf bank_mask:0xf
  s_nop 1
  v_mov_b32 v10, v9
  s_nop 1
  v_permlane32_swap_b32 v9, v10
  v_add_f32 v9, v9, v10
  v_mov_b32 v10, v9
  s_nop 1
  v_permlane16_swap_b32 v9, v10
  v_add_f32 v9, v9, v10
  v_cmp_eq_u32 vcc, 2, v0
  s_nop 1
  v_cndmask_b32 v20, v20, v9, vcc
  s_waitcnt vmcnt(12)
  v_dot2_f32_bf16 v8, v44, v4, 0
  s_nop 2
  v_dot2_f32_bf16 v8, v45, v5, v8
  v_dot2_f32_bf16 v8, v46, v6, v8
  v_dot2_f32_bf16 v8, v47, v7, v8
  s_nop 2
  v_mov_b32 v9, v8
  s_nop 1
  v_add_f32_dpp v9, v9, v9 row_ror:1 row_mask:0xf bank_mask:0xf
  s_nop 1
  v_add_f32_dpp v9, v9, v9 row_ror:2 row_mask:0xf bank_mask:0xf
  s_nop 1
  v_add_f32_dpp v9, v9, v9 row_ror:4 row_mask:0xf bank_mask:0xf
  s_nop 1
  v_add_f32_dpp v9, v9, v9 row_ror:8 row_mask:0xf bank_mask:0xf
  s_nop 1
  v_mov_b32 v10, v9
  s_nop 1
  v_permlane32_swap_b32 v9, v10
  v_add_f32 v9, v9, v10
  v_mov_b32 v10, v9
  s_nop 1
  v_permlane16_swap_b32 v9, v10
  v_add_f32 v9, v9, v10
  v_cmp_eq_u32 vcc, 3, v0
  s_nop 1
  v_cndmask_b32 v20, v20, v9, vcc
  s_waitcnt vmcnt(11)
  v_dot2_f32_bf16 v8, v48, v4, 0
  s_nop 2
  v_dot2_f32_bf16 v8, v49, v5, v8
  v_dot2_f32_bf16 v8, v50, v6, v8
  v_dot2_f32_bf16 v8, v51, v7, v8
  s_nop 2
  v_mov_b32 v9, v8
  s_nop 1
  v_add_f32_dpp v9, v9, v9 row_ror:1 row_mask:0xf bank_mask:0xf
  s_nop 1
  v_add_f32_dpp v9, v9, v9 row_ror:2 row_mask:0xf bank_mask:0xf
  s_nop 1
  v_add_f32_dpp v9, v9, v9 row_ror:4 row_mask:0xf bank_mask:0xf
  s_nop 1
  v_add_f32_dpp v9, v9, v9 row_ror:8 row_mask:0xf bank_mask:0xf
  s_nop 1
  v_mov_b32 v10, v9
  s_nop 1
  v_permlane32_swap_b32 v9, v10
  v_add_f32 v9, v9, v10
  v_mov_b32 v10, v9
  s_nop 1
  v_permlane16_swap_b32 v9, v10
  v_add_f32 v9, v9, v10
  v_cmp_eq_u32 vcc, 4, v0
  s_nop 1
  v_cndmask_b32 v20, v20, v9, vcc
  s_waitcnt vmcnt(10)
  v_dot2_f32_bf16 v8, v52, v4, 0
  s_nop 2
  v_dot2_f32_bf16 v8, v53, v5, v8
  v_dot2_f32_bf16 v8, v54, v6, v8
  v_dot2_f32_bf16 v8, v55, v7, v8
  s_nop 2
  v_mov_b32 v9, v8
  s_nop 1
  v_add_f32_dpp v9, v9, v9 row_ror:1 row_mask:0xf bank_mask:0xf
  s_nop 1
  v_add_f32_dpp v9, v9, v9 row_ror:2 row_mask:0xf bank_mask:0xf
  s_nop 1
  v_add_f32_dpp v9, v9, v9 row_ror:4 row_mask:0xf bank_mask:0xf
  s_nop 1
  v_add_f32_dpp v9, v9, v9 row_ror:8 row_mask:0xf bank_mask:0xf
  s_nop 1
  v_mov_b32 v10, v9
  s_nop 1
  v_permlane32_swap_b32 v9, v10
  v_add_f32 v9, v9, v10
  v_mov_b32 v10, v9
  s_nop 1
  v_permlane16_swap_b32 v9, v10
  v_add_f32 v9, v9, v10
  v_cmp_eq_u32 vcc, 5, v0
  s_nop 1
  v_cndmask_b32 v20, v20, v9, vcc
  s_waitcnt vmcnt(9)
  v_dot2_f32_bf16 v8, v56, v4, 0
  s_nop 2
  v_dot2_f32_bf16 v8, v57, v5, v8
  v_dot2_f32_bf16 v8, v58, v6, v8
  v_dot2_f32_bf16 v8, v59, v7, v8
  s_nop 2
  v_mov_b32 v9, v8
  s_nop 1
  v_add_f32_dpp v9, v9, v9 row_ror:1 row_mask:0xf bank_mask:0xf
  s_nop 1
  v_add_f32_dpp v9, v9, v9 row_ror:2 row_mask:0xf bank_mask:0xf
  s_nop 1
  v_add_f32_dpp v9, v9, v9 row_ror:4 row_mask:0xf bank_mask:0xf
  s_nop 1
  v_add_f32_dpp v9, v9, v9 row_ror:8 row_mask:0xf bank_mask:0xf
  s_nop 1
  v_mov_b32 v10, v9
  s_nop 1
  v_permlane32_swap_b32 v9, v10
  v_add_f32 v9, v9, v10
  v_mov_b32 v10, v9
  s_nop 1
  v_permlane16_swap_b32 v9, v10
  v_add_f32 v9, v9, v10
  v_cmp_eq_u32 vcc, 6, v0
  s_nop 1
  v_cndmask_b32 v20, v20, v9, vcc
  s_waitcnt vmcnt(8)
  v_dot2_f32_bf16 v8, v60, v4, 0
  s_nop 2
  v_dot2_f32_bf16 v8, v61, v5, v8
  v_dot2_f32_bf16 v8, v62, v6, v8
  v_dot2_f32_bf16 v8, v63, v7, v8
  s_nop 2
  v_mov_b32 v9, v8
  s_nop 1
  v_add_f32_dpp v9, v9, v9 row_ror:1 row_mask:0xf bank_mask:0xf
  s_nop 1
  v_add_f32_dpp v9, v9, v9 row_ror:2 row_mask:0xf bank_mask:0xf
  s_nop 1
  v_add_f32_dpp v9, v9, v9 row_ror:4 row_mask:0xf bank_mask:0xf
  s_nop 1
  v_add_f32_dpp v9, v9, v9 row_ror:8 row_mask:0xf bank_mask:0xf
  s_nop 1
  v_mov_b32 v10, v9
  s_nop 1
  v_permlane32_swap_b32 v9, v10
  v_add_f32 v9, v9, v10
  v_mov_b32 v10, v9
  s_nop 1
  v_permlane16_swap_b32 v9, v10
  v_add_f32 v9, v9, v10
  v_cmp_eq_u32 vcc, 7, v0
  s_nop 1
  v_cndmask_b32 v20, v20, v9, vcc
  s_waitcnt vmcnt(7)
  v_dot2_f32_bf16 v8, v64, v4, 0
  s_nop 2
  v_dot2_f32_bf16 v8, v65, v5, v8
  v_dot2_f32_bf16 v8, v66, v6, v8
  v_dot2_f32_bf16 v8, v67, v7, v8
  s_nop 2
  v_mov_b32 v9, v8
  s_nop 1
  v_add_f32_dpp v9, v9, v9 row_ror:1 row_mask:0xf bank_mask:0xf
  s_nop 1
  v_add_f32_dpp v9, v9, v9 row_ror:2 row_mask:0xf bank_mask:0xf
  s_nop 1
  v_add_f32_dpp v9, v9, v9 row_ror:4 row_mask:0xf bank_mask:0xf
  s_nop 1
  v_add_f32_dpp v9, v9, v9 row_ror:8 row_mask:0xf bank_mask:0xf
  s_nop 1
  v_mov_b32 v10, v9
  s_nop 1
  v_permlane32_swap_b32 v9, v10
  v_add_f32 v9, v9, v10
  v_mov_b32 v10, v9
  s_nop 1
  v_permlane16_swap_b32 v9, v10
  v_add_f32 v9, v9, v10
  v_cmp_eq_u32 vcc, 8, v0
  s_nop 1
  v_cndmask_b32 v20, v20, v9, vcc
  s_waitcnt vmcnt(6)
  v_dot2_f32_bf16 v8, v68, v4, 0
  s_nop 2
  v_dot2_f32_bf16 v8, v69, v5, v8
  v_dot2_f32_bf16 v8, v70, v6, v8
  v_dot2_f32_bf16 v8, v71, v7, v8
  s_nop 2
  v_mov_b32 v9, v8
  s_nop 1
  v_add_f32_dpp v9, v9, v9 row_ror:1 row_mask:0xf bank_mask:0xf
  s_nop 1
  v_add_f32_dpp v9, v9, v9 row_ror:2 row_mask:0xf bank_mask:0xf
  s_nop 1
  v_add_f32_dpp v9, v9, v9 row_ror:4 row_mask:0xf bank_mask:0xf
  s_nop 1
  v_add_f32_dpp v9, v9, v9 row_ror:8 row_mask:0xf bank_mask:0xf
  s_nop 1
  v_mov_b32 v10, v9
  s_nop 1
  v_permlane32_swap_b32 v9, v10
  v_add_f32 v9, v9, v10
  v_mov_b32 v10, v9
  s_nop 1
  v_permlane16_swap_b32 v9, v10
  v_add_f32 v9, v9, v10
  v_cmp_eq_u32 vcc, 9, v0
  s_nop 1
  v_cndmask_b32 v20, v20, v9, vcc
  s_waitcnt vmcnt(5)
  v_dot2_f32_bf16 v8, v72, v4, 0
  s_nop 2
  v_dot2_f32_bf16 v8, v73, v5, v8
  v_dot2_f32_bf16 v8, v74, v6, v8
  v_dot2_f32_bf16 v8, v75, v7, v8
  s_nop 2
  v_mov_b32 v9, v8
  s_nop 1
  v_add_f32_dpp v9, v9, v9 row_ror:1 row_mask:0xf bank_mask:0xf
  s_nop 1
  v_add_f32_dpp v9, v9, v9 row_ror:2 row_mask:0xf bank_mask:0xf
  s_nop 1
  v_add_f32_dpp v9, v9, v9 row_ror:4 row_mask:0xf bank_mask:0xf
  s_nop 1
  v_add_f32_dpp v9, v9, v9 row_ror:8 row_mask:0xf bank_mask:0xf
  s_nop 1
  v_mov_b32 v10, v9
  s_nop 1
  v_permlane32_swap_b32 v9, v10
  v_add_f32 v9, v9, v10
  v_mov_b32 v10, v9
  s_nop 1
  v_permlane16_swap_b32 v9, v10
  v_add_f32 v9, v9, v10
  v_cmp_eq_u32 vcc, 10, v0
  s_nop 1
  v_cndmask_b32 v20, v20, v9, vcc
  s_waitcnt vmcnt(4)
  v_dot2_f32_bf16 v8, v76, v4, 0
  s_nop 2
  v_dot2_f32_bf16 v8, v77, v5, v8
  v_dot2_f32_bf16 v8, v78, v6, v8
  v_dot2_f32_bf16 v8, v79, v7, v8
  s_nop 2
  v_mov_b32 v9, v8
  s_nop 1
  v_add_f32_dpp v9, v9, v9 row_ror:1 row_mask:0xf bank_mask:0xf
  s_nop 1
  v_add_f32_dpp v9, v9, v9 row_ror:2 row_mask:0xf bank_mask:0xf
  s_nop 1
  v_add_f32_dpp v9, v9, v9 row_ror:4 row_mask:0xf bank_mask:0xf
  s_nop 1
  v_add_f32_dpp v9, v9, v9 row_ror:8 row_mask:0xf bank_mask:0xf
  s_nop 1
  v_mov_b32 v10, v9
  s_nop 1
  v_permlane32_swap_b32 v9, v10
  v_add_f32 v9, v9, v10
  v_mov_b32 v10, v9
  s_nop 1
  v_permlane16_swap_b32 v9, v10
  v_add_f32 v9, v9, v10
  v_cmp_eq_u32 vcc, 11, v0
  s_nop 1
  v_cndmask_b32 v20, v20, v9, vcc
  s_waitcnt vmcnt(3)
  v_dot2_f32_bf16 v8, v80, v4, 0
  s_nop 2
  v_dot2_f32_bf16 v8, v81, v5, v8
  v_dot2_f32_bf16 v8, v82, v6, v8
  v_dot2_f32_bf16 v8, v83, v7, v8
  s_nop 2
  v_mov_b32 v9, v8
  s_nop 1
  v_add_f32_dpp v9, v9, v9 row_ror:1 row_mask:0xf bank_mask:0xf
  s_nop 1
  v_add_f32_dpp v9, v9, v9 row_ror:2 row_mask:0xf bank_mask:0xf
  s_nop 1
  v_add_f32_dpp v9, v9, v9 row_ror:4 row_mask:0xf bank_mask:0xf
  s_nop 1
  v_add_f32_dpp v9, v9, v9 row_ror:8 row_mask:0xf bank_mask:0xf
  s_nop 1
  v_mov_b32 v10, v9
  s_nop 1
  v_permlane32_swap_b32 v9, v10
  v_add_f32 v9, v9, v10
  v_mov_b32 v10, v9
  s_nop 1
  v_permlane16_swap_b32 v9, v10
  v_add_f32 v9, v9, v10
  v_cmp_eq_u32 vcc, 12, v0
  s_nop 1
  v_cndmask_b32 v20, v20, v9, vcc
  s_waitcnt vmcnt(2)
  v_dot2_f32_bf16 v8, v84, v4, 0
  s_nop 2
  v_dot2_f32_bf16 v8, v85, v5, v8
  v_dot2_f32_bf16 v8, v86, v6, v8
  v_dot2_f32_bf16 v8, v87, v7, v8
  s_nop 2
  v_mov_b32 v9, v8
  s_nop 1
  v_add_f32_dpp v9, v9, v9 row_ror:1 row_mask:0xf bank_mask:0xf
  s_nop 1
  v_add_f32_dpp v9, v9, v9 row_ror:2 row_mask:0xf bank_mask:0xf
  s_nop 1
  v_add_f32_dpp v9, v9, v9 row_ror:4 row_mask:0xf bank_mask:0xf
  s_nop 1
  v_add_f32_dpp v9, v9, v9 row_ror:8 row_mask:0xf bank_mask:0xf
  s_nop 1
  v_mov_b32 v10, v9
  s_nop 1
  v_permlane32_swap_b32 v9, v10
  v_add_f32 v9, v9, v10
  v_mov_b32 v10, v9
  s_nop 1
  v_permlane16_swap_b32 v9, v10
  v_add_f32 v9, v9, v10
  v_cmp_eq_u32 vcc, 13, v0
  s_nop 1
  v_cndmask_b32 v20, v20, v9, vcc
  s_waitcnt vmcnt(1)
  v_dot2_f32_bf16 v8, v88, v4, 0
  s_nop 2
  v_dot2_f32_bf16 v8, v89, v5, v8
  v_dot2_f32_bf16 v8, v90, v6, v8
  v_dot2_f32_bf16 v8, v91, v7, v8
  s_nop 2
  v_mov_b32 v9, v8
  s_nop 1
  v_add_f32_dpp v9, v9, v9 row_ror:1 row_mask:0xf bank_mask:0xf
  s_nop 1
  v_add_f32_dpp v9, v9, v9 row_ror:2 row_mask:0xf bank_mask:0xf
  s_nop 1
  v_add_f32_dpp v9, v9, v9 row_ror:4 row_mask:0xf bank_mask:0xf
  s_nop 1
  v_add_f32_dpp v9, v9, v9 row_ror:8 row_mask:0xf bank_mask:0xf
  s_nop 1
  v_mov_b32 v10, v9
  s_nop 1
  v_permlane32_swap_b32 v9, v10
  v_add_f32 v9, v9, v10
  v_mov_b32 v10, v9
  s_nop 1
  v_permlane16_swap_b32 v9, v10
  v_add_f32 v9, v9, v10
  v_cmp_eq_u32 vcc, 14, v0
  s_nop 1
  v_cndmask_b32 v20, v20, v9, vcc
  s_waitcnt vmcnt(0)
  v_dot2_f32_bf16 v8, v92, v4, 0
  s_nop 2
  v_dot2_f32_bf16 v8, v93, v5, v8
  v_dot2_f32_bf16 v8, v94, v6, v8
  v_dot2_f32_bf16 v8, v95, v7, v8
  s_nop 2
  v_mov_b32 v9, v8
  s_nop 1
  v_add_f32_dpp v9, v9, v9 row_ror:1 row_mask:0xf bank_mask:0xf
  s_nop 1
  v_add_f32_dpp v9, v9, v9 row_ror:2 row_mask:0xf bank_mask:0xf
  s_nop 1
  v_add_f32_dpp v9, v9, v9 row_ror:4 row_mask:0xf bank_mask:0xf
  s_nop 1
  v_add_f32_dpp v9, v9, v9 row_ror:8 row_mask:0xf bank_mask:0xf
  s_nop 1
  v_mov_b32 v10, v9
  s_nop 1
  v_permlane32_swap_b32 v9, v10
  v_add_f32 v9, v9, v10
  v_mov_b32 v10, v9
  s_nop 1
  v_permlane16_swap_b32 v9, v10
  v_add_f32 v9, v9, v10
  v_cmp_eq_u32 vcc, 15, v0
  s_nop 1
  v_cndmask_b32 v20, v20, v9, vcc
  v_mul_f32 v20, 0xbfb8aa3b, v20
  v_exp_f32 v20, v20
  s_nop 0
  v_add_f32 v20, 1.0, v20
  v_rcp_f32 v20, v20
  v_lshlrev_b32 v21, 2, v0
  s_mov_b64 exec, 0xffff
  buffer_store_dword v20, v21, s[4:7], s38 offen sc1
  s_mov_b64 exec, -1
  s_add_u32 s38, s38, 64
  s_add_u32 s37, s37, 16384
  s_add_u32 s46, s46, 1
  s_cmp_lt_u32 s46, 8
  s_cbranch_scc1 p1_gate_l
p1_fin:
  s_waitcnt vmcnt(0)
  s_barrier
  s_cmp_lg_u32 s33, 0
  s_cbranch_scc1 p1_done
  v_mov_b32 v9, 16
  s_mov_b64 exec, 1
  buffer_store_dword v9, off, s[4:7], s44 sc1
  s_mov_b64 exec, -1
p1_done:
  s_cmp_eq_u32 s3, 1
  s_cbranch_scc0 L_p2b
  v_lshlrev_b32 v1, 4, v0
  v_lshrrev_b32 v2, 4, v0
  v_and_b32 v3, 15, v0
  v_lshrrev_b32 v4, 2, v3
  v_lshlrev_b32 v5, 3, v2
  v_lshl_add_u32 v5, v4, 1, v5
  v_and_b32 v4, 1, v3
  v_add_u32 v5, v5, v4
  v_lshlrev_b32 v5, 4, v5
  v_lshlrev_b32 v4, 2, v2
  v_sub_u32 v6, v3, v4
  s_and_b32 s41, s33, 1
  s_lshl_b32 s41, s41, 4
  v_add_u32 v6, s41, v6
  v_cmp_le_i32 s[72:73], 0, v6
  v_cmp_le_i32 s[74:75], 1, v6
  v_cmp_le_i32 s[76:77], 2, v6
  v_cmp_le_i32 s[78:79], 3, v6
  v_cmp_le_i32 s[80:81], 16, v6
  v_cmp_le_i32 s[82:83], 17, v6
  v_cmp_le_i32 s[84:85], 18, v6
  v_cmp_le_i32 s[86:87], 19, v6
  v_mov_b32 v7, 0xff800000
  s_mov_b32 s43, 0x3e0293ee
  v_and_b32 v8, 1, v0
  v_lshrrev_b32 v9, 1, v0
  v_min_u32 v9, 2, v9
  v_lshlrev_b32 v9, 6, v9
  v_add_u32 v8, v8, v9
  v_lshlrev_b32 v8, 6, v8
  s_lshl_b32 s41, s32, 7
  s_add_u32 s39, s41, 85200896
  v_mov_b32 v10, 0
  v_lshlrev_b32 v172, 3, v0
  v_lshlrev_b32 v173, 2, v0
  v_mov_b32 v249, 0
  v_mov_b32 v250, 0
  s_mov_b32 s40, 0
p2a_p1_9:
  buffer_load_dword v11, v8, s[4:7], s39 offen sc1
  s_add_u32 s40, s40, 1
  s_cmp_gt_u32 s40, 1048576
  s_cbranch_scc1 p2a_p1_9_d
  s_waitcnt vmcnt(0)
  v_cmp_gt_u32 vcc, 16, v11
  s_cbranch_vccz p2a_p1_9_d
  s_sleep 2
  s_branch p2a_p1_9
p2a_p1_9_d:
  s_lshr_b32 s34, s33, 1
  s_lshl_b32 s39, s32, 7
  s_add_u32 s39, s39, 85196800
  s_mov_b32 s44, 0
p2a_loop:
  s_lshl_b32 s41, s34, 5
  s_add_u32 s41, s41, s32
  s_lshl_b32 s35, s41, 13
  s_lshl_b32 s36, s41, 11
  s_add_u32 s36, s36, 75497472
  s_and_b32 s42, s33, 1
  s_lshl_b32 s41, s34, 1
  s_add_u32 s41, s41, s42
  s_lshl_b32 s41, s41, 5
  s_add_u32 s41, s41, s32
  s_lshl_b32 s38, s41, 2
  s_add_u32 s38, s38, 85217280
  s_lshl_b32 s37, s41, 12
  s_add_u32 s37, s37, 50331648
  s_lshl_b32 s42, s42, 12
  s_add_u32 s41, s35, s42
  s_add_u32 s41, s41, 0
  buffer_load_dwordx4 v[32:35], v1, s[4:7], s41 offen offset:0 sc1
  buffer_load_dwordx4 v[36:39], v1, s[4:7], s41 offen offset:1024 sc1
  buffer_load_dwordx4 v[40:43], v1, s[4:7], s41 offen offset:2048 sc1
  buffer_load_dwordx4 v[44:47], v1, s[4:7], s41 offen offset:3072 sc1
  s_add_u32 s41, s35, 16777216
  buffer_load_dwordx4 v[64:67], v1, s[4:7], s41 offen offset:0 sc1
  buffer_load_dwordx4 v[68:71], v1, s[4:7], s41 offen offset:1024 sc1
  buffer_load_dwordx4 v[72:75], v1, s[4:7], s41 offen offset:2048 sc1
  buffer_load_dwordx4 v[76:79], v1, s[4:7], s41 offen offset:3072 sc1
  s_add_u32 s41, s35, 16781312
  buffer_load_dwordx4 v[80:83], v1, s[4:7], s41 offen offset:0 sc1
  buffer_load_dwordx4 v[84:87], v1, s[4:7], s41 offen offset:1024 sc1
  buffer_load_dwordx4 v[88:91], v1, s[4:7], s41 offen offset:2048 sc1
  buffer_load_dwordx4 v[92:95], v1, s[4:7], s41 offen offset:3072 sc1
  s_add_u32 s41, s35, 33554432
  buffer_load_dwordx4 v[96:99], v1, s[4:7], s41 offen offset:0 sc1
  buffer_load_dwordx4 v[100:103], v1, s[4:7], s41 offen offset:1024 sc1
  buffer_load_dwordx4 v[104:107], v1, s[4:7], s41 offen offset:2048 sc1
  buffer_load_dwordx4 v[108:111], v1, s[4:7], s41 offen offset:3072 sc1
  s_add_u32 s41, s35, 33558528
  buffer_load_dwordx4 v[112:115], v1, s[4:7], s41 offen offset:0 sc1
  buffer_load_dwordx4 v[116:119], v1, s[4:7], s41 offen offset:1024 sc1
  buffer_load_dwordx4 v[120:123], v1, s[4:7], s41 offen offset:2048 sc1
  buffer_load_dwordx4 v[124:127], v1, s[4:7], s41 offen offset:3072 sc1
  s_add_u32 s50, s36, 4194304
  s_waitcnt vmcnt(8)
  v_mfma_f32_16x16x32_bf16 v[152:155], v[64:67], v[32:35], 0
  v_mfma_f32_16x16x32_bf16 v[156:159], v[80:83], v[32:35], 0
  v_mfma_f32_16x16x32_bf16 v[152:155], v[68:71], v[36:39], v[152:155]
  v_mfma_f32_16x16x32_bf16 v[156:159], v[84:87], v[36:39], v[156:159]
  v_mfma_f32_16x16x32_bf16 v[152:155], v[72:75], v[40:43], v[152:155]
  v_mfma_f32_16x16x32_bf16 v[156:159], v[88:91], v[40:43], v[156:159]
  v_mfma_f32_16x16x32_bf16 v[152:155], v[76:79], v[44:47], v[152:155]
  v_mfma_f32_16x16x32_bf16 v[156:159], v[92:95], v[44:47], v[156:159]
  s_cmp_lt_u32 s34, s44
  s_cbranch_scc1 p2a_have
  s_add_u32 s42, s34, 1
  s_mov_b32 s40, 0
p2a_ch_10:
  buffer_load_dword v11, v10, s[4:7], s39 offen sc1
  s_add_u32 s40, s40, 1
  s_cmp_gt_u32 s40, 1048576
  s_cbranch_scc1 p2a_ch_10_d
  s_waitcnt vmcnt(0)
  v_cmp_gt_u32 vcc, s42, v11
  s_cbranch_vccz p2a_ch_10_d
  s_sleep 2
  s_branch p2a_ch_10
p2a_ch_10_d:
  s_waitcnt vmcnt(0)
  v_readfirstlane_b32 s44, v11
p2a_have:
  buffer_load_dwordx4 v[128:131], v5, s[4:7], s36 offen offset:0 sc1
  buffer_load_dwordx4 v[132:135], v5, s[4:7], s36 offen offset:512 sc1
  buffer_load_dwordx4 v[136:139], v5, s[4:7], s36 offen offset:1024 sc1
  buffer_load_dwordx4 v[140:143], v5, s[4:7], s36 offen offset:1536 sc1
  buffer_load_dwordx4 v[144:147], v1, s[4:7], s50 offen sc1
  buffer_load_dwordx2 v[148:149], v172, s[4:7], s50 offen offset:1024 sc1
  buffer_load_dword v150, v173, s[4:7], s50 offen offset:1536 sc1
  buffer_load_dword v151, v173, s[4:7], s50 offen offset:1792 sc1
  v_cndmask_b32 v152, v7, v152, s[72:73]
  v_cndmask_b32 v153, v7, v153, s[74:75]
  v_cndmask_b32 v154, v7, v154, s[76:77]
  v_cndmask_b32 v155, v7, v155, s[78:79]
  v_cndmask_b32 v156, v7, v156, s[80:81]
  v_cndmask_b32 v157, v7, v157, s[82:83]
  v_cndmask_b32 v158, v7, v158, s[84:85]
  v_cndmask_b32 v159, v7, v159, s[86:87]
  v_max3_f32 v12, v152, v153, v154
  v_max3_f32 v12, v12, v155, v156
  v_max3_f32 v12, v12, v157, v158
  v_max_f32 v12, v12, v159
  s_waitcnt vmcnt(7)
  v_mfma_f32_16x16x32_bf16 v[160:163], v[128:131], v[32:35], 0
  s_waitcnt vmcnt(6)
  v_mfma_f32_16x16x32_bf16 v[160:163], v[132:135], v[36:39], v[160:163]
  s_waitcnt vmcnt(5)
  v_mfma_f32_16x16x32_bf16 v[160:163], v[136:139], v[40:43], v[160:163]
  s_waitcnt vmcnt(4)
  v_mfma_f32_16x16x32_bf16 v[160:163], v[140:143], v[44:47], v[160:163]
  s_nop 7
  v_max3_f32 v14, v12, v160, v161
  v_max3_f32 v12, v12, v160, v161
  s_nop 1
  v_permlane32_swap_b32 v12, v14
  v_max_f32 v13, v12, v14
  v_max_f32 v12, v12, v14
  s_nop 1
  v_permlane16_swap_b32 v12, v13
  v_max_f32 v12, v12, v13
  v_mul_f32 v12, s43, v12
  v_fma_f32 v152, v152, s43, -v12
  v_fma_f32 v153, v153, s43, -v12
  v_fma_f32 v154, v154, s43, -v12
  v_fma_f32 v155, v155, s43, -v12
  v_fma_f32 v156, v156, s43, -v12
  v_fma_f32 v157, v157, s43, -v12
  v_fma_f32 v158, v158, s43, -v12
  v_fma_f32 v159, v159, s43, -v12
  v_fma_f32 v160, v160, s43, -v12
  v_fma_f32 v161, v161, s43, -v12
  v_exp_f32 v152, v152
  v_exp_f32 v153, v153
  v_exp_f32 v154, v154
  v_exp_f32 v155, v155
  v_exp_f32 v156, v156
  v_exp_f32 v157, v157
  v_exp_f32 v158, v158
  v_exp_f32 v159, v159
  v_exp_f32 v160, v160
  v_exp_f32 v161, v161
  v_cvt_pk_bf16_f32 v240, v152, v153
  v_cvt_pk_bf16_f32 v241, v154, v155
  v_cvt_pk_bf16_f32 v242, v156, v157
  v_cvt_pk_bf16_f32 v243, v158, v159
  v_cvt_pk_bf16_f32 v248, v160, v161
  v_cvt_pk_bf16_f32 v251, v160, v161
  s_waitcnt vmcnt(0)
  v_mfma_f32_16x16x32_bf16 v[176:179], v[96:99], v[240:243], 0
  v_add_f32 v12, v152, v153
  v_add_f32 v13, v154, v155
  v_mfma_f32_16x16x32_bf16 v[180:183], v[100:103], v[240:243], 0
  v_add_f32 v12, v12, v156
  v_add_f32 v13, v13, v157
  v_mfma_f32_16x16x32_bf16 v[184:187], v[104:107], v[240:243], 0
  v_add_f32 v12, v12, v158
  v_add_f32 v13, v13, v159
  v_mfma_f32_16x16x32_bf16 v[188:191], v[108:111], v[240:243], 0
  v_add_f32 v12, v12, v160
  v_add_f32 v13, v13, v161
  v_mfma_f32_16x16x16_bf16 v[176:179], v[144:145], v[248:249], v[176:179]
  v_add_f32 v14, v12, v13
  v_add_f32 v12, v12, v13
  v_mfma_f32_16x16x16_bf16 v[180:183], v[144:145], v[250:251], v[180:183]
  s_nop 0
  v_permlane32_swap_b32 v12, v14
  v_mfma_f32_16x16x16_bf16 v[184:187], v[146:147], v[248:249], v[184:187]
  v_add_f32 v13, v12, v14
  v_add_f32 v12, v12, v14
  v_mfma_f32_16x16x16_bf16 v[188:191], v[146:147], v[250:251], v[188:191]
  s_nop 0
  v_permlane16_swap_b32 v12, v13
  v_mfma_f32_16x16x32_bf16 v[192:195], v[112:115], v[240:243], 0
  v_add_f32 v12, v12, v13
  v_mfma_f32_16x16x32_bf16 v[196:199], v[116:119], v[240:243], 0
  v_rcp_f32 v12, v12
  v_mfma_f32_16x16x32_bf16 v[200:203], v[120:123], v[240:243], 0
  v_mul_f32 v176, v12, v176
  v_mul_f32 v177, v12, v177
  v_mfma_f32_16x16x32_bf16 v[204:207], v[124:127], v[240:243], 0
  v_mul_f32 v178, v12, v178
  v_mul_f32 v179, v12, v179
  v_mfma_f32_16x16x16_bf16 v[192:195], v[148:149], v[248:249], v[192:195]
  v_cvt_pk_bf16_f32 v16, v176, v177
  v_cvt_pk_bf16_f32 v17, v178, v179
  v_mfma_f32_16x16x16_bf16 v[196:199], v[148:149], v[250:251], v[196:199]
  v_mul_f32 v180, v12, v180
  v_mul_f32 v181, v12, v181
  v_mfma_f32_16x16x16_bf16 v[200:203], v[150:151], v[248:249], v[200:203]
  v_mul_f32 v182, v12, v182
  v_mul_f32 v183, v12, v183
  v_mfma_f32_16x16x16_bf16 v[204:207], v[150:151], v[250:251], v[204:207]
  v_cvt_pk_bf16_f32 v18, v180, v181
  v_cvt_pk_bf16_f32 v19, v182, v183
  buffer_store_dwordx4 v[16:19], v1, s[4:7], s37 offen offset:0 sc1
  v_mul_f32 v184, v12, v184
  v_mul_f32 v185, v12, v185
  v_mul_f32 v186, v12, v186
  v_mul_f32 v187, v12, v187
  v_cvt_pk_bf16_f32 v20, v184, v185
  v_cvt_pk_bf16_f32 v21, v186, v187
  v_mul_f32 v188, v12, v188
  v_mul_f32 v189, v12, v189
  v_mul_f32 v190, v12, v190
  v_mul_f32 v191, v12, v191
  v_cvt_pk_bf16_f32 v22, v188, v189
  v_cvt_pk_bf16_f32 v23, v190, v191
  buffer_store_dwordx4 v[20:23], v1, s[4:7], s37 offen offset:1024 sc1
  v_mul_f32 v192, v12, v192
  v_mul_f32 v193, v12, v193
  v_mul_f32 v194, v12, v194
  v_mul_f32 v195, v12, v195
  v_cvt_pk_bf16_f32 v24, v192, v193
  v_cvt_pk_bf16_f32 v25, v194, v195
  v_mul_f32 v196, v12, v196
  v_mul_f32 v197, v12, v197
  v_mul_f32 v198, v12, v198
  v_mul_f32 v199, v12, v199
  v_cvt_pk_bf16_f32 v26, v196, v197
  v_cvt_pk_bf16_f32 v27, v198, v199
  buffer_store_dwordx4 v[24:27], v1, s[4:7], s37 offen offset:2048 sc1
  v_mul_f32 v200, v12, v200
  v_mul_f32 v201, v12, v201
  v_mul_f32 v202, v12, v202
  v_mul_f32 v203, v12, v203
  v_cvt_pk_bf16_f32 v28, v200, v201
  v_cvt_pk_bf16_f32 v29, v202, v203
  v_mul_f32 v204, v12, v204
  v_mul_f32 v205, v12, v205
  v_mul_f32 v206, v12, v206
  v_mul_f32 v207, v12, v207
  v_cvt_pk_bf16_f32 v30, v204, v205
  v_cvt_pk_bf16_f32 v31, v206, v207
  buffer_store_dwordx4 v[28:31], v1, s[4:7], s37 offen offset:3072 sc1
  v_mov_b32 v11, 1
  s_waitcnt vmcnt(0)
  s_mov_b64 exec, 1
  buffer_store_dword v11, off, s[4:7], s38 sc1
  s_mov_b64 exec, -1
  s_add_u32 s34, s34, 2
  s_cmp_lt_u32 s34, 64
  s_cbranch_scc1 p2a_loop
  s_endpgm
L_p2b:
  s_mov_b32 s12, s74
  s_and_b32 s13, s75, 0xffff
  s_mov_b32 s14, 0x400000
  s_mov_b32 s15, 0x00020000
  s_mov_b32 s16, s84
  s_and_b32 s17, s85, 0xffff
  s_mov_b32 s18, 0x1c0000
  s_mov_b32 s19, 0x00020000
  s_mov_b32 s20, s86
  s_and_b32 s21, s87, 0xffff
  s_mov_b32 s22, 0x400
  s_mov_b32 s23, 0x00020000
  s_mov_b32 s24, s90
  s_and_b32 s25, s91, 0xffff
  s_mov_b32 s26, 0x200000
  s_mov_b32 s27, 0x00020000
  v_lshrrev_b32 v1, 1, v0
  v_lshlrev_b32 v1, 10, v1
  v_and_b32 v2, 1, v0
  v_lshl_add_u32 v1, v2, 4, v1
  s_lshl_b32 s41, s32, 5
  v_add_u32 v1, s41, v1
  s_mul_i32 s51, s33, 40960
  v_lshlrev_b32 v2, 3, v0
  v_add_u32 v2, s51, v2
  s_lshl_b32 s41, s33, 20
  s_add_u32 m0, s51, 0
  s_nop 0
  buffer_load_dwordx4 v1, s[12:15], s41 offen lds
  s_add_u32 s41, s41, 32768
  s_add_u32 m0, s51, 1024
  s_nop 0
  buffer_load_dwordx4 v1, s[12:15], s41 offen lds
  s_add_u32 s41, s41, 32768
  s_add_u32 m0, s51, 2048
  s_nop 0
  buffer_load_dwordx4 v1, s[12:15], s41 offen lds
  s_add_u32 s41, s41, 32768
  s_add_u32 m0, s51, 3072
  s_nop 0
  buffer_load_dwordx4 v1, s[12:15], s41 offen lds
  s_add_u32 s41, s41, 32768
  s_add_u32 m0, s51, 4096
  s_nop 0
  buffer_load_dwordx4 v1, s[12:15], s41 offen lds
  s_add_u32 s41, s41, 32768
  s_add_u32 m0, s51, 5120
  s_nop 0
  buffer_load_dwordx4 v1, s[12:15], s41 offen lds
  s_add_u32 s41, s41, 32768
  s_add_u32 m0, s51, 6144
  s_nop 0
  buffer_load_dwordx4 v1, s[12:15], s41 offen lds
  s_add_u32 s41, s41, 32768
  s_add_u32 m0, s51, 7168
  s_nop 0
  buffer_load_dwordx4 v1, s[12:15], s41 offen lds
  s_add_u32 s41, s41, 32768
  s_add_u32 m0, s51, 8192
  s_nop 0
  buffer_load_dwordx4 v1, s[12:15], s41 offen lds
  s_add_u32 s41, s41, 32768
  s_add_u32 m0, s51, 9216
  s_nop 0
  buffer_load_dwordx4 v1, s[12:15], s41 offen lds
  s_add_u32 s41, s41, 32768
  s_add_u32 m0, s51, 10240
  s_nop 0
  buffer_load_dwordx4 v1, s[12:15], s41 offen lds
  s_add_u32 s41, s41, 32768
  s_add_u32 m0, s51, 11264
  s_nop 0
  buffer_load_dwordx4 v1, s[12:15], s41 offen lds
  s_add_u32 s41, s41, 32768
  s_add_u32 m0, s51, 12288
  s_nop 0
  buffer_load_dwordx4 v1, s[12:15], s41 offen lds
  s_add_u32 s41, s41, 32768
  s_add_u32 m0, s51, 13312
  s_nop 0
  buffer_load_dwordx4 v1, s[12:15], s41 offen lds
  s_add_u32 s41, s41, 32768
  s_add_u32 m0, s51, 14336
  s_nop 0
  buffer_load_dwordx4 v1, s[12:15], s41 offen lds
  s_add_u32 s41, s41, 32768
  s_add_u32 m0, s51, 15360
  s_nop 0
  buffer_load_dwordx4 v1, s[12:15], s41 offen lds
  s_add_u32 s41, s41, 32768
  s_add_u32 m0, s51, 16384
  s_nop 0
  buffer_load_dwordx4 v1, s[12:15], s41 offen lds
  s_add_u32 s41, s41, 32768
  s_add_u32 m0, s51, 17408
  s_nop 0
  buffer_load_dwordx4 v1, s[12:15], s41 offen lds
  s_add_u32 s41, s41, 32768
  s_add_u32 m0, s51, 18432
  s_nop 0
  buffer_load_dwordx4 v1, s[12:15], s41 offen lds
  s_add_u32 s41, s41, 32768
  s_add_u32 m0, s51, 19456
  s_nop 0
  buffer_load_dwordx4 v1, s[12:15], s41 offen lds
  s_add_u32 s41, s41, 32768
  s_add_u32 m0, s51, 20480
  s_nop 0
  buffer_load_dwordx4 v1, s[12:15], s41 offen lds
  s_add_u32 s41, s41, 32768
  s_add_u32 m0, s51, 21504
  s_nop 0
  buffer_load_dwordx4 v1, s[12:15], s41 offen lds
  s_add_u32 s41, s41, 32768
  s_add_u32 m0, s51, 22528
  s_nop 0
  buffer_load_dwordx4 v1, s[12:15], s41 offen lds
  s_add_u32 s41, s41, 32768
  s_add_u32 m0, s51, 23552
  s_nop 0
  buffer_load_dwordx4 v1, s[12:15], s41 offen lds
  s_add_u32 s41, s41, 32768
  s_add_u32 m0, s51, 24576
  s_nop 0
  buffer_load_dwordx4 v1, s[12:15], s41 offen lds
  s_add_u32 s41, s41, 32768
  s_add_u32 m0, s51, 25600
  s_nop 0
  buffer_load_dwordx4 v1, s[12:15], s41 offen lds
  s_add_u32 s41, s41, 32768
  s_add_u32 m0, s51, 26624
  s_nop 0
  buffer_load_dwordx4 v1, s[12:15], s41 offen lds
  s_add_u32 s41, s41, 32768
  s_add_u32 m0, s51, 27648
  s_nop 0
  buffer_load_dwordx4 v1, s[12:15], s41 offen lds
  s_add_u32 s41, s41, 32768
  s_add_u32 m0, s51, 28672
  s_nop 0
  buffer_load_dwordx4 v1, s[12:15], s41 offen lds
  s_add_u32 s41, s41, 32768
  s_add_u32 m0, s51, 29696
  s_nop 0
  buffer_load_dwordx4 v1, s[12:15], s41 offen lds
  s_add_u32 s41, s41, 32768
  s_add_u32 m0, s51, 30720
  s_nop 0
  buffer_load_dwordx4 v1, s[12:15], s41 offen lds
  s_add_u32 s41, s41, 32768
  s_add_u32 m0, s51, 31744
  s_nop 0
  buffer_load_dwordx4 v1, s[12:15], s41 offen lds
  s_add_u32 s41, s41, 32768
  s_waitcnt vmcnt(0)
  ds_read_b64_tr_b16 a[0:1], v2 offset:0
  ds_read_b64_tr_b16 a[2:3], v2 offset:512
  ds_read_b64_tr_b16 a[4:5], v2 offset:1024
  ds_read_b64_tr_b16 a[6:7], v2 offset:1536
  ds_read_b64_tr_b16 a[8:9], v2 offset:2048
  ds_read_b64_tr_b16 a[10:11], v2 offset:2560
  ds_read_b64_tr_b16 a[12:13], v2 offset:3072
  ds_read_b64_tr_b16 a[14:15], v2 offset:3584
  ds_read_b64_tr_b16 a[16:17], v2 offset:4096
  ds_read_b64_tr_b16 a[18:19], v2 offset:4608
  ds_read_b64_tr_b16 a[20:21], v2 offset:5120
  ds_read_b64_tr_b16 a[22:23], v2 offset:5632
  ds_read_b64_tr_b16 a[24:25], v2 offset:6144
  ds_read_b64_tr_b16 a[26:27], v2 offset:6656
  ds_read_b64_tr_b16 a[28:29], v2 offset:7168
  ds_read_b64_tr_b16 a[30:31], v2 offset:7680
  ds_read_b64_tr_b16 a[32:33], v2 offset:8192
  ds_read_b64_tr_b16 a[34:35], v2 offset:8704
  ds_read_b64_tr_b16 a[36:37], v2 offset:9216
  ds_read_b64_tr_b16 a[38:39], v2 offset:9728
  ds_read_b64_tr_b16 a[40:41], v2 offset:10240
  ds_read_b64_tr_b16 a[42:43], v2 offset:10752
  ds_read_b64_tr_b16 a[44:45], v2 offset:11264
  ds_read_b64_tr_b16 a[46:47], v2 offset:11776
  ds_read_b64_tr_b16 a[48:49], v2 offset:12288
  ds_read_b64_tr_b16 a[50:51], v2 offset:12800
  ds_read_b64_tr_b16 a[52:53], v2 offset:13312
  ds_read_b64_tr_b16 a[54:55], v2 offset:13824
  ds_read_b64_tr_b16 a[56:57], v2 offset:14336
  ds_read_b64_tr_b16 a[58:59], v2 offset:14848
  ds_read_b64_tr_b16 a[60:61], v2 offset:15360
  ds_read_b64_tr_b16 a[62:63], v2 offset:15872
  ds_read_b64_tr_b16 a[64:65], v2 offset:16384
  ds_read_b64_tr_b16 a[66:67], v2 offset:16896
  ds_read_b64_tr_b16 a[68:69], v2 offset:17408
  ds_read_b64_tr_b16 a[70:71], v2 offset:17920
  ds_read_b64_tr_b16 a[72:73], v2 offset:18432
  ds_read_b64_tr_b16 a[74:75], v2 offset:18944
  ds_read_b64_tr_b16 a[76:77], v2 offset:19456
  ds_read_b64_tr_b16 a[78:79], v2 offset:19968
  ds_read_b64_tr_b16 a[80:81], v2 offset:20480
  ds_read_b64_tr_b16 a[82:83], v2 offset:20992
  ds_read_b64_tr_b16 a[84:85], v2 offset:21504
  ds_read_b64_tr_b16 a[86:87], v2 offset:22016
  ds_read_b64_tr_b16 a[88:89], v2 offset:22528
  ds_read_b64_tr_b16 a[90:91], v2 offset:23040
  ds_read_b64_tr_b16 a[92:93], v2 offset:23552
  ds_read_b64_tr_b16 a[94:95], v2 offset:24064
  ds_read_b64_tr_b16 a[96:97], v2 offset:24576
  ds_read_b64_tr_b16 a[98:99], v2 offset:25088
  ds_read_b64_tr_b16 a[100:101], v2 offset:25600
  ds_read_b64_tr_b16 a[102:103], v2 offset:26112
  ds_read_b64_tr_b16 a[104:105], v2 offset:26624
  ds_read_b64_tr_b16 a[106:107], v2 offset:27136
  ds_read_b64_tr_b16 a[108:109], v2 offset:27648
  ds_read_b64_tr_b16 a[110:111], v2 offset:28160
  ds_read_b64_tr_b16 a[112:113], v2 offset:28672
  ds_read_b64_tr_b16 a[114:115], v2 offset:29184
  ds_read_b64_tr_b16 a[116:117], v2 offset:29696
  ds_read_b64_tr_b16 a[118:119], v2 offset:30208
  ds_read_b64_tr_b16 a[120:121], v2 offset:30720
  ds_read_b64_tr_b16 a[122:123], v2 offset:31232
  ds_read_b64_tr_b16 a[124:125], v2 offset:31744
  ds_read_b64_tr_b16 a[126:127], v2 offset:32256
  s_waitcnt lgkmcnt(0)
  s_mul_i32 s41, s33, 458752
  s_add_u32 m0, s51, 0
  s_nop 0
  buffer_load_dwordx4 v1, s[16:19], s41 offen lds
  s_add_u32 s41, s41, 32768
  s_add_u32 m0, s51, 1024
  s_nop 0
  buffer_load_dwordx4 v1, s[16:19], s41 offen lds
  s_add_u32 s41, s41, 32768
  s_add_u32 m0, s51, 2048
  s_nop 0
  buffer_load_dwordx4 v1, s[16:19], s41 offen lds
  s_add_u32 s41, s41, 32768
  s_add_u32 m0, s51, 3072
  s_nop 0
  buffer_load_dwordx4 v1, s[16:19], s41 offen lds
  s_add_u32 s41, s41, 32768
  s_add_u32 m0, s51, 4096
  s_nop 0
  buffer_load_dwordx4 v1, s[16:19], s41 offen lds
  s_add_u32 s41, s41, 32768
  s_add_u32 m0, s51, 5120
  s_nop 0
  buffer_load_dwordx4 v1, s[16:19], s41 offen lds
  s_add_u32 s41, s41, 32768
  s_add_u32 m0, s51, 6144
  s_nop 0
  buffer_load_dwordx4 v1, s[16:19], s41 offen lds
  s_add_u32 s41, s41, 32768
  s_add_u32 m0, s51, 7168
  s_nop 0
  buffer_load_dwordx4 v1, s[16:19], s41 offen lds
  s_add_u32 s41, s41, 32768
  s_add_u32 m0, s51, 8192
  s_nop 0
  buffer_load_dwordx4 v1, s[16:19], s41 offen lds
  s_add_u32 s41, s41, 32768
  s_add_u32 m0, s51, 9216
  s_nop 0
  buffer_load_dwordx4 v1, s[16:19], s41 offen lds
  s_add_u32 s41, s41, 32768
  s_add_u32 m0, s51, 10240
  s_nop 0
  buffer_load_dwordx4 v1, s[16:19], s41 offen lds
  s_add_u32 s41, s41, 32768
  s_add_u32 m0, s51, 11264
  s_nop 0
  buffer_load_dwordx4 v1, s[16:19], s41 offen lds
  s_add_u32 s41, s41, 32768
  s_add_u32 m0, s51, 12288
  s_nop 0
  buffer_load_dwordx4 v1, s[16:19], s41 offen lds
  s_add_u32 s41, s41, 32768
  s_add_u32 m0, s51, 13312
  s_nop 0
  buffer_load_dwordx4 v1, s[16:19], s41 offen lds
  s_add_u32 s41, s41, 32768
  v_lshlrev_b32 v3, 4, v0
  v_lshrrev_b32 v4, 4, v0
  v_and_b32 v5, 15, v0
  v_lshlrev_b32 v6, 2, v5
  v_lshlrev_b32 v7, 10, v5
  v_lshl_add_u32 v7, v4, 3, v7
  v_lshlrev_b32 v8, 3, v4
  s_lshl_b32 s42, s32, 5
  buffer_load_dwordx2 v[10:11], v8, s[20:23], s42 offen
  v_and_b32 v9, 7, v0
  v_lshlrev_b32 v9, 2, v9
  v_min_u32 v16, 31, v0
  v_lshlrev_b32 v16, 6, v16
  s_waitcnt vmcnt(0)
  v_lshlrev_b32 v12, 16, v10
  v_and_b32 v13, 0xffff0000, v10
  v_lshlrev_b32 v14, 16, v11
  v_and_b32 v15, 0xffff0000, v11
  ds_read_b64_tr_b16 a[128:129], v2 offset:0
  ds_read_b64_tr_b16 a[130:131], v2 offset:512
  ds_read_b64_tr_b16 a[132:133], v2 offset:1024
  ds_read_b64_tr_b16 a[134:135], v2 offset:1536
  ds_read_b64_tr_b16 a[136:137], v2 offset:2048
  ds_read_b64_tr_b16 a[138:139], v2 offset:2560
  ds_read_b64_tr_b16 a[140:141], v2 offset:3072
  ds_read_b64_tr_b16 a[142:143], v2 offset:3584
  ds_read_b64_tr_b16 a[144:145], v2 offset:4096
  ds_read_b64_tr_b16 a[146:147], v2 offset:4608
  ds_read_b64_tr_b16 a[148:149], v2 offset:5120
  ds_read_b64_tr_b16 a[150:151], v2 offset:5632
  ds_read_b64_tr_b16 a[152:153], v2 offset:6144
  ds_read_b64_tr_b16 a[154:155], v2 offset:6656
  ds_read_b64_tr_b16 a[156:157], v2 offset:7168
  ds_read_b64_tr_b16 a[158:159], v2 offset:7680
  ds_read_b64_tr_b16 a[160:161], v2 offset:8192
  ds_read_b64_tr_b16 a[162:163], v2 offset:8704
  ds_read_b64_tr_b16 a[164:165], v2 offset:9216
  ds_read_b64_tr_b16 a[166:167], v2 offset:9728
  ds_read_b64_tr_b16 a[168:169], v2 offset:10240
  ds_read_b64_tr_b16 a[170:171], v2 offset:10752
  ds_read_b64_tr_b16 a[172:173], v2 offset:11264
  ds_read_b64_tr_b16 a[174:175], v2 offset:11776
  ds_read_b64_tr_b16 a[176:177], v2 offset:12288
  ds_read_b64_tr_b16 a[178:179], v2 offset:12800
  ds_read_b64_tr_b16 a[180:181], v2 offset:13312
  ds_read_b64_tr_b16 a[182:183], v2 offset:13824
  s_mov_b32 s42, 85213184
  s_mov_b32 s40, 0
p2b_p1_11:
  buffer_load_dword v17, v16, s[4:7], s42 offen sc1
  s_add_u32 s40, s40, 1
  s_cmp_gt_u32 s40, 1048576
  s_cbranch_scc1 p2b_p1_11_d
  s_waitcnt vmcnt(0)
  v_cmp_gt_u32 vcc, 16, v17
  s_cbranch_vccz p2b_p1_11_d
  s_sleep 2
  s_branch p2b_p1_11
p2b_p1_11_d:
  s_waitcnt lgkmcnt(0)
  s_barrier
  s_sub_u32 s34, s3, 2
  s_lshl_b32 s38, s33, 10
  v_add_u32 v18, s38, v3
p2b_loop:
  s_mul_i32 s35, s34, 57344
  s_mul_i32 s41, s33, 14336
  s_add_u32 s35, s35, s41
  s_add_u32 s35, s35, 67108864
  s_lshl_b32 s36, s34, 17
  s_lshl_b32 s41, s33, 15
  s_add_u32 s36, s36, s41
  s_add_u32 s36, s36, 50331648
  s_lshl_b32 s37, s34, 7
  s_lshl_b32 s41, s33, 5
  s_add_u32 s37, s37, s41
  s_add_u32 s37, s37, 85217280
  s_lshl_b32 s42, s34, 6
  s_add_u32 s42, s42, 85262336
  buffer_load_dword v19, v6, s[4:7], s42 offen sc1
  buffer_load_dwordx4 v[64:67], v3, s[4:7], s35 offen offset:0 sc1
  buffer_load_dwordx4 v[68:71], v3, s[4:7], s35 offen offset:1024 sc1
  buffer_load_dwordx4 v[72:75], v3, s[4:7], s35 offen offset:2048 sc1
  buffer_load_dwordx4 v[76:79], v3, s[4:7], s35 offen offset:3072 sc1
  s_add_u32 s35, s35, 4096
  buffer_load_dwordx4 v[80:83], v3, s[4:7], s35 offen offset:0 sc1
  buffer_load_dwordx4 v[84:87], v3, s[4:7], s35 offen offset:1024 sc1
  buffer_load_dwordx4 v[88:91], v3, s[4:7], s35 offen offset:2048 sc1
  buffer_load_dwordx4 v[92:95], v3, s[4:7], s35 offen offset:3072 sc1
  s_add_u32 s35, s35, 4096
  buffer_load_dwordx4 v[96:99], v3, s[4:7], s35 offen offset:0 sc1
  buffer_load_dwordx4 v[100:103], v3, s[4:7], s35 offen offset:1024 sc1
  buffer_load_dwordx4 v[104:107], v3, s[4:7], s35 offen offset:2048 sc1
  buffer_load_dwordx4 v[108:111], v3, s[4:7], s35 offen offset:3072 sc1
  s_add_u32 s35, s35, 4096
  buffer_load_dwordx4 v[112:115], v3, s[4:7], s35 offen offset:0 sc1
  buffer_load_dwordx4 v[116:119], v3, s[4:7], s35 offen offset:1024 sc1
  s_waitcnt vmcnt(13)
  v_mfma_f32_16x16x32_bf16 v[24:27], a[128:131], v[64:67], 0
  s_waitcnt vmcnt(12)
  v_mfma_f32_16x16x32_bf16 v[28:31], a[132:135], v[68:71], 0
  s_waitcnt vmcnt(11)
  v_mfma_f32_16x16x32_bf16 v[24:27], a[136:139], v[72:75], v[24:27]
  s_waitcnt vmcnt(10)
  v_mfma_f32_16x16x32_bf16 v[28:31], a[140:143], v[76:79], v[28:31]
  s_waitcnt vmcnt(9)
  v_mfma_f32_16x16x32_bf16 v[24:27], a[144:147], v[80:83], v[24:27]
  s_waitcnt vmcnt(8)
  v_mfma_f32_16x16x32_bf16 v[28:31], a[148:151], v[84:87], v[28:31]
  s_waitcnt vmcnt(7)
  v_mfma_f32_16x16x32_bf16 v[24:27], a[152:155], v[88:91], v[24:27]
  s_waitcnt vmcnt(6)
  v_mfma_f32_16x16x32_bf16 v[28:31], a[156:159], v[92:95], v[28:31]
  s_waitcnt vmcnt(5)
  v_mfma_f32_16x16x32_bf16 v[24:27], a[160:163], v[96:99], v[24:27]
  s_waitcnt vmcnt(4)
  v_mfma_f32_16x16x32_bf16 v[28:31], a[164:167], v[100:103], v[28:31]
  s_waitcnt vmcnt(3)
  v_mfma_f32_16x16x32_bf16 v[24:27], a[168:171], v[104:107], v[24:27]
  s_waitcnt vmcnt(2)
  v_mfma_f32_16x16x32_bf16 v[28:31], a[172:175], v[108:111], v[28:31]
  s_waitcnt vmcnt(1)
  v_mfma_f32_16x16x32_bf16 v[24:27], a[176:179], v[112:115], v[24:27]
  s_waitcnt vmcnt(0)
  v_mfma_f32_16x16x32_bf16 v[28:31], a[180:183], v[116:119], v[28:31]
  s_nop 7
  v_sub_f32 v20, 1.0, v19
  v_add_f32 v24, v24, v28
  v_mul_f32 v24, v20, v24
  v_add_f32 v25, v25, v29
  v_mul_f32 v25, v20, v25
  v_add_f32 v26, v26, v30
  v_mul_f32 v26, v20, v26
  v_add_f32 v27, v27, v31
  v_mul_f32 v27, v20, v27
  s_mov_b32 s40, 0
p2b_o_12:
  buffer_load_dword v17, v9, s[4:7], s37 offen sc1
  s_add_u32 s40, s40, 1
  s_cmp_gt_u32 s40, 1048576
  s_cbranch_scc1 p2b_o_12_d
  s_waitcnt vmcnt(0)
  v_cmp_gt_u32 vcc, 1, v17
  s_cbranch_vccz p2b_o_12_d
  s_sleep 2
  s_branch p2b_o_12
p2b_o_12_d:
  s_add_u32 s41, s36, 0
  buffer_load_dwordx4 v[128:131], v3, s[4:7], s41 offen offset:0 sc1
  s_add_u32 s41, s36, 0
  buffer_load_dwordx4 v[132:135], v3, s[4:7], s41 offen offset:1024 sc1
  s_add_u32 s41, s36, 0
  buffer_load_dwordx4 v[136:139], v3, s[4:7], s41 offen offset:2048 sc1
  s_add_u32 s41, s36, 0
  buffer_load_dwordx4 v[140:143], v3, s[4:7], s41 offen offset:3072 sc1
  s_add_u32 s41, s36, 4096
  buffer_load_dwordx4 v[144:147], v3, s[4:7], s41 offen offset:0 sc1
  s_add_u32 s41, s36, 4096
  buffer_load_dwordx4 v[148:151], v3, s[4:7], s41 offen offset:1024 sc1
  s_add_u32 s41, s36, 4096
  buffer_load_dwordx4 v[152:155], v3, s[4:7], s41 offen offset:2048 sc1
  s_add_u32 s41, s36, 4096
  buffer_load_dwordx4 v[156:159], v3, s[4:7], s41 offen offset:3072 sc1
  s_add_u32 s41, s36, 8192
  buffer_load_dwordx4 v[160:163], v3, s[4:7], s41 offen offset:0 sc1
  s_add_u32 s41, s36, 8192
  buffer_load_dwordx4 v[164:167], v3, s[4:7], s41 offen offset:1024 sc1
  s_add_u32 s41, s36, 8192
  buffer_load_dwordx4 v[168:171], v3, s[4:7], s41 offen offset:2048 sc1
  s_add_u32 s41, s36, 8192
  buffer_load_dwordx4 v[172:175], v3, s[4:7], s41 offen offset:3072 sc1
  s_add_u32 s41, s36, 12288
  buffer_load_dwordx4 v[176:179], v3, s[4:7], s41 offen offset:0 sc1
  s_add_u32 s41, s36, 12288
  buffer_load_dwordx4 v[180:183], v3, s[4:7], s41 offen offset:1024 sc1
  s_add_u32 s41, s36, 12288
  buffer_load_dwordx4 v[184:187], v3, s[4:7], s41 offen offset:2048 sc1
  s_add_u32 s41, s36, 12288
  buffer_load_dwordx4 v[188:191], v3, s[4:7], s41 offen offset:3072 sc1
  s_add_u32 s41, s36, 16384
  buffer_load_dwordx4 v[192:195], v3, s[4:7], s41 offen offset:0 sc1
  s_add_u32 s41, s36, 16384
  buffer_load_dwordx4 v[196:199], v3, s[4:7], s41 offen offset:1024 sc1
  s_add_u32 s41, s36, 16384
  buffer_load_dwordx4 v[200:203], v3, s[4:7], s41 offen offset:2048 sc1
  s_add_u32 s41, s36, 16384
  buffer_load_dwordx4 v[204:207], v3, s[4:7], s41 offen offset:3072 sc1
  s_add_u32 s41, s36, 20480
  buffer_load_dwordx4 v[208:211], v3, s[4:7], s41 offen offset:0 sc1
  s_add_u32 s41, s36, 20480
  buffer_load_dwordx4 v[212:215], v3, s[4:7], s41 offen offset:1024 sc1
  s_add_u32 s41, s36, 20480
  buffer_load_dwordx4 v[216:219], v3, s[4:7], s41 offen offset:2048 sc1
  s_add_u32 s41, s36, 20480
  buffer_load_dwordx4 v[220:223], v3, s[4:7], s41 offen offset:3072 sc1
  s_add_u32 s41, s36, 24576
  buffer_load_dwordx4 v[224:227], v3, s[4:7], s41 offen offset:0 sc1
  s_add_u32 s41, s36, 24576
  buffer_load_dwordx4 v[228:231], v3, s[4:7], s41 offen offset:1024 sc1
  s_add_u32 s41, s36, 24576
  buffer_load_dwordx4 v[232:235], v3, s[4:7], s41 offen offset:2048 sc1
  s_add_u32 s41, s36, 24576
  buffer_load_dwordx4 v[236:239], v3, s[4:7], s41 offen offset:3072 sc1
  s_add_u32 s41, s36, 28672
  buffer_load_dwordx4 v[240:243], v3, s[4:7], s41 offen offset:0 sc1
  s_add_u32 s41, s36, 28672
  buffer_load_dwordx4 v[244:247], v3, s[4:7], s41 offen offset:1024 sc1
  s_add_u32 s41, s36, 28672
  buffer_load_dwordx4 v[248:251], v3, s[4:7], s41 offen offset:2048 sc1
  s_add_u32 s41, s36, 28672
  buffer_load_dwordx4 v[252:255], v3, s[4:7], s41 offen offset:3072 sc1
  s_waitcnt vmcnt(31)
  v_mfma_f32_16x16x32_bf16 v[32:35], a[0:3], v[128:131], 0
  s_waitcnt vmcnt(30)
  v_mfma_f32_16x16x32_bf16 v[32:35], a[4:7], v[132:135], v[32:35]
  s_waitcnt vmcnt(29)
  v_mfma_f32_16x16x32_bf16 v[32:35], a[8:11], v[136:139], v[32:35]
  s_waitcnt vmcnt(28)
  v_mfma_f32_16x16x32_bf16 v[32:35], a[12:15], v[140:143], v[32:35]
  s_waitcnt vmcnt(27)
  v_mfma_f32_16x16x32_bf16 v[32:35], a[16:19], v[144:147], v[32:35]
  s_waitcnt vmcnt(26)
  v_mfma_f32_16x16x32_bf16 v[32:35], a[20:23], v[148:151], v[32:35]
  s_waitcnt vmcnt(25)
  v_mfma_f32_16x16x32_bf16 v[32:35], a[24:27], v[152:155], v[32:35]
  s_waitcnt vmcnt(24)
  v_mfma_f32_16x16x32_bf16 v[32:35], a[28:31], v[156:159], v[32:35]
  s_waitcnt vmcnt(23)
  v_mfma_f32_16x16x32_bf16 v[32:35], a[32:35], v[160:163], v[32:35]
  s_waitcnt vmcnt(22)
  v_mfma_f32_16x16x32_bf16 v[32:35], a[36:39], v[164:167], v[32:35]
  s_waitcnt vmcnt(21)
  v_mfma_f32_16x16x32_bf16 v[32:35], a[40:43], v[168:171], v[32:35]
  s_waitcnt vmcnt(20)
  v_mfma_f32_16x16x32_bf16 v[32:35], a[44:47], v[172:175], v[32:35]
  s_waitcnt vmcnt(19)
  v_mfma_f32_16x16x32_bf16 v[32:35], a[48:51], v[176:179], v[32:35]
  s_waitcnt vmcnt(18)
  v_mfma_f32_16x16x32_bf16 v[32:35], a[52:55], v[180:183], v[32:35]
  s_waitcnt vmcnt(17)
  v_mfma_f32_16x16x32_bf16 v[32:35], a[56:59], v[184:187], v[32:35]
  s_waitcnt vmcnt(16)
  v_mfma_f32_16x16x32_bf16 v[32:35], a[60:63], v[188:191], v[32:35]
  s_waitcnt vmcnt(15)
  v_mfma_f32_16x16x32_bf16 v[32:35], a[64:67], v[192:195], v[32:35]
  s_waitcnt vmcnt(14)
  v_mfma_f32_16x16x32_bf16 v[32:35], a[68:71], v[196:199], v[32:35]
  s_waitcnt vmcnt(13)
  v_mfma_f32_16x16x32_bf16 v[32:35], a[72:75], v[200:203], v[32:35]
  s_waitcnt vmcnt(12)
  v_mfma_f32_16x16x32_bf16 v[32:35], a[76:79], v[204:207], v[32:35]
  s_waitcnt vmcnt(11)
  v_mfma_f32_16x16x32_bf16 v[32:35], a[80:83], v[208:211], v[32:35]
  s_waitcnt vmcnt(10)
  v_mfma_f32_16x16x32_bf16 v[32:35], a[84:87], v[212:215], v[32:35]
  s_waitcnt vmcnt(9)
  v_mfma_f32_16x16x32_bf16 v[32:35], a[88:91], v[216:219], v[32:35]
  s_waitcnt vmcnt(8)
  v_mfma_f32_16x16x32_bf16 v[32:35], a[92:95], v[220:223], v[32:35]
  s_waitcnt vmcnt(7)
  v_mfma_f32_16x16x32_bf16 v[32:35], a[96:99], v[224:227], v[32:35]
  s_waitcnt vmcnt(6)
  v_mfma_f32_16x16x32_bf16 v[32:35], a[100:103], v[228:231], v[32:35]
  s_waitcnt vmcnt(5)
  v_mfma_f32_16x16x32_bf16 v[32:35], a[104:107], v[232:235], v[32:35]
  s_waitcnt vmcnt(4)
  v_mfma_f32_16x16x32_bf16 v[32:35], a[108:111], v[236:239], v[32:35]
  s_waitcnt vmcnt(3)
  v_mfma_f32_16x16x32_bf16 v[32:35], a[112:115], v[240:243], v[32:35]
  s_waitcnt vmcnt(2)
  v_mfma_f32_16x16x32_bf16 v[32:35], a[116:119], v[244:247], v[32:35]
  s_waitcnt vmcnt(1)
  v_mfma_f32_16x16x32_bf16 v[32:35], a[120:123], v[248:251], v[32:35]
  s_waitcnt vmcnt(0)
  v_mfma_f32_16x16x32_bf16 v[32:35], a[124:127], v[252:255], v[32:35]
  s_nop 7
  v_fma_f32 v24, v19, v32, v24
  v_fma_f32 v25, v19, v33, v25
  v_fma_f32 v26, v19, v34, v26
  v_fma_f32 v27, v19, v35, v27
  ds_write_b128 v18, v[24:27]
  s_waitcnt lgkmcnt(0)
  s_barrier
  s_cmp_lg_u32 s33, 0
  s_cbranch_scc1 p2b_next
  v_and_b32 v21, 4096, v18
  v_add_u32 v21, v21, v3
  ds_read_b128 v[36:39], v21 offset:1024
  ds_read_b128 v[40:43], v21 offset:2048
  ds_read_b128 v[44:47], v21 offset:3072
  v_fma_f32 v24, v20, v12, v24
  v_fma_f32 v25, v20, v13, v25
  v_fma_f32 v26, v20, v14, v26
  v_fma_f32 v27, v20, v15, v27
  s_waitcnt lgkmcnt(0)
  v_add_f32 v24, v24, v36
  v_add_f32 v40, v40, v44
  v_add_f32 v24, v24, v40
  v_add_f32 v25, v25, v37
  v_add_f32 v41, v41, v45
  v_add_f32 v25, v25, v41
  v_add_f32 v26, v26, v38
  v_add_f32 v42, v42, v46
  v_add_f32 v26, v26, v42
  v_add_f32 v27, v27, v39
  v_add_f32 v43, v43, v47
  v_add_f32 v27, v27, v43
  v_cvt_pk_bf16_f32 v22, v24, v25
  v_cvt_pk_bf16_f32 v23, v26, v27
  s_lshl_b32 s41, s34, 14
  s_lshl_b32 s42, s32, 5
  s_add_u32 s41, s41, s42
  buffer_store_dwordx2 v[22:23], v7, s[24:27], s41 offen
p2b_next:
  v_xor_b32 v18, 4096, v18
  s_add_u32 s34, s34, 6
  s_cmp_lt_u32 s34, 128
  s_cbranch_scc1 p2b_loop
  s_endpgm
L_exit:
  s_endpgm
.section .rodata,"a"
.p2align 6
.amdhsa_kernel gated_mix__memory_aug_recurrent_mem_tr__dense_activation_squared_relu__prompt_kernel
  .amdhsa_next_free_vgpr 512
  .amdhsa_next_free_sgpr 102
  .amdhsa_accum_offset 256
  .amdhsa_group_segment_fixed_size 0
  .amdhsa_kernarg_size 128
  .amdhsa_user_sgpr_count 2
  .amdhsa_user_sgpr_kernarg_segment_ptr 1
  .amdhsa_system_sgpr_workgroup_id_x 1
.end_amdhsa_kernel
```
